```python
import torch

def _softmax(x, axis=-1):
    return torch.softmax(x, dim=axis)
def _gelu(x):
    return torch.nn.functional.gelu(x, approximate="tanh")
def _silu(x):
    return torch.nn.functional.silu(x)
def _sigmoid(x):
    return torch.sigmoid(x)
def _layernorm(x, axis=-1, eps=1e-5):
    m = x.mean(dim=axis, keepdim=True)
    v = x.var(dim=axis, keepdim=True, unbiased=False)
    return (x - m) / torch.sqrt(v + eps)
def _scatter_add(tgt, idx, src, axis=0):
    return tgt.clone().index_add_(axis, idx, src)
def _segment_sum(src, seg, n):
    out = torch.zeros((n,) + src.shape[1:], dtype=src.dtype)
    return out.index_add_(0, seg, src)
def _pad(x, pw):
    flat = tuple(v for pair in reversed(pw) for v in pair)
    return torch.nn.functional.pad(x, flat)

kernel_name = 'recurrent_scan__ssm_conv_s5__dense_activation_silu__prompt'

def setup_inputs():

    _w = (lambda a: (lambda t: t.to(torch.bfloat16) if t.is_floating_point() else t)(torch.as_tensor(a)))
    def _A_setup():
        B, S, D = 1, 2048, 640
        P = D
        Lambda_re = -0.5 * (lambda _x: torch.exp(torch.as_tensor(_x)))((lambda *s: torch.randn(*s, dtype=torch.bfloat16) * 0.8)(P))
        Lambda_im = (lambda *s: torch.randn(*s, dtype=torch.bfloat16) * 0.8)(P) * 1.0
        B_re = (lambda *s: torch.randn(*s, dtype=torch.bfloat16) * 0.8)(P, D) * (D ** -0.5)
        B_im = (lambda *s: torch.randn(*s, dtype=torch.bfloat16) * 0.8)(P, D) * (D ** -0.5)
        C_re = (lambda *s: torch.randn(*s, dtype=torch.bfloat16) * 0.8)(D, P) * (P ** -0.5)
        C_im = (lambda *s: torch.randn(*s, dtype=torch.bfloat16) * 0.8)(D, P) * (P ** -0.5)
        log_dt = (lambda *s: torch.randn(*s, dtype=torch.bfloat16) * 0.8)(P) * 0.3 - 2.0
        Dskip = (lambda *s: torch.randn(*s, dtype=torch.bfloat16) * 0.4)(D)
        return {
            "x": _w((lambda *s: torch.randn(*s, dtype=torch.bfloat16) * 0.05)(B, S, D)),
            "Lambda_re": _w(Lambda_re),
            "Lambda_im": _w(Lambda_im),
            "B_re": _w(B_re),
            "B_im": _w(B_im),
            "C_re": _w(C_re),
            "C_im": _w(C_im),
            "log_dt": _w(log_dt),
            "Dskip": _w(Dskip),
        }
    _A_in = _A_setup()

    def _B_setup():
        B, S, D, F = 1, 2048, 640, 1536
        return {
            "x": _w((lambda *s: torch.randn(*s, dtype=torch.bfloat16) * 0.05)(B, S, D)),
            "w1": _w((lambda *s: torch.randn(*s, dtype=torch.bfloat16) * 0.8)(D, F) * (D ** -0.5)),
            "w2": _w((lambda *s: torch.randn(*s, dtype=torch.bfloat16) * 0.1)(F, D) * (F ** -0.5)),
        }
    _B_in = _B_setup()

    return {
        "A_x": _A_in["x"],
        "A_Lambda_re": _A_in["Lambda_re"],
        "A_Lambda_im": _A_in["Lambda_im"],
        "A_B_re": _A_in["B_re"],
        "A_B_im": _A_in["B_im"],
        "A_C_re": _A_in["C_re"],
        "A_C_im": _A_in["C_im"],
        "A_log_dt": _A_in["log_dt"],
        "A_Dskip": _A_in["Dskip"],
        "B_x": _B_in["x"],
        "B_w1": _B_in["w1"],
        "B_w2": _B_in["w2"],
    }

def reference(A_x, A_Lambda_re, A_Lambda_im, A_B_re, A_B_im, A_C_re, A_C_im, A_log_dt, A_Dskip, B_x, B_w1, B_w2):
    def _A_ref(x, Lambda_re, Lambda_im, B_re, B_im, C_re, C_im, log_dt, Dskip):
        Bsz, L, H = x.shape
        Lam = Lambda_re + 1j * Lambda_im
        Bmat = B_re + 1j * B_im
        Cmat = C_re + 1j * C_im
        dt = torch.exp(log_dt)
        Lam_bar = torch.exp(dt * Lam)
        B_bar = ((Lam_bar - 1.0) / Lam)[:, None] * Bmat
        Bu = torch.einsum("bld,pd->blp", x + 0j, B_bar)
        h = torch.zeros_like(Bu[:, 0, :])
        hs = []
        for t in range(L):
            h = Lam_bar[None, :] * h + Bu[:, t, :]
            hs.append(h)
        hseq = torch.stack(hs, 1)
        y = 2.0 * torch.einsum("blp,dp->bld", hseq, Cmat).real + x * Dskip[None, None, :]
        return y

    def _B_ref(x, w1, w2):
        h = torch.einsum("bsd,df->bsf", x, w1)
        h = _silu(h)
        out = torch.einsum("bsf,fd->bsd", h, w2)
        return out

    x = A_x
    xn = _layernorm(x, axis=-1)
    s = _A_ref(xn, A_Lambda_re, A_Lambda_im, A_B_re, A_B_im, A_C_re, A_C_im, A_log_dt, A_Dskip)
    g = _silu(_B_ref(xn, B_w1, B_w2))
    return x + s * g
```

```asm
; @launch kernel=k0_kernel grid=(241,1,1) block=(256,1,1) lds=32768
; @launch kernel=k1_kernel grid=(256,1,1) block=(256,1,1) lds=154624
; @launch kernel=k3_kernel grid=(256,1,1) block=(256,1,1) lds=86016
.amdgcn_target "amdgcn-amd-amdhsa--gfx950"
.text
.globl k0_kernel
.p2align 8
.type k0_kernel,@function
k0_kernel:
    s_cmp_ge_u32 s2, 241
    s_cbranch_scc1 K0_END
    s_load_dwordx2 s[6:7], s[0:1], 112
    s_cmp_ge_u32 s2, 128
    s_cbranch_scc1 K0_NOTLN
    s_load_dwordx2 s[4:5], s[0:1], 0
    v_lshrrev_b32 v1, 6, v0
    v_and_b32 v2, 63, v0
    v_lshlrev_b32 v1, 2, v1
    v_lshlrev_b32 v3, 8, v2
    v_lshl_add_u32 v3, v1, 4, v3
    v_lshrrev_b32 v4, 2, v2
    v_lshlrev_b32 v4, 8, v4
    v_and_b32 v5, 3, v2
    v_lshl_add_u32 v4, v5, 2, v4
    v_lshl_add_u32 v4, v1, 4, v4
    v_add_u32 v4, 16384, v4
    s_lshl_b32 s3, s2, 4
    v_add_u32 v1, s3, v1
    v_mul_u32_u24 v1, 1280, v1
    v_lshlrev_b32 v5, 2, v2
    v_add_u32 v5, v5, v1
    v_lshlrev_b32 v2, 4, v2
    v_add_u32 v2, v2, v1
    s_waitcnt lgkmcnt(0)
    s_mov_b32 s8, s4
    s_mov_b32 s9, s5
    s_and_b32 s9, s9, 0xffff
    s_mov_b32 s10, 0x280000
    s_mov_b32 s11, 0x00020000
    s_mov_b32 s12, s6
    s_mov_b32 s13, s7
    s_and_b32 s13, s13, 0xffff
    s_mov_b32 s14, 0x280000
    s_mov_b32 s15, 0x00020000
    s_mov_b32 s3, 0
    buffer_load_dwordx4 v[16:19], v2, s[8:11], s3 offen
    buffer_load_dword v20, v5, s[8:11], s3 offen offset:1024
    s_mov_b32 s3, 1280
    buffer_load_dwordx4 v[40:43], v2, s[8:11], s3 offen
    buffer_load_dword v44, v5, s[8:11], s3 offen offset:1024
    s_mov_b32 s3, 2560
    buffer_load_dwordx4 v[64:67], v2, s[8:11], s3 offen
    buffer_load_dword v68, v5, s[8:11], s3 offen offset:1024
    s_mov_b32 s3, 3840
    buffer_load_dwordx4 v[88:91], v2, s[8:11], s3 offen
    buffer_load_dword v92, v5, s[8:11], s3 offen offset:1024
    v_mov_b32 v8, 0x44200000
    v_mov_b32 v9, 0x3acccccd
    s_waitcnt vmcnt(0)
    v_lshlrev_b32 v22, 16, v16
    v_and_b32 v23, 0xffff0000, v16
    v_lshlrev_b32 v24, 16, v17
    v_and_b32 v25, 0xffff0000, v17
    v_lshlrev_b32 v26, 16, v18
    v_and_b32 v27, 0xffff0000, v18
    v_lshlrev_b32 v28, 16, v19
    v_and_b32 v29, 0xffff0000, v19
    v_lshlrev_b32 v30, 16, v20
    v_and_b32 v31, 0xffff0000, v20
    v_add_f32 v32, v22, v23
    v_add_f32 v33, v24, v25
    v_add_f32 v34, v26, v27
    v_add_f32 v35, v28, v29
    v_add_f32 v36, v30, v31
    v_add_f32 v32, v32, v33
    v_add_f32 v34, v34, v35
    v_add_f32 v32, v32, v34
    v_add_f32 v32, v32, v36
    v_lshlrev_b32 v46, 16, v40
    v_and_b32 v47, 0xffff0000, v40
    v_lshlrev_b32 v48, 16, v41
    v_and_b32 v49, 0xffff0000, v41
    v_lshlrev_b32 v50, 16, v42
    v_and_b32 v51, 0xffff0000, v42
    v_lshlrev_b32 v52, 16, v43
    v_and_b32 v53, 0xffff0000, v43
    v_lshlrev_b32 v54, 16, v44
    v_and_b32 v55, 0xffff0000, v44
    v_add_f32 v56, v46, v47
    v_add_f32 v57, v48, v49
    v_add_f32 v58, v50, v51
    v_add_f32 v59, v52, v53
    v_add_f32 v60, v54, v55
    v_add_f32 v56, v56, v57
    v_add_f32 v58, v58, v59
    v_add_f32 v56, v56, v58
    v_add_f32 v56, v56, v60
    v_lshlrev_b32 v70, 16, v64
    v_and_b32 v71, 0xffff0000, v64
    v_lshlrev_b32 v72, 16, v65
    v_and_b32 v73, 0xffff0000, v65
    v_lshlrev_b32 v74, 16, v66
    v_and_b32 v75, 0xffff0000, v66
    v_lshlrev_b32 v76, 16, v67
    v_and_b32 v77, 0xffff0000, v67
    v_lshlrev_b32 v78, 16, v68
    v_and_b32 v79, 0xffff0000, v68
    v_add_f32 v80, v70, v71
    v_add_f32 v81, v72, v73
    v_add_f32 v82, v74, v75
    v_add_f32 v83, v76, v77
    v_add_f32 v84, v78, v79
    v_add_f32 v80, v80, v81
    v_add_f32 v82, v82, v83
    v_add_f32 v80, v80, v82
    v_add_f32 v80, v80, v84
    v_lshlrev_b32 v94, 16, v88
    v_and_b32 v95, 0xffff0000, v88
    v_lshlrev_b32 v96, 16, v89
    v_and_b32 v97, 0xffff0000, v89
    v_lshlrev_b32 v98, 16, v90
    v_and_b32 v99, 0xffff0000, v90
    v_lshlrev_b32 v100, 16, v91
    v_and_b32 v101, 0xffff0000, v91
    v_lshlrev_b32 v102, 16, v92
    v_and_b32 v103, 0xffff0000, v92
    v_add_f32 v104, v94, v95
    v_add_f32 v105, v96, v97
    v_add_f32 v106, v98, v99
    v_add_f32 v107, v100, v101
    v_add_f32 v108, v102, v103
    v_add_f32 v104, v104, v105
    v_add_f32 v106, v106, v107
    v_add_f32 v104, v104, v106
    v_add_f32 v104, v104, v108
    s_nop 1
    v_add_f32_dpp v33, v32, v32 quad_perm:[1,0,3,2] row_mask:0xf bank_mask:0xf
    v_add_f32_dpp v57, v56, v56 quad_perm:[1,0,3,2] row_mask:0xf bank_mask:0xf
    v_add_f32_dpp v81, v80, v80 quad_perm:[1,0,3,2] row_mask:0xf bank_mask:0xf
    v_add_f32_dpp v105, v104, v104 quad_perm:[1,0,3,2] row_mask:0xf bank_mask:0xf
    v_mov_b32 v32, v33
    v_mov_b32 v56, v57
    v_mov_b32 v80, v81
    v_mov_b32 v104, v105
    s_nop 1
    v_add_f32_dpp v33, v32, v32 quad_perm:[2,3,0,1] row_mask:0xf bank_mask:0xf
    v_add_f32_dpp v57, v56, v56 quad_perm:[2,3,0,1] row_mask:0xf bank_mask:0xf
    v_add_f32_dpp v81, v80, v80 quad_perm:[2,3,0,1] row_mask:0xf bank_mask:0xf
    v_add_f32_dpp v105, v104, v104 quad_perm:[2,3,0,1] row_mask:0xf bank_mask:0xf
    v_mov_b32 v32, v33
    v_mov_b32 v56, v57
    v_mov_b32 v80, v81
    v_mov_b32 v104, v105
    s_nop 1
    v_add_f32_dpp v33, v32, v32 row_half_mirror row_mask:0xf bank_mask:0xf
    v_add_f32_dpp v57, v56, v56 row_half_mirror row_mask:0xf bank_mask:0xf
    v_add_f32_dpp v81, v80, v80 row_half_mirror row_mask:0xf bank_mask:0xf
    v_add_f32_dpp v105, v104, v104 row_half_mirror row_mask:0xf bank_mask:0xf
    v_mov_b32 v32, v33
    v_mov_b32 v56, v57
    v_mov_b32 v80, v81
    v_mov_b32 v104, v105
    s_nop 1
    v_add_f32_dpp v33, v32, v32 row_mirror row_mask:0xf bank_mask:0xf
    v_add_f32_dpp v57, v56, v56 row_mirror row_mask:0xf bank_mask:0xf
    v_add_f32_dpp v81, v80, v80 row_mirror row_mask:0xf bank_mask:0xf
    v_add_f32_dpp v105, v104, v104 row_mirror row_mask:0xf bank_mask:0xf
    v_mov_b32 v32, v33
    v_mov_b32 v56, v57
    v_mov_b32 v80, v81
    v_mov_b32 v104, v105
    s_nop 1
    v_readlane_b32 s40, v32, 0
    v_readlane_b32 s41, v32, 16
    v_readlane_b32 s42, v32, 32
    v_readlane_b32 s43, v32, 48
    v_readlane_b32 s44, v56, 0
    v_readlane_b32 s45, v56, 16
    v_readlane_b32 s46, v56, 32
    v_readlane_b32 s47, v56, 48
    v_readlane_b32 s48, v80, 0
    v_readlane_b32 s49, v80, 16
    v_readlane_b32 s50, v80, 32
    v_readlane_b32 s51, v80, 48
    v_readlane_b32 s52, v104, 0
    v_readlane_b32 s53, v104, 16
    v_readlane_b32 s54, v104, 32
    v_readlane_b32 s55, v104, 48
    s_nop 1
    v_mov_b32 v32, s40
    v_add_f32 v32, s41, v32
    v_mov_b32 v33, s42
    v_add_f32 v33, s43, v33
    v_add_f32 v32, v32, v33
    v_mov_b32 v56, s44
    v_add_f32 v56, s45, v56
    v_mov_b32 v57, s46
    v_add_f32 v57, s47, v57
    v_add_f32 v56, v56, v57
    v_mov_b32 v80, s48
    v_add_f32 v80, s49, v80
    v_mov_b32 v81, s50
    v_add_f32 v81, s51, v81
    v_add_f32 v80, v80, v81
    v_mov_b32 v104, s52
    v_add_f32 v104, s53, v104
    v_mov_b32 v105, s54
    v_add_f32 v105, s55, v105
    v_add_f32 v104, v104, v105
    v_mul_f32 v34, v32, v9
    v_fma_f32 v33, -v34, v8, v32
    v_fma_f32 v34, v33, v9, v34
    v_mov_b32 v32, 0
    v_sub_f32 v33, v22, v34
    v_fma_f32 v32, v33, v33, v32
    v_sub_f32 v33, v23, v34
    v_fma_f32 v32, v33, v33, v32
    v_sub_f32 v33, v24, v34
    v_fma_f32 v32, v33, v33, v32
    v_sub_f32 v33, v25, v34
    v_fma_f32 v32, v33, v33, v32
    v_sub_f32 v33, v26, v34
    v_fma_f32 v32, v33, v33, v32
    v_sub_f32 v33, v27, v34
    v_fma_f32 v32, v33, v33, v32
    v_sub_f32 v33, v28, v34
    v_fma_f32 v32, v33, v33, v32
    v_sub_f32 v33, v29, v34
    v_fma_f32 v32, v33, v33, v32
    v_sub_f32 v33, v30, v34
    v_fma_f32 v32, v33, v33, v32
    v_sub_f32 v33, v31, v34
    v_fma_f32 v32, v33, v33, v32
    v_mul_f32 v58, v56, v9
    v_fma_f32 v57, -v58, v8, v56
    v_fma_f32 v58, v57, v9, v58
    v_mov_b32 v56, 0
    v_sub_f32 v57, v46, v58
    v_fma_f32 v56, v57, v57, v56
    v_sub_f32 v57, v47, v58
    v_fma_f32 v56, v57, v57, v56
    v_sub_f32 v57, v48, v58
    v_fma_f32 v56, v57, v57, v56
    v_sub_f32 v57, v49, v58
    v_fma_f32 v56, v57, v57, v56
    v_sub_f32 v57, v50, v58
    v_fma_f32 v56, v57, v57, v56
    v_sub_f32 v57, v51, v58
    v_fma_f32 v56, v57, v57, v56
    v_sub_f32 v57, v52, v58
    v_fma_f32 v56, v57, v57, v56
    v_sub_f32 v57, v53, v58
    v_fma_f32 v56, v57, v57, v56
    v_sub_f32 v57, v54, v58
    v_fma_f32 v56, v57, v57, v56
    v_sub_f32 v57, v55, v58
    v_fma_f32 v56, v57, v57, v56
    v_mul_f32 v82, v80, v9
    v_fma_f32 v81, -v82, v8, v80
    v_fma_f32 v82, v81, v9, v82
    v_mov_b32 v80, 0
    v_sub_f32 v81, v70, v82
    v_fma_f32 v80, v81, v81, v80
    v_sub_f32 v81, v71, v82
    v_fma_f32 v80, v81, v81, v80
    v_sub_f32 v81, v72, v82
    v_fma_f32 v80, v81, v81, v80
    v_sub_f32 v81, v73, v82
    v_fma_f32 v80, v81, v81, v80
    v_sub_f32 v81, v74, v82
    v_fma_f32 v80, v81, v81, v80
    v_sub_f32 v81, v75, v82
    v_fma_f32 v80, v81, v81, v80
    v_sub_f32 v81, v76, v82
    v_fma_f32 v80, v81, v81, v80
    v_sub_f32 v81, v77, v82
    v_fma_f32 v80, v81, v81, v80
    v_sub_f32 v81, v78, v82
    v_fma_f32 v80, v81, v81, v80
    v_sub_f32 v81, v79, v82
    v_fma_f32 v80, v81, v81, v80
    v_mul_f32 v106, v104, v9
    v_fma_f32 v105, -v106, v8, v104
    v_fma_f32 v106, v105, v9, v106
    v_mov_b32 v104, 0
    v_sub_f32 v105, v94, v106
    v_fma_f32 v104, v105, v105, v104
    v_sub_f32 v105, v95, v106
    v_fma_f32 v104, v105, v105, v104
    v_sub_f32 v105, v96, v106
    v_fma_f32 v104, v105, v105, v104
    v_sub_f32 v105, v97, v106
    v_fma_f32 v104, v105, v105, v104
    v_sub_f32 v105, v98, v106
    v_fma_f32 v104, v105, v105, v104
    v_sub_f32 v105, v99, v106
    v_fma_f32 v104, v105, v105, v104
    v_sub_f32 v105, v100, v106
    v_fma_f32 v104, v105, v105, v104
    v_sub_f32 v105, v101, v106
    v_fma_f32 v104, v105, v105, v104
    v_sub_f32 v105, v102, v106
    v_fma_f32 v104, v105, v105, v104
    v_sub_f32 v105, v103, v106
    v_fma_f32 v104, v105, v105, v104
    s_nop 1
    v_add_f32_dpp v33, v32, v32 quad_perm:[1,0,3,2] row_mask:0xf bank_mask:0xf
    v_add_f32_dpp v57, v56, v56 quad_perm:[1,0,3,2] row_mask:0xf bank_mask:0xf
    v_add_f32_dpp v81, v80, v80 quad_perm:[1,0,3,2] row_mask:0xf bank_mask:0xf
    v_add_f32_dpp v105, v104, v104 quad_perm:[1,0,3,2] row_mask:0xf bank_mask:0xf
    v_mov_b32 v32, v33
    v_mov_b32 v56, v57
    v_mov_b32 v80, v81
    v_mov_b32 v104, v105
    s_nop 1
    v_add_f32_dpp v33, v32, v32 quad_perm:[2,3,0,1] row_mask:0xf bank_mask:0xf
    v_add_f32_dpp v57, v56, v56 quad_perm:[2,3,0,1] row_mask:0xf bank_mask:0xf
    v_add_f32_dpp v81, v80, v80 quad_perm:[2,3,0,1] row_mask:0xf bank_mask:0xf
    v_add_f32_dpp v105, v104, v104 quad_perm:[2,3,0,1] row_mask:0xf bank_mask:0xf
    v_mov_b32 v32, v33
    v_mov_b32 v56, v57
    v_mov_b32 v80, v81
    v_mov_b32 v104, v105
    s_nop 1
    v_add_f32_dpp v33, v32, v32 row_half_mirror row_mask:0xf bank_mask:0xf
    v_add_f32_dpp v57, v56, v56 row_half_mirror row_mask:0xf bank_mask:0xf
    v_add_f32_dpp v81, v80, v80 row_half_mirror row_mask:0xf bank_mask:0xf
    v_add_f32_dpp v105, v104, v104 row_half_mirror row_mask:0xf bank_mask:0xf
    v_mov_b32 v32, v33
    v_mov_b32 v56, v57
    v_mov_b32 v80, v81
    v_mov_b32 v104, v105
    s_nop 1
    v_add_f32_dpp v33, v32, v32 row_mirror row_mask:0xf bank_mask:0xf
    v_add_f32_dpp v57, v56, v56 row_mirror row_mask:0xf bank_mask:0xf
    v_add_f32_dpp v81, v80, v80 row_mirror row_mask:0xf bank_mask:0xf
    v_add_f32_dpp v105, v104, v104 row_mirror row_mask:0xf bank_mask:0xf
    v_mov_b32 v32, v33
    v_mov_b32 v56, v57
    v_mov_b32 v80, v81
    v_mov_b32 v104, v105
    s_nop 1
    v_readlane_b32 s40, v32, 0
    v_readlane_b32 s41, v32, 16
    v_readlane_b32 s42, v32, 32
    v_readlane_b32 s43, v32, 48
    v_readlane_b32 s44, v56, 0
    v_readlane_b32 s45, v56, 16
    v_readlane_b32 s46, v56, 32
    v_readlane_b32 s47, v56, 48
    v_readlane_b32 s48, v80, 0
    v_readlane_b32 s49, v80, 16
    v_readlane_b32 s50, v80, 32
    v_readlane_b32 s51, v80, 48
    v_readlane_b32 s52, v104, 0
    v_readlane_b32 s53, v104, 16
    v_readlane_b32 s54, v104, 32
    v_readlane_b32 s55, v104, 48
    s_nop 1
    v_mov_b32 v32, s40
    v_add_f32 v32, s41, v32
    v_mov_b32 v33, s42
    v_add_f32 v33, s43, v33
    v_add_f32 v32, v32, v33
    v_mov_b32 v56, s44
    v_add_f32 v56, s45, v56
    v_mov_b32 v57, s46
    v_add_f32 v57, s47, v57
    v_add_f32 v56, v56, v57
    v_mov_b32 v80, s48
    v_add_f32 v80, s49, v80
    v_mov_b32 v81, s50
    v_add_f32 v81, s51, v81
    v_add_f32 v80, v80, v81
    v_mov_b32 v104, s52
    v_add_f32 v104, s53, v104
    v_mov_b32 v105, s54
    v_add_f32 v105, s55, v105
    v_add_f32 v104, v104, v105
    v_mul_f32 v35, v32, v9
    v_fma_f32 v33, -v35, v8, v32
    v_fma_f32 v35, v33, v9, v35
    v_cvt_pk_bf16_f32 v34, v34, v34
    v_lshlrev_b32 v34, 16, v34
    v_cvt_pk_bf16_f32 v35, v35, v35
    v_lshlrev_b32 v35, 16, v35
    v_add_f32 v35, 0x3727c5ac, v35
    v_cvt_pk_bf16_f32 v35, v35, v35
    v_lshlrev_b32 v35, 16, v35
    v_sqrt_f32 v36, v35
    s_nop 0
    v_rcp_f32 v37, v36
    v_fma_f32 v33, -v36, v36, v35
    v_mul_f32 v37, 0.5, v37
    v_fma_f32 v36, v33, v37, v36
    v_cvt_pk_bf16_f32 v36, v36, v36
    v_lshlrev_b32 v36, 16, v36
    v_rcp_f32 v37, v36
    s_nop 0
    v_sub_f32 v32, v22, v34
    v_sub_f32 v33, v23, v34
    v_cvt_pk_bf16_f32 v32, v32, v33
    v_and_b32 v33, 0xffff0000, v32
    v_lshlrev_b32 v32, 16, v32
    v_mul_f32 v38, v32, v37
    v_fma_f32 v21, -v38, v36, v32
    v_fma_f32 v38, v21, v37, v38
    v_mul_f32 v39, v33, v37
    v_fma_f32 v21, -v39, v36, v33
    v_fma_f32 v39, v21, v37, v39
    v_cvt_pk_bf16_f32 v16, v38, v39
    v_sub_f32 v32, v24, v34
    v_sub_f32 v33, v25, v34
    v_cvt_pk_bf16_f32 v32, v32, v33
    v_and_b32 v33, 0xffff0000, v32
    v_lshlrev_b32 v32, 16, v32
    v_mul_f32 v38, v32, v37
    v_fma_f32 v21, -v38, v36, v32
    v_fma_f32 v38, v21, v37, v38
    v_mul_f32 v39, v33, v37
    v_fma_f32 v21, -v39, v36, v33
    v_fma_f32 v39, v21, v37, v39
    v_cvt_pk_bf16_f32 v17, v38, v39
    v_sub_f32 v32, v26, v34
    v_sub_f32 v33, v27, v34
    v_cvt_pk_bf16_f32 v32, v32, v33
    v_and_b32 v33, 0xffff0000, v32
    v_lshlrev_b32 v32, 16, v32
    v_mul_f32 v38, v32, v37
    v_fma_f32 v21, -v38, v36, v32
    v_fma_f32 v38, v21, v37, v38
    v_mul_f32 v39, v33, v37
    v_fma_f32 v21, -v39, v36, v33
    v_fma_f32 v39, v21, v37, v39
    v_cvt_pk_bf16_f32 v18, v38, v39
    v_sub_f32 v32, v28, v34
    v_sub_f32 v33, v29, v34
    v_cvt_pk_bf16_f32 v32, v32, v33
    v_and_b32 v33, 0xffff0000, v32
    v_lshlrev_b32 v32, 16, v32
    v_mul_f32 v38, v32, v37
    v_fma_f32 v21, -v38, v36, v32
    v_fma_f32 v38, v21, v37, v38
    v_mul_f32 v39, v33, v37
    v_fma_f32 v21, -v39, v36, v33
    v_fma_f32 v39, v21, v37, v39
    v_cvt_pk_bf16_f32 v19, v38, v39
    v_sub_f32 v32, v30, v34
    v_sub_f32 v33, v31, v34
    v_cvt_pk_bf16_f32 v32, v32, v33
    v_and_b32 v33, 0xffff0000, v32
    v_lshlrev_b32 v32, 16, v32
    v_mul_f32 v38, v32, v37
    v_fma_f32 v21, -v38, v36, v32
    v_fma_f32 v38, v21, v37, v38
    v_mul_f32 v39, v33, v37
    v_fma_f32 v21, -v39, v36, v33
    v_fma_f32 v39, v21, v37, v39
    v_cvt_pk_bf16_f32 v20, v38, v39
    ds_write_b128 v3, v[16:19] offset:0
    ds_write_b32 v4, v20 offset:0
    v_mul_f32 v59, v56, v9
    v_fma_f32 v57, -v59, v8, v56
    v_fma_f32 v59, v57, v9, v59
    v_cvt_pk_bf16_f32 v58, v58, v58
    v_lshlrev_b32 v58, 16, v58
    v_cvt_pk_bf16_f32 v59, v59, v59
    v_lshlrev_b32 v59, 16, v59
    v_add_f32 v59, 0x3727c5ac, v59
    v_cvt_pk_bf16_f32 v59, v59, v59
    v_lshlrev_b32 v59, 16, v59
    v_sqrt_f32 v60, v59
    s_nop 0
    v_rcp_f32 v61, v60
    v_fma_f32 v57, -v60, v60, v59
    v_mul_f32 v61, 0.5, v61
    v_fma_f32 v60, v57, v61, v60
    v_cvt_pk_bf16_f32 v60, v60, v60
    v_lshlrev_b32 v60, 16, v60
    v_rcp_f32 v61, v60
    s_nop 0
    v_sub_f32 v56, v46, v58
    v_sub_f32 v57, v47, v58
    v_cvt_pk_bf16_f32 v56, v56, v57
    v_and_b32 v57, 0xffff0000, v56
    v_lshlrev_b32 v56, 16, v56
    v_mul_f32 v62, v56, v61
    v_fma_f32 v45, -v62, v60, v56
    v_fma_f32 v62, v45, v61, v62
    v_mul_f32 v63, v57, v61
    v_fma_f32 v45, -v63, v60, v57
    v_fma_f32 v63, v45, v61, v63
    v_cvt_pk_bf16_f32 v40, v62, v63
    v_sub_f32 v56, v48, v58
    v_sub_f32 v57, v49, v58
    v_cvt_pk_bf16_f32 v56, v56, v57
    v_and_b32 v57, 0xffff0000, v56
    v_lshlrev_b32 v56, 16, v56
    v_mul_f32 v62, v56, v61
    v_fma_f32 v45, -v62, v60, v56
    v_fma_f32 v62, v45, v61, v62
    v_mul_f32 v63, v57, v61
    v_fma_f32 v45, -v63, v60, v57
    v_fma_f32 v63, v45, v61, v63
    v_cvt_pk_bf16_f32 v41, v62, v63
    v_sub_f32 v56, v50, v58
    v_sub_f32 v57, v51, v58
    v_cvt_pk_bf16_f32 v56, v56, v57
    v_and_b32 v57, 0xffff0000, v56
    v_lshlrev_b32 v56, 16, v56
    v_mul_f32 v62, v56, v61
    v_fma_f32 v45, -v62, v60, v56
    v_fma_f32 v62, v45, v61, v62
    v_mul_f32 v63, v57, v61
    v_fma_f32 v45, -v63, v60, v57
    v_fma_f32 v63, v45, v61, v63
    v_cvt_pk_bf16_f32 v42, v62, v63
    v_sub_f32 v56, v52, v58
    v_sub_f32 v57, v53, v58
    v_cvt_pk_bf16_f32 v56, v56, v57
    v_and_b32 v57, 0xffff0000, v56
    v_lshlrev_b32 v56, 16, v56
    v_mul_f32 v62, v56, v61
    v_fma_f32 v45, -v62, v60, v56
    v_fma_f32 v62, v45, v61, v62
    v_mul_f32 v63, v57, v61
    v_fma_f32 v45, -v63, v60, v57
    v_fma_f32 v63, v45, v61, v63
    v_cvt_pk_bf16_f32 v43, v62, v63
    v_sub_f32 v56, v54, v58
    v_sub_f32 v57, v55, v58
    v_cvt_pk_bf16_f32 v56, v56, v57
    v_and_b32 v57, 0xffff0000, v56
    v_lshlrev_b32 v56, 16, v56
    v_mul_f32 v62, v56, v61
    v_fma_f32 v45, -v62, v60, v56
    v_fma_f32 v62, v45, v61, v62
    v_mul_f32 v63, v57, v61
    v_fma_f32 v45, -v63, v60, v57
    v_fma_f32 v63, v45, v61, v63
    v_cvt_pk_bf16_f32 v44, v62, v63
    ds_write_b128 v3, v[40:43] offset:16
    ds_write_b32 v4, v44 offset:16
    v_mul_f32 v83, v80, v9
    v_fma_f32 v81, -v83, v8, v80
    v_fma_f32 v83, v81, v9, v83
    v_cvt_pk_bf16_f32 v82, v82, v82
    v_lshlrev_b32 v82, 16, v82
    v_cvt_pk_bf16_f32 v83, v83, v83
    v_lshlrev_b32 v83, 16, v83
    v_add_f32 v83, 0x3727c5ac, v83
    v_cvt_pk_bf16_f32 v83, v83, v83
    v_lshlrev_b32 v83, 16, v83
    v_sqrt_f32 v84, v83
    s_nop 0
    v_rcp_f32 v85, v84
    v_fma_f32 v81, -v84, v84, v83
    v_mul_f32 v85, 0.5, v85
    v_fma_f32 v84, v81, v85, v84
    v_cvt_pk_bf16_f32 v84, v84, v84
    v_lshlrev_b32 v84, 16, v84
    v_rcp_f32 v85, v84
    s_nop 0
    v_sub_f32 v80, v70, v82
    v_sub_f32 v81, v71, v82
    v_cvt_pk_bf16_f32 v80, v80, v81
    v_and_b32 v81, 0xffff0000, v80
    v_lshlrev_b32 v80, 16, v80
    v_mul_f32 v86, v80, v85
    v_fma_f32 v69, -v86, v84, v80
    v_fma_f32 v86, v69, v85, v86
    v_mul_f32 v87, v81, v85
    v_fma_f32 v69, -v87, v84, v81
    v_fma_f32 v87, v69, v85, v87
    v_cvt_pk_bf16_f32 v64, v86, v87
    v_sub_f32 v80, v72, v82
    v_sub_f32 v81, v73, v82
    v_cvt_pk_bf16_f32 v80, v80, v81
    v_and_b32 v81, 0xffff0000, v80
    v_lshlrev_b32 v80, 16, v80
    v_mul_f32 v86, v80, v85
    v_fma_f32 v69, -v86, v84, v80
    v_fma_f32 v86, v69, v85, v86
    v_mul_f32 v87, v81, v85
    v_fma_f32 v69, -v87, v84, v81
    v_fma_f32 v87, v69, v85, v87
    v_cvt_pk_bf16_f32 v65, v86, v87
    v_sub_f32 v80, v74, v82
    v_sub_f32 v81, v75, v82
    v_cvt_pk_bf16_f32 v80, v80, v81
    v_and_b32 v81, 0xffff0000, v80
    v_lshlrev_b32 v80, 16, v80
    v_mul_f32 v86, v80, v85
    v_fma_f32 v69, -v86, v84, v80
    v_fma_f32 v86, v69, v85, v86
    v_mul_f32 v87, v81, v85
    v_fma_f32 v69, -v87, v84, v81
    v_fma_f32 v87, v69, v85, v87
    v_cvt_pk_bf16_f32 v66, v86, v87
    v_sub_f32 v80, v76, v82
    v_sub_f32 v81, v77, v82
    v_cvt_pk_bf16_f32 v80, v80, v81
    v_and_b32 v81, 0xffff0000, v80
    v_lshlrev_b32 v80, 16, v80
    v_mul_f32 v86, v80, v85
    v_fma_f32 v69, -v86, v84, v80
    v_fma_f32 v86, v69, v85, v86
    v_mul_f32 v87, v81, v85
    v_fma_f32 v69, -v87, v84, v81
    v_fma_f32 v87, v69, v85, v87
    v_cvt_pk_bf16_f32 v67, v86, v87
    v_sub_f32 v80, v78, v82
    v_sub_f32 v81, v79, v82
    v_cvt_pk_bf16_f32 v80, v80, v81
    v_and_b32 v81, 0xffff0000, v80
    v_lshlrev_b32 v80, 16, v80
    v_mul_f32 v86, v80, v85
    v_fma_f32 v69, -v86, v84, v80
    v_fma_f32 v86, v69, v85, v86
    v_mul_f32 v87, v81, v85
    v_fma_f32 v69, -v87, v84, v81
    v_fma_f32 v87, v69, v85, v87
    v_cvt_pk_bf16_f32 v68, v86, v87
    ds_write_b128 v3, v[64:67] offset:32
    ds_write_b32 v4, v68 offset:32
    v_mul_f32 v107, v104, v9
    v_fma_f32 v105, -v107, v8, v104
    v_fma_f32 v107, v105, v9, v107
    v_cvt_pk_bf16_f32 v106, v106, v106
    v_lshlrev_b32 v106, 16, v106
    v_cvt_pk_bf16_f32 v107, v107, v107
    v_lshlrev_b32 v107, 16, v107
    v_add_f32 v107, 0x3727c5ac, v107
    v_cvt_pk_bf16_f32 v107, v107, v107
    v_lshlrev_b32 v107, 16, v107
    v_sqrt_f32 v108, v107
    s_nop 0
    v_rcp_f32 v109, v108
    v_fma_f32 v105, -v108, v108, v107
    v_mul_f32 v109, 0.5, v109
    v_fma_f32 v108, v105, v109, v108
    v_cvt_pk_bf16_f32 v108, v108, v108
    v_lshlrev_b32 v108, 16, v108
    v_rcp_f32 v109, v108
    s_nop 0
    v_sub_f32 v104, v94, v106
    v_sub_f32 v105, v95, v106
    v_cvt_pk_bf16_f32 v104, v104, v105
    v_and_b32 v105, 0xffff0000, v104
    v_lshlrev_b32 v104, 16, v104
    v_mul_f32 v110, v104, v109
    v_fma_f32 v93, -v110, v108, v104
    v_fma_f32 v110, v93, v109, v110
    v_mul_f32 v111, v105, v109
    v_fma_f32 v93, -v111, v108, v105
    v_fma_f32 v111, v93, v109, v111
    v_cvt_pk_bf16_f32 v88, v110, v111
    v_sub_f32 v104, v96, v106
    v_sub_f32 v105, v97, v106
    v_cvt_pk_bf16_f32 v104, v104, v105
    v_and_b32 v105, 0xffff0000, v104
    v_lshlrev_b32 v104, 16, v104
    v_mul_f32 v110, v104, v109
    v_fma_f32 v93, -v110, v108, v104
    v_fma_f32 v110, v93, v109, v110
    v_mul_f32 v111, v105, v109
    v_fma_f32 v93, -v111, v108, v105
    v_fma_f32 v111, v93, v109, v111
    v_cvt_pk_bf16_f32 v89, v110, v111
    v_sub_f32 v104, v98, v106
    v_sub_f32 v105, v99, v106
    v_cvt_pk_bf16_f32 v104, v104, v105
    v_and_b32 v105, 0xffff0000, v104
    v_lshlrev_b32 v104, 16, v104
    v_mul_f32 v110, v104, v109
    v_fma_f32 v93, -v110, v108, v104
    v_fma_f32 v110, v93, v109, v110
    v_mul_f32 v111, v105, v109
    v_fma_f32 v93, -v111, v108, v105
    v_fma_f32 v111, v93, v109, v111
    v_cvt_pk_bf16_f32 v90, v110, v111
    v_sub_f32 v104, v100, v106
    v_sub_f32 v105, v101, v106
    v_cvt_pk_bf16_f32 v104, v104, v105
    v_and_b32 v105, 0xffff0000, v104
    v_lshlrev_b32 v104, 16, v104
    v_mul_f32 v110, v104, v109
    v_fma_f32 v93, -v110, v108, v104
    v_fma_f32 v110, v93, v109, v110
    v_mul_f32 v111, v105, v109
    v_fma_f32 v93, -v111, v108, v105
    v_fma_f32 v111, v93, v109, v111
    v_cvt_pk_bf16_f32 v91, v110, v111
    v_sub_f32 v104, v102, v106
    v_sub_f32 v105, v103, v106
    v_cvt_pk_bf16_f32 v104, v104, v105
    v_and_b32 v105, 0xffff0000, v104
    v_lshlrev_b32 v104, 16, v104
    v_mul_f32 v110, v104, v109
    v_fma_f32 v93, -v110, v108, v104
    v_fma_f32 v110, v93, v109, v110
    v_mul_f32 v111, v105, v109
    v_fma_f32 v93, -v111, v108, v105
    v_fma_f32 v111, v93, v109, v111
    v_cvt_pk_bf16_f32 v92, v110, v111
    ds_write_b128 v3, v[88:91] offset:48
    ds_write_b32 v4, v92 offset:48
    v_lshlrev_b32 v1, 4, v0
    s_mul_i32 s3, s2, 20480
    s_waitcnt lgkmcnt(0)
    s_barrier
    ds_read_b128 v[16:19], v1 offset:0
    ds_read_b128 v[20:23], v1 offset:4096
    ds_read_b128 v[24:27], v1 offset:8192
    ds_read_b128 v[28:31], v1 offset:12288
    ds_read_b128 v[32:35], v1 offset:16384
    s_waitcnt lgkmcnt(4)
    s_add_u32 s4, s3, 0
    buffer_store_dwordx4 v[16:19], v1, s[12:15], s4 offen
    s_waitcnt lgkmcnt(3)
    s_add_u32 s4, s3, 4096
    buffer_store_dwordx4 v[20:23], v1, s[12:15], s4 offen
    s_waitcnt lgkmcnt(2)
    s_add_u32 s4, s3, 8192
    buffer_store_dwordx4 v[24:27], v1, s[12:15], s4 offen
    s_waitcnt lgkmcnt(1)
    s_add_u32 s4, s3, 12288
    buffer_store_dwordx4 v[28:31], v1, s[12:15], s4 offen
    s_waitcnt lgkmcnt(0)
    s_add_u32 s4, s3, 16384
    buffer_store_dwordx4 v[32:35], v1, s[12:15], s4 offen
    s_endpgm
K0_NOTLN:
    s_cmp_ge_u32 s2, 168
    s_cbranch_scc1 K0_NOTCP
    s_load_dwordx8 s[16:23], s[0:1], 24
    s_sub_u32 s3, s2, 128
    s_mul_hi_u32 s24, s3, 0xccccccd
    s_mul_i32 s25, s24, 20
    s_sub_u32 s25, s3, s25
    s_lshl_b32 s25, s25, 1
    v_and_b32 v1, 15, v0
    v_lshrrev_b32 v3, 4, v0
    v_mul_u32_u24 v1, 1280, v1
    v_lshlrev_b32 v2, 4, v0
    s_mul_i32 s3, s25, 20480
    s_waitcnt lgkmcnt(0)
    s_cmp_ge_u32 s24, 2
    s_cbranch_scc1 K0_CC
    v_lshl_add_u32 v1, v3, 4, v1
    s_cmp_eq_u32 s24, 1
    s_cselect_b32 s16, s18, s16
    s_cselect_b32 s17, s19, s17
    s_mov_b32 s8, s16
    s_mov_b32 s9, s17
    s_and_b32 s9, s9, 0xffff
    s_mov_b32 s10, 0xc8000
    s_mov_b32 s11, 0x00020000
    s_add_u32 s12, s6, 0x1180000
    s_addc_u32 s13, s7, 0
    s_and_b32 s13, s13, 0xffff
    s_mov_b32 s14, 0x190000
    s_mov_b32 s15, 0x00020000
    s_mul_i32 s4, s24, 819200
    s_add_u32 s4, s4, s3
    s_add_u32 s26, s3, 20480
    buffer_load_dwordx4 v[4:7], v1, s[8:11], s3 offen offset:0
    buffer_load_dwordx4 v[8:11], v1, s[8:11], s3 offen offset:256
    buffer_load_dwordx4 v[12:15], v1, s[8:11], s3 offen offset:512
    buffer_load_dwordx4 v[16:19], v1, s[8:11], s3 offen offset:768
    buffer_load_dwordx4 v[20:23], v1, s[8:11], s3 offen offset:1024
    buffer_load_dwordx4 v[24:27], v1, s[8:11], s26 offen offset:0
    buffer_load_dwordx4 v[28:31], v1, s[8:11], s26 offen offset:256
    buffer_load_dwordx4 v[32:35], v1, s[8:11], s26 offen offset:512
    buffer_load_dwordx4 v[36:39], v1, s[8:11], s26 offen offset:768
    buffer_load_dwordx4 v[40:43], v1, s[8:11], s26 offen offset:1024
    s_waitcnt vmcnt(9)
    s_add_u32 s5, s4, 0
    buffer_store_dwordx4 v[4:7], v2, s[12:15], s5 offen
    s_waitcnt vmcnt(8)
    s_add_u32 s5, s4, 4096
    buffer_store_dwordx4 v[8:11], v2, s[12:15], s5 offen
    s_waitcnt vmcnt(7)
    s_add_u32 s5, s4, 8192
    buffer_store_dwordx4 v[12:15], v2, s[12:15], s5 offen
    s_waitcnt vmcnt(6)
    s_add_u32 s5, s4, 12288
    buffer_store_dwordx4 v[16:19], v2, s[12:15], s5 offen
    s_waitcnt vmcnt(5)
    s_add_u32 s5, s4, 16384
    buffer_store_dwordx4 v[20:23], v2, s[12:15], s5 offen
    s_waitcnt vmcnt(4)
    s_add_u32 s5, s4, 20480
    buffer_store_dwordx4 v[24:27], v2, s[12:15], s5 offen
    s_waitcnt vmcnt(3)
    s_add_u32 s5, s4, 24576
    buffer_store_dwordx4 v[28:31], v2, s[12:15], s5 offen
    s_waitcnt vmcnt(2)
    s_add_u32 s5, s4, 28672
    buffer_store_dwordx4 v[32:35], v2, s[12:15], s5 offen
    s_waitcnt vmcnt(1)
    s_add_u32 s5, s4, 32768
    buffer_store_dwordx4 v[36:39], v2, s[12:15], s5 offen
    s_waitcnt vmcnt(0)
    s_add_u32 s5, s4, 36864
    buffer_store_dwordx4 v[40:43], v2, s[12:15], s5 offen
    s_endpgm
K0_CC:
    v_lshl_add_u32 v1, v3, 3, v1
    s_mov_b32 s8, s20
    s_mov_b32 s9, s21
    s_and_b32 s9, s9, 0xffff
    s_mov_b32 s10, 0xc8000
    s_mov_b32 s11, 0x00020000
    s_mov_b32 s28, s22
    s_mov_b32 s29, s23
    s_and_b32 s29, s29, 0xffff
    s_mov_b32 s30, 0xc8000
    s_mov_b32 s31, 0x00020000
    s_add_u32 s12, s6, 0x1310000
    s_addc_u32 s13, s7, 0
    s_and_b32 s13, s13, 0xffff
    s_mov_b32 s14, 0x190000
    s_mov_b32 s15, 0x00020000
    s_sub_u32 s24, s24, 2
    s_mul_i32 s4, s24, 640
    s_add_u32 s3, s3, s4
    s_add_u32 s33, s3, 20480
    s_mul_i32 s4, s25, 40960
    s_mul_i32 s5, s24, 20480
    s_add_u32 s4, s4, s5
    buffer_load_dwordx2 v[4:5], v1, s[8:11], s3 offen offset:0
    buffer_load_dwordx2 v[6:7], v1, s[28:31], s3 offen offset:0
    buffer_load_dwordx2 v[8:9], v1, s[8:11], s3 offen offset:128
    buffer_load_dwordx2 v[10:11], v1, s[28:31], s3 offen offset:128
    buffer_load_dwordx2 v[12:13], v1, s[8:11], s3 offen offset:256
    buffer_load_dwordx2 v[14:15], v1, s[28:31], s3 offen offset:256
    buffer_load_dwordx2 v[16:17], v1, s[8:11], s3 offen offset:384
    buffer_load_dwordx2 v[18:19], v1, s[28:31], s3 offen offset:384
    buffer_load_dwordx2 v[20:21], v1, s[8:11], s3 offen offset:512
    buffer_load_dwordx2 v[22:23], v1, s[28:31], s3 offen offset:512
    buffer_load_dwordx2 v[24:25], v1, s[8:11], s33 offen offset:0
    buffer_load_dwordx2 v[26:27], v1, s[28:31], s33 offen offset:0
    buffer_load_dwordx2 v[28:29], v1, s[8:11], s33 offen offset:128
    buffer_load_dwordx2 v[30:31], v1, s[28:31], s33 offen offset:128
    buffer_load_dwordx2 v[32:33], v1, s[8:11], s33 offen offset:256
    buffer_load_dwordx2 v[34:35], v1, s[28:31], s33 offen offset:256
    buffer_load_dwordx2 v[36:37], v1, s[8:11], s33 offen offset:384
    buffer_load_dwordx2 v[38:39], v1, s[28:31], s33 offen offset:384
    buffer_load_dwordx2 v[40:41], v1, s[8:11], s33 offen offset:512
    buffer_load_dwordx2 v[42:43], v1, s[28:31], s33 offen offset:512
    s_mov_b32 s26, 0x05040100
    s_mov_b32 s27, 0x07060302
    s_mov_b32 s32, 0x80008000
    s_waitcnt vmcnt(0)
    v_xor_b32 v6, s32, v6
    v_xor_b32 v7, s32, v7
    v_perm_b32 v48, v6, v4, s26
    v_perm_b32 v49, v6, v4, s27
    v_perm_b32 v50, v7, v5, s26
    v_perm_b32 v51, v7, v5, s27
    s_add_u32 s5, s4, 0
    buffer_store_dwordx4 v[48:51], v2, s[12:15], s5 offen
    v_xor_b32 v10, s32, v10
    v_xor_b32 v11, s32, v11
    v_perm_b32 v52, v10, v8, s26
    v_perm_b32 v53, v10, v8, s27
    v_perm_b32 v54, v11, v9, s26
    v_perm_b32 v55, v11, v9, s27
    s_add_u32 s5, s4, 4096
    buffer_store_dwordx4 v[52:55], v2, s[12:15], s5 offen
    v_xor_b32 v14, s32, v14
    v_xor_b32 v15, s32, v15
    v_perm_b32 v56, v14, v12, s26
    v_perm_b32 v57, v14, v12, s27
    v_perm_b32 v58, v15, v13, s26
    v_perm_b32 v59, v15, v13, s27
    s_add_u32 s5, s4, 8192
    buffer_store_dwordx4 v[56:59], v2, s[12:15], s5 offen
    v_xor_b32 v18, s32, v18
    v_xor_b32 v19, s32, v19
    v_perm_b32 v60, v18, v16, s26
    v_perm_b32 v61, v18, v16, s27
    v_perm_b32 v62, v19, v17, s26
    v_perm_b32 v63, v19, v17, s27
    s_add_u32 s5, s4, 12288
    buffer_store_dwordx4 v[60:63], v2, s[12:15], s5 offen
    v_xor_b32 v22, s32, v22
    v_xor_b32 v23, s32, v23
    v_perm_b32 v64, v22, v20, s26
    v_perm_b32 v65, v22, v20, s27
    v_perm_b32 v66, v23, v21, s26
    v_perm_b32 v67, v23, v21, s27
    s_add_u32 s5, s4, 16384
    buffer_store_dwordx4 v[64:67], v2, s[12:15], s5 offen
    v_xor_b32 v26, s32, v26
    v_xor_b32 v27, s32, v27
    v_perm_b32 v68, v26, v24, s26
    v_perm_b32 v69, v26, v24, s27
    v_perm_b32 v70, v27, v25, s26
    v_perm_b32 v71, v27, v25, s27
    s_add_u32 s5, s4, 40960
    buffer_store_dwordx4 v[68:71], v2, s[12:15], s5 offen
    v_xor_b32 v30, s32, v30
    v_xor_b32 v31, s32, v31
    v_perm_b32 v72, v30, v28, s26
    v_perm_b32 v73, v30, v28, s27
    v_perm_b32 v74, v31, v29, s26
    v_perm_b32 v75, v31, v29, s27
    s_add_u32 s5, s4, 45056
    buffer_store_dwordx4 v[72:75], v2, s[12:15], s5 offen
    v_xor_b32 v34, s32, v34
    v_xor_b32 v35, s32, v35
    v_perm_b32 v76, v34, v32, s26
    v_perm_b32 v77, v34, v32, s27
    v_perm_b32 v78, v35, v33, s26
    v_perm_b32 v79, v35, v33, s27
    s_add_u32 s5, s4, 49152
    buffer_store_dwordx4 v[76:79], v2, s[12:15], s5 offen
    v_xor_b32 v38, s32, v38
    v_xor_b32 v39, s32, v39
    v_perm_b32 v80, v38, v36, s26
    v_perm_b32 v81, v38, v36, s27
    v_perm_b32 v82, v39, v37, s26
    v_perm_b32 v83, v39, v37, s27
    s_add_u32 s5, s4, 53248
    buffer_store_dwordx4 v[80:83], v2, s[12:15], s5 offen
    v_xor_b32 v42, s32, v42
    v_xor_b32 v43, s32, v43
    v_perm_b32 v84, v42, v40, s26
    v_perm_b32 v85, v42, v40, s27
    v_perm_b32 v86, v43, v41, s26
    v_perm_b32 v87, v43, v41, s27
    s_add_u32 s5, s4, 57344
    buffer_store_dwordx4 v[84:87], v2, s[12:15], s5 offen
    s_endpgm
K0_NOTCP:
    s_cmp_ge_u32 s2, 228
    s_cbranch_scc1 K0_NOTTR
    s_cmp_ge_u32 s2, 228
    s_cbranch_scc1 K0_TR2
    s_load_dwordx2 s[4:5], s[0:1], 80
    s_sub_u32 s3, s2, 168
    s_mul_hi_u32 s18, s3, 0x2aaaaaab
    s_mul_i32 s19, s18, 6
    s_sub_u32 s19, s3, s19
    s_lshl_b32 s19, s19, 2
    s_mov_b32 s16, 3072
    s_mov_b32 s17, 20480
    s_mov_b32 s22, 128
    s_mov_b32 s23, 81920
    s_waitcnt lgkmcnt(0)
    s_add_u32 s12, s6, 0x280000
    s_addc_u32 s13, s7, 0
    s_and_b32 s13, s13, 0xffff
    s_mov_b32 s14, 0x1e0000
    s_mov_b32 s15, 0x00020000
    s_branch K0_TRGO
K0_TR2:
    s_load_dwordx2 s[4:5], s[0:1], 88
    s_sub_u32 s3, s2, 228
    s_mul_hi_u32 s18, s3, 0x1999999a
    s_mul_i32 s19, s18, 10
    s_sub_u32 s19, s3, s19
    s_lshl_b32 s18, s18, 2
    s_mov_b32 s16, 1280
    s_mov_b32 s17, 49152
    s_mov_b32 s22, 81920
    s_mov_b32 s23, 2048
    s_waitcnt lgkmcnt(0)
    s_add_u32 s12, s6, 0x460000
    s_addc_u32 s13, s7, 0
    s_and_b32 s13, s13, 0xffff
    s_mov_b32 s14, 0x1e0000
    s_mov_b32 s15, 0x00020000
K0_TRGO:
    s_mov_b32 s8, s4
    s_mov_b32 s9, s5
    s_and_b32 s9, s9, 0xffff
    s_mov_b32 s10, 0x1e0000
    s_mov_b32 s11, 0x00020000
    s_lshl_b32 s20, s18, 11
    s_lshl_b32 s21, s19, 2
    s_mul_i32 s21, s21, s17
    s_add_u32 s20, s20, s21
    s_lshl_b32 s18, s18, 6
    s_lshl_b32 s19, s19, 6
    v_lshrrev_b32 v1, 3, v0
    v_and_b32 v2, 7, v0
    v_add_u32 v3, s18, v1
    v_mul_lo_u32 v3, v3, s16
    v_lshlrev_b32 v4, 4, v2
    v_add_u32 v3, v3, v4
    s_lshl_b32 s3, s19, 1
    v_add_u32 v3, s3, v3
    s_lshl_b32 s3, s16, 5
    s_mov_b32 s24, 0
    s_add_u32 s25, s24, s3
    buffer_load_dwordx4 v[8:11], v3, s[8:11], s24 offen
    buffer_load_dwordx4 v[12:15], v3, s[8:11], s25 offen
    s_add_u32 s24, s24, s22
    s_add_u32 s25, s24, s3
    buffer_load_dwordx4 v[16:19], v3, s[8:11], s24 offen
    buffer_load_dwordx4 v[20:23], v3, s[8:11], s25 offen
    s_add_u32 s24, s24, s22
    s_add_u32 s25, s24, s3
    buffer_load_dwordx4 v[24:27], v3, s[8:11], s24 offen
    buffer_load_dwordx4 v[28:31], v3, s[8:11], s25 offen
    s_add_u32 s24, s24, s22
    s_add_u32 s25, s24, s3
    buffer_load_dwordx4 v[32:35], v3, s[8:11], s24 offen
    buffer_load_dwordx4 v[36:39], v3, s[8:11], s25 offen
    s_add_u32 s24, s24, s22
    v_lshlrev_b32 v5, 7, v1
    v_add_u32 v5, v5, v4
    s_waitcnt vmcnt(6)
    ds_write_b128 v5, v[8:11] offset:0
    ds_write_b128 v5, v[12:15] offset:4096
    s_waitcnt vmcnt(4)
    ds_write_b128 v5, v[16:19] offset:8192
    ds_write_b128 v5, v[20:23] offset:12288
    s_waitcnt vmcnt(2)
    ds_write_b128 v5, v[24:27] offset:16384
    ds_write_b128 v5, v[28:31] offset:20480
    s_waitcnt vmcnt(0)
    ds_write_b128 v5, v[32:35] offset:24576
    ds_write_b128 v5, v[36:39] offset:28672
    v_and_b32 v1, 15, v0
    v_lshrrev_b32 v2, 4, v0
    v_and_b32 v2, 7, v2
    v_lshrrev_b32 v6, 7, v0
    v_lshlrev_b32 v5, 10, v2
    v_lshl_add_u32 v5, v1, 1, v5
    v_lshl_add_u32 v5, v6, 5, v5
    v_mul_lo_u32 v3, v6, s17
    v_lshl_add_u32 v3, v2, 8, v3
    v_lshl_add_u32 v3, v1, 4, v3
    s_lshl_b32 s21, s17, 1
    s_waitcnt lgkmcnt(0)
    s_barrier
    ds_read_u16 v8, v5 offset:0
    ds_read_u16 v9, v5 offset:128
    ds_read_u16 v10, v5 offset:256
    ds_read_u16 v11, v5 offset:384
    ds_read_u16 v12, v5 offset:512
    ds_read_u16 v13, v5 offset:640
    ds_read_u16 v14, v5 offset:768
    ds_read_u16 v15, v5 offset:896
    ds_read_u16 v16, v5 offset:64
    ds_read_u16 v17, v5 offset:192
    ds_read_u16 v18, v5 offset:320
    ds_read_u16 v19, v5 offset:448
    ds_read_u16 v20, v5 offset:576
    ds_read_u16 v21, v5 offset:704
    ds_read_u16 v22, v5 offset:832
    ds_read_u16 v23, v5 offset:960
    s_waitcnt lgkmcnt(0)
    v_lshl_or_b32 v24, v9, 16, v8
    v_lshl_or_b32 v25, v11, 16, v10
    v_lshl_or_b32 v26, v13, 16, v12
    v_lshl_or_b32 v27, v15, 16, v14
    v_lshl_or_b32 v28, v17, 16, v16
    v_lshl_or_b32 v29, v19, 16, v18
    v_lshl_or_b32 v30, v21, 16, v20
    v_lshl_or_b32 v31, v23, 16, v22
    s_add_u32 s25, s20, s21
    buffer_store_dwordx4 v[24:27], v3, s[12:15], s20 offen
    buffer_store_dwordx4 v[28:31], v3, s[12:15], s25 offen
    s_add_u32 s20, s20, s23
    ds_read_u16 v32, v5 offset:8192
    ds_read_u16 v33, v5 offset:8320
    ds_read_u16 v34, v5 offset:8448
    ds_read_u16 v35, v5 offset:8576
    ds_read_u16 v36, v5 offset:8704
    ds_read_u16 v37, v5 offset:8832
    ds_read_u16 v38, v5 offset:8960
    ds_read_u16 v39, v5 offset:9088
    ds_read_u16 v40, v5 offset:8256
    ds_read_u16 v41, v5 offset:8384
    ds_read_u16 v42, v5 offset:8512
    ds_read_u16 v43, v5 offset:8640
    ds_read_u16 v44, v5 offset:8768
    ds_read_u16 v45, v5 offset:8896
    ds_read_u16 v46, v5 offset:9024
    ds_read_u16 v47, v5 offset:9152
    s_waitcnt lgkmcnt(0)
    v_lshl_or_b32 v48, v33, 16, v32
    v_lshl_or_b32 v49, v35, 16, v34
    v_lshl_or_b32 v50, v37, 16, v36
    v_lshl_or_b32 v51, v39, 16, v38
    v_lshl_or_b32 v52, v41, 16, v40
    v_lshl_or_b32 v53, v43, 16, v42
    v_lshl_or_b32 v54, v45, 16, v44
    v_lshl_or_b32 v55, v47, 16, v46
    s_add_u32 s25, s20, s21
    buffer_store_dwordx4 v[48:51], v3, s[12:15], s20 offen
    buffer_store_dwordx4 v[52:55], v3, s[12:15], s25 offen
    s_add_u32 s20, s20, s23
    ds_read_u16 v8, v5 offset:16384
    ds_read_u16 v9, v5 offset:16512
    ds_read_u16 v10, v5 offset:16640
    ds_read_u16 v11, v5 offset:16768
    ds_read_u16 v12, v5 offset:16896
    ds_read_u16 v13, v5 offset:17024
    ds_read_u16 v14, v5 offset:17152
    ds_read_u16 v15, v5 offset:17280
    ds_read_u16 v16, v5 offset:16448
    ds_read_u16 v17, v5 offset:16576
    ds_read_u16 v18, v5 offset:16704
    ds_read_u16 v19, v5 offset:16832
    ds_read_u16 v20, v5 offset:16960
    ds_read_u16 v21, v5 offset:17088
    ds_read_u16 v22, v5 offset:17216
    ds_read_u16 v23, v5 offset:17344
    s_waitcnt lgkmcnt(0)
    v_lshl_or_b32 v24, v9, 16, v8
    v_lshl_or_b32 v25, v11, 16, v10
    v_lshl_or_b32 v26, v13, 16, v12
    v_lshl_or_b32 v27, v15, 16, v14
    v_lshl_or_b32 v28, v17, 16, v16
    v_lshl_or_b32 v29, v19, 16, v18
    v_lshl_or_b32 v30, v21, 16, v20
    v_lshl_or_b32 v31, v23, 16, v22
    s_add_u32 s25, s20, s21
    buffer_store_dwordx4 v[24:27], v3, s[12:15], s20 offen
    buffer_store_dwordx4 v[28:31], v3, s[12:15], s25 offen
    s_add_u32 s20, s20, s23
    ds_read_u16 v32, v5 offset:24576
    ds_read_u16 v33, v5 offset:24704
    ds_read_u16 v34, v5 offset:24832
    ds_read_u16 v35, v5 offset:24960
    ds_read_u16 v36, v5 offset:25088
    ds_read_u16 v37, v5 offset:25216
    ds_read_u16 v38, v5 offset:25344
    ds_read_u16 v39, v5 offset:25472
    ds_read_u16 v40, v5 offset:24640
    ds_read_u16 v41, v5 offset:24768
    ds_read_u16 v42, v5 offset:24896
    ds_read_u16 v43, v5 offset:25024
    ds_read_u16 v44, v5 offset:25152
    ds_read_u16 v45, v5 offset:25280
    ds_read_u16 v46, v5 offset:25408
    ds_read_u16 v47, v5 offset:25536
    s_waitcnt lgkmcnt(0)
    v_lshl_or_b32 v48, v33, 16, v32
    v_lshl_or_b32 v49, v35, 16, v34
    v_lshl_or_b32 v50, v37, 16, v36
    v_lshl_or_b32 v51, v39, 16, v38
    v_lshl_or_b32 v52, v41, 16, v40
    v_lshl_or_b32 v53, v43, 16, v42
    v_lshl_or_b32 v54, v45, 16, v44
    v_lshl_or_b32 v55, v47, 16, v46
    s_add_u32 s25, s20, s21
    buffer_store_dwordx4 v[48:51], v3, s[12:15], s20 offen
    buffer_store_dwordx4 v[52:55], v3, s[12:15], s25 offen
    s_add_u32 s20, s20, s23
    s_endpgm
K0_NOTTR:
    s_cmp_ge_u32 s2, 231
    s_cbranch_scc1 K0_ZERO
    s_load_dwordx4 s[16:19], s[0:1], 8
    s_load_dwordx2 s[4:5], s[0:1], 56
    s_sub_u32 s3, s2, 228
    s_lshl_b32 s3, s3, 8
    v_add_u32 v1, s3, v0
    v_lshlrev_b32 v2, 1, v1
    s_waitcnt lgkmcnt(0)
    s_mov_b32 s8, s16
    s_mov_b32 s9, s17
    s_and_b32 s9, s9, 0xffff
    s_mov_b32 s10, 0x500
    s_mov_b32 s11, 0x00020000
    s_mov_b32 s12, s18
    s_mov_b32 s13, s19
    s_and_b32 s13, s13, 0xffff
    s_mov_b32 s14, 0x500
    s_mov_b32 s15, 0x00020000
    s_mov_b32 s24, s4
    s_mov_b32 s25, s5
    s_and_b32 s25, s25, 0xffff
    s_mov_b32 s26, 0x500
    s_mov_b32 s27, 0x00020000
    s_add_u32 s36, s6, 0x640000
    s_addc_u32 s37, s7, 0
    s_and_b32 s37, s37, 0xffff
    s_mov_b32 s38, 0x32000
    s_mov_b32 s39, 0x00020000
    buffer_load_ushort v3, v2, s[8:11], 0 offen
    buffer_load_ushort v4, v2, s[12:15], 0 offen
    buffer_load_ushort v5, v2, s[24:27], 0 offen
    s_mov_b32 s30, 0x3fb8aa3b
    s_mov_b32 s31, 0x32a57060
    s_mov_b32 s32, 0x3f317218
    s_mov_b32 s33, 0x3e22f983
    s_mov_b32 s34, 0x31dc9c88
    s_waitcnt vmcnt(0)
    v_lshlrev_b32 v3, 16, v3
    v_lshlrev_b32 v4, 16, v4
    v_lshlrev_b32 v5, 16, v5
    v_mul_f32 v7, s30, v5
    v_fma_f32 v8, v5, s30, -v7
    v_fma_f32 v8, v5, s31, v8
    v_exp_f32 v6, v7
    v_mul_f32 v8, s32, v8
    v_fma_f32 v6, v6, v8, v6
    v_cvt_pk_bf16_f32 v6, v6, v6
    v_lshlrev_b32 v6, 16, v6
    v_mul_f32 v7, v6, v3
    v_mul_f32 v8, v6, v4
    v_mul_f32 v10, s30, v7
    v_fma_f32 v11, v7, s30, -v10
    v_fma_f32 v11, v7, s31, v11
    v_exp_f32 v9, v10
    v_mul_f32 v11, s32, v11
    v_fma_f32 v9, v9, v11, v9
    v_mul_f32 v10, s33, v8
    v_fma_f32 v11, v8, s33, -v10
    v_fma_f32 v11, v8, s34, v11
    v_fract_f32 v10, v10
    v_add_f32 v10, v10, v11
    v_cos_f32 v12, v10
    v_sin_f32 v13, v10
    s_nop 0
    v_mul_f32 v18, v9, v12
    v_mul_f32 v19, v9, v13
    v_add_f32 v10, -1.0, v18
    v_mul_f32 v11, v3, v3
    v_fma_f32 v11, v4, v4, v11
    v_rcp_f32 v12, v11
    v_mul_f32 v13, v10, v3
    v_fma_f32 v13, v19, v4, v13
    v_mul_f32 v14, v19, v3
    v_fma_f32 v14, -v10, v4, v14
    v_mul_f32 v16, v13, v12
    v_fma_f32 v15, -v16, v11, v13
    v_fma_f32 v16, v15, v12, v16
    v_mul_f32 v17, v14, v12
    v_fma_f32 v15, -v17, v11, v14
    v_fma_f32 v17, v15, v12, v17
    v_mul_f32 v20, v18, v18
    v_fma_f32 v20, -v19, v19, v20
    v_mul_f32 v21, v18, v19
    v_fma_f32 v21, v19, v18, v21
    v_mul_f32 v22, v20, v18
    v_fma_f32 v22, -v21, v19, v22
    v_mul_f32 v23, v20, v19
    v_fma_f32 v23, v21, v18, v23
    v_mul_f32 v24, v20, v20
    v_fma_f32 v24, -v21, v21, v24
    v_mul_f32 v25, v20, v21
    v_fma_f32 v25, v21, v20, v25
    v_mul_f32 v28, v24, v24
    v_fma_f32 v28, -v25, v25, v28
    v_mul_f32 v29, v24, v25
    v_fma_f32 v29, v25, v24, v29
    v_mul_f32 v26, v28, v28
    v_fma_f32 v26, -v29, v29, v26
    v_mul_f32 v27, v28, v29
    v_fma_f32 v27, v29, v28, v27
    v_mul_f32 v28, v26, v26
    v_fma_f32 v28, -v27, v27, v28
    v_mul_f32 v29, v26, v27
    v_fma_f32 v29, v27, v26, v29
    v_mul_f32 v30, v28, v28
    v_fma_f32 v30, -v29, v29, v30
    v_mul_f32 v31, v28, v29
    v_fma_f32 v31, v29, v28, v31
    v_mul_f32 v26, v30, v30
    v_fma_f32 v26, -v31, v31, v26
    v_mul_f32 v27, v30, v31
    v_fma_f32 v27, v31, v30, v27
    v_lshlrev_b32 v2, 6, v1
    v_cmp_gt_u32 vcc, 640, v1
    s_and_saveexec_b64 s[40:41], vcc
    s_cbranch_execz K0_END
    v_mov_b32 v40, v16
    v_mov_b32 v41, v17
    v_mov_b32 v42, v18
    v_mov_b32 v43, v20
    v_mov_b32 v44, v22
    v_mov_b32 v45, v24
    v_mov_b32 v46, v19
    v_mov_b32 v47, v21
    v_mov_b32 v48, v23
    v_mov_b32 v49, v25
    v_mov_b32 v50, v26
    v_mov_b32 v51, v27
    buffer_store_dwordx4 v[40:43], v2, s[36:39], 0 offen
    buffer_store_dwordx4 v[44:47], v2, s[36:39], 0 offen offset:16
    buffer_store_dwordx4 v[48:51], v2, s[36:39], 0 offen offset:32
    v_lshlrev_b32 v2, 8, v1
    v_add_u32 v2, 40960, v2
    v_mov_b32 v32, 1.0
    v_mov_b32 v33, 0
    v_mov_b32 v34, v24
    v_mov_b32 v35, v25
    buffer_store_dwordx4 v[32:35], v2, s[36:39], 0 offen offset:0
    v_mul_f32 v36, v34, v24
    v_fma_f32 v36, -v35, v25, v36
    v_mul_f32 v37, v34, v25
    v_fma_f32 v37, v35, v24, v37
    v_mul_f32 v38, v36, v24
    v_fma_f32 v38, -v37, v25, v38
    v_mul_f32 v39, v36, v25
    v_fma_f32 v39, v37, v24, v39
    s_nop 1
    buffer_store_dwordx4 v[36:39], v2, s[36:39], 0 offen offset:16
    v_mul_f32 v32, v38, v24
    v_fma_f32 v32, -v39, v25, v32
    v_mul_f32 v33, v38, v25
    v_fma_f32 v33, v39, v24, v33
    v_mul_f32 v34, v32, v24
    v_fma_f32 v34, -v33, v25, v34
    v_mul_f32 v35, v32, v25
    v_fma_f32 v35, v33, v24, v35
    s_nop 1
    buffer_store_dwordx4 v[32:35], v2, s[36:39], 0 offen offset:32
    v_mul_f32 v36, v34, v24
    v_fma_f32 v36, -v35, v25, v36
    v_mul_f32 v37, v34, v25
    v_fma_f32 v37, v35, v24, v37
    v_mul_f32 v38, v36, v24
    v_fma_f32 v38, -v37, v25, v38
    v_mul_f32 v39, v36, v25
    v_fma_f32 v39, v37, v24, v39
    s_nop 1
    buffer_store_dwordx4 v[36:39], v2, s[36:39], 0 offen offset:48
    v_mul_f32 v32, v38, v24
    v_fma_f32 v32, -v39, v25, v32
    v_mul_f32 v33, v38, v25
    v_fma_f32 v33, v39, v24, v33
    v_mul_f32 v34, v32, v24
    v_fma_f32 v34, -v33, v25, v34
    v_mul_f32 v35, v32, v25
    v_fma_f32 v35, v33, v24, v35
    s_nop 1
    buffer_store_dwordx4 v[32:35], v2, s[36:39], 0 offen offset:64
    v_mul_f32 v36, v34, v24
    v_fma_f32 v36, -v35, v25, v36
    v_mul_f32 v37, v34, v25
    v_fma_f32 v37, v35, v24, v37
    v_mul_f32 v38, v36, v24
    v_fma_f32 v38, -v37, v25, v38
    v_mul_f32 v39, v36, v25
    v_fma_f32 v39, v37, v24, v39
    s_nop 1
    buffer_store_dwordx4 v[36:39], v2, s[36:39], 0 offen offset:80
    v_mul_f32 v32, v38, v24
    v_fma_f32 v32, -v39, v25, v32
    v_mul_f32 v33, v38, v25
    v_fma_f32 v33, v39, v24, v33
    v_mul_f32 v34, v32, v24
    v_fma_f32 v34, -v33, v25, v34
    v_mul_f32 v35, v32, v25
    v_fma_f32 v35, v33, v24, v35
    s_nop 1
    buffer_store_dwordx4 v[32:35], v2, s[36:39], 0 offen offset:96
    v_mul_f32 v36, v34, v24
    v_fma_f32 v36, -v35, v25, v36
    v_mul_f32 v37, v34, v25
    v_fma_f32 v37, v35, v24, v37
    v_mul_f32 v38, v36, v24
    v_fma_f32 v38, -v37, v25, v38
    v_mul_f32 v39, v36, v25
    v_fma_f32 v39, v37, v24, v39
    s_nop 1
    buffer_store_dwordx4 v[36:39], v2, s[36:39], 0 offen offset:112
    v_mul_f32 v32, v38, v24
    v_fma_f32 v32, -v39, v25, v32
    v_mul_f32 v33, v38, v25
    v_fma_f32 v33, v39, v24, v33
    v_mul_f32 v34, v32, v24
    v_fma_f32 v34, -v33, v25, v34
    v_mul_f32 v35, v32, v25
    v_fma_f32 v35, v33, v24, v35
    s_nop 1
    buffer_store_dwordx4 v[32:35], v2, s[36:39], 0 offen offset:128
    v_mul_f32 v36, v34, v24
    v_fma_f32 v36, -v35, v25, v36
    v_mul_f32 v37, v34, v25
    v_fma_f32 v37, v35, v24, v37
    v_mul_f32 v38, v36, v24
    v_fma_f32 v38, -v37, v25, v38
    v_mul_f32 v39, v36, v25
    v_fma_f32 v39, v37, v24, v39
    s_nop 1
    buffer_store_dwordx4 v[36:39], v2, s[36:39], 0 offen offset:144
    v_mul_f32 v32, v38, v24
    v_fma_f32 v32, -v39, v25, v32
    v_mul_f32 v33, v38, v25
    v_fma_f32 v33, v39, v24, v33
    v_mul_f32 v34, v32, v24
    v_fma_f32 v34, -v33, v25, v34
    v_mul_f32 v35, v32, v25
    v_fma_f32 v35, v33, v24, v35
    s_nop 1
    buffer_store_dwordx4 v[32:35], v2, s[36:39], 0 offen offset:160
    v_mul_f32 v36, v34, v24
    v_fma_f32 v36, -v35, v25, v36
    v_mul_f32 v37, v34, v25
    v_fma_f32 v37, v35, v24, v37
    v_mul_f32 v38, v36, v24
    v_fma_f32 v38, -v37, v25, v38
    v_mul_f32 v39, v36, v25
    v_fma_f32 v39, v37, v24, v39
    s_nop 1
    buffer_store_dwordx4 v[36:39], v2, s[36:39], 0 offen offset:176
    v_mul_f32 v32, v38, v24
    v_fma_f32 v32, -v39, v25, v32
    v_mul_f32 v33, v38, v25
    v_fma_f32 v33, v39, v24, v33
    v_mul_f32 v34, v32, v24
    v_fma_f32 v34, -v33, v25, v34
    v_mul_f32 v35, v32, v25
    v_fma_f32 v35, v33, v24, v35
    s_nop 1
    buffer_store_dwordx4 v[32:35], v2, s[36:39], 0 offen offset:192
    v_mul_f32 v36, v34, v24
    v_fma_f32 v36, -v35, v25, v36
    v_mul_f32 v37, v34, v25
    v_fma_f32 v37, v35, v24, v37
    v_mul_f32 v38, v36, v24
    v_fma_f32 v38, -v37, v25, v38
    v_mul_f32 v39, v36, v25
    v_fma_f32 v39, v37, v24, v39
    s_nop 1
    buffer_store_dwordx4 v[36:39], v2, s[36:39], 0 offen offset:208
    v_mul_f32 v32, v38, v24
    v_fma_f32 v32, -v39, v25, v32
    v_mul_f32 v33, v38, v25
    v_fma_f32 v33, v39, v24, v33
    v_mul_f32 v34, v32, v24
    v_fma_f32 v34, -v33, v25, v34
    v_mul_f32 v35, v32, v25
    v_fma_f32 v35, v33, v24, v35
    s_nop 1
    buffer_store_dwordx4 v[32:35], v2, s[36:39], 0 offen offset:224
    v_mul_f32 v36, v34, v24
    v_fma_f32 v36, -v35, v25, v36
    v_mul_f32 v37, v34, v25
    v_fma_f32 v37, v35, v24, v37
    v_mul_f32 v38, v36, v24
    v_fma_f32 v38, -v37, v25, v38
    v_mul_f32 v39, v36, v25
    v_fma_f32 v39, v37, v24, v39
    s_nop 1
    buffer_store_dwordx4 v[36:39], v2, s[36:39], 0 offen offset:240
    s_endpgm
K0_ZERO:
    s_sub_u32 s3, s2, 231
    s_lshl_b32 s3, s3, 8
    v_add_u32 v1, s3, v0
    v_lshlrev_b32 v1, 4, v1
    v_mov_b32 v4, 0
    v_mov_b32 v5, 0
    v_mov_b32 v6, 0
    v_mov_b32 v7, 0
    s_waitcnt lgkmcnt(0)
    s_add_u32 s8, s6, 0x1600000
    s_addc_u32 s9, s7, 0
    s_and_b32 s9, s9, 0xffff
    s_mov_b32 s10, 0x28000
    s_mov_b32 s11, 0x00020000
    s_mov_b32 s3, 0
    buffer_store_dwordx4 v[4:7], v1, s[8:11], s3 offen
    s_mov_b32 s3, 40960
    buffer_store_dwordx4 v[4:7], v1, s[8:11], s3 offen
    s_mov_b32 s3, 81920
    buffer_store_dwordx4 v[4:7], v1, s[8:11], s3 offen
    s_mov_b32 s3, 122880
    buffer_store_dwordx4 v[4:7], v1, s[8:11], s3 offen
K0_END:
    s_endpgm
.globl k1_kernel
.p2align 8
.type k1_kernel,@function
k1_kernel:
    s_cmp_ge_u32 s2, 256
    s_cbranch_scc1 K1_END
    s_load_dwordx2 s[6:7], s[0:1], 112
    s_load_dwordx2 s[84:85], s[0:1], 88
    s_load_dwordx4 s[88:91], s[0:1], 40
    v_lshrrev_b32 v1, 6, v0
    v_and_b32 v4, 63, v0
    s_nop 0
    v_readfirstlane_b32 s28, v1
    s_and_b32 s3, s2, 7
    s_lshr_b32 s4, s2, 3
    s_and_b32 s29, s3, 1
    s_lshl_b32 s29, s29, 3
    s_and_b32 s5, s4, 7
    s_add_u32 s29, s29, s5
    s_lshr_b32 s48, s4, 3
    s_and_b32 s5, s3, 6
    s_and_b32 s49, s48, 1
    s_add_u32 s49, s49, s5
    v_and_b32 v5, 15, v4
    v_lshrrev_b32 v6, 4, v4
    v_lshlrev_b32 v1, 4, v4
    s_lshl_b32 s32, s28, 10
    s_lshl_b32 s33, s29, 3
    s_lshl_b32 s3, s28, 1
    s_add_u32 s45, s33, s3
    s_mul_i32 s33, s45, 20480
    s_add_u32 s34, s33, 20480
    s_lshl_b32 s54, s28, 12
    s_add_u32 s54, s54, 24576
    v_add_u32 v7, s54, v1
    s_mul_i32 s30, s49, 3
    s_mul_i32 s46, s49, 5
    s_lshl_b32 s3, s49, 1
    s_add_u32 s3, s3, 24
    s_mul_i32 s4, s49, 7
    s_add_u32 s4, s4, 40
    s_cmp_ge_u32 s48, 2
    s_cselect_b32 s30, s3, s30
    s_cselect_b32 s46, s4, s46
    s_and_b32 s3, s28, 1
    s_lshl_b32 s3, s3, 10
    s_lshr_b32 s4, s28, 1
    s_mul_i32 s31, s30, 20480
    s_add_u32 s31, s31, s3
    s_mul_i32 s5, s4, 819200
    s_add_u32 s31, s31, s5
    s_add_u32 s31, s31, 18350080
    s_add_u32 s47, s46, s4
    s_mul_i32 s47, s47, 20480
    s_add_u32 s47, s47, s3
    s_add_u32 s47, s47, 2621440
    s_waitcnt lgkmcnt(0)
    s_mov_b32 s8, s6
    s_mov_b32 s9, s7
    s_and_b32 s9, s9, 0xffff
    s_mov_b32 s10, 0x280000
    s_mov_b32 s11, 0x00020000
    s_mov_b32 s12, s6
    s_mov_b32 s13, s7
    s_and_b32 s13, s13, 0xffff
    s_mov_b32 s14, 0x14a0000
    s_mov_b32 s15, 0x00020000
    s_add_u32 s16, s6, 0x640000
    s_addc_u32 s17, s7, 0
    s_and_b32 s17, s17, 0xffff
    s_mov_b32 s18, 0x32000
    s_mov_b32 s19, 0x00020000
    s_add_u32 s20, s6, 0x1600000
    s_addc_u32 s21, s7, 0
    s_and_b32 s21, s21, 0xffff
    s_mov_b32 s22, 0x28000
    s_mov_b32 s23, 0x00020000
    s_add_u32 s24, s6, 0x680000
    s_addc_u32 s25, s7, 0
    s_and_b32 s25, s25, 0xffff
    s_mov_b32 s26, 0x500000
    s_mov_b32 s27, 0x00020000
    s_add_u32 s56, s6, 0xb80000
    s_addc_u32 s57, s7, 0
    s_and_b32 s57, s57, 0xffff
    s_mov_b32 s58, 0x600000
    s_mov_b32 s59, 0x00020000
    s_mov_b32 s76, s84
    s_mov_b32 s77, s85
    s_and_b32 s77, s77, 0xffff
    s_mov_b32 s78, 0x1e0000
    s_mov_b32 s79, 0x00020000
    s_mov_b32 s80, s88
    s_mov_b32 s81, s89
    s_and_b32 s81, s81, 0xffff
    s_mov_b32 s82, 0xc8000
    s_mov_b32 s83, 0x00020000
    s_mov_b32 s84, s90
    s_mov_b32 s85, s91
    s_and_b32 s85, s85, 0xffff
    s_mov_b32 s86, 0xc8000
    s_mov_b32 s87, 0x00020000
    s_mul_hi_u32 s68, s2, 0x1999999a
    s_mul_i32 s69, s68, 10
    s_sub_u32 s69, s2, s69
    s_cmp_ge_u32 s48, 2
    s_cbranch_scc1 K1_TYPEB
    s_lshl_b32 s3, s30, 10
    s_cmp_ge_u32 s28, 3
    s_cbranch_scc1 K1_NOCA
    s_add_u32 s35, s3, s32
    s_add_u32 m0, s32, 122880
    s_nop 0
    buffer_load_dwordx4 v1, s[16:19], s35 offen lds
K1_NOCA:
    s_lshl_b32 s3, s30, 12
    s_add_u32 s3, s3, 40960
    s_add_u32 s3, s3, s32
    s_add_u32 m0, s32, 125952
    s_add_u32 s35, s3, 0
    buffer_load_dwordx4 v1, s[16:19], s35 offen lds
    s_add_u32 m0, s32, 130048
    s_add_u32 s35, s3, 4096
    buffer_load_dwordx4 v1, s[16:19], s35 offen lds
    s_add_u32 m0, s32, 134144
    s_add_u32 s35, s3, 8192
    buffer_load_dwordx4 v1, s[16:19], s35 offen lds
    s_mov_b32 s53, 0
    s_mov_b32 s50, 0
    s_add_u32 m0, s50, s32
    s_add_u32 m0, m0, 0
    s_add_u32 s35, s31, 0
    s_add_u32 s35, s35, s53
    buffer_load_dwordx4 v1, s[12:15], s35 offen lds
    s_add_u32 m0, s50, s32
    s_add_u32 m0, m0, 4096
    s_add_u32 s35, s31, 20480
    s_add_u32 s35, s35, s53
    buffer_load_dwordx4 v1, s[12:15], s35 offen lds
    s_add_u32 m0, s50, s32
    s_add_u32 m0, m0, 8192
    s_add_u32 s35, s31, 40960
    s_add_u32 s35, s35, s53
    buffer_load_dwordx4 v1, s[12:15], s35 offen lds
    s_add_u32 m0, s50, s32
    s_add_u32 m0, m0, 12288
    s_add_u32 s35, s47, 0
    s_add_u32 s35, s35, s53
    buffer_load_dwordx4 v1, s[12:15], s35 offen lds
    s_add_u32 m0, s50, s32
    s_add_u32 m0, m0, 16384
    s_add_u32 s35, s47, 40960
    s_add_u32 s35, s35, s53
    buffer_load_dwordx4 v1, s[12:15], s35 offen lds
    s_cmp_ge_u32 s28, 2
    s_cbranch_scc1 K1_SKA_12605
    s_add_u32 m0, s50, s32
    s_add_u32 m0, m0, 20480
    s_add_u32 s35, s47, 81920
    s_add_u32 s35, s35, s53
    buffer_load_dwordx4 v1, s[12:15], s35 offen lds
K1_SKA_12605:
    s_add_u32 m0, s50, s54
    s_add_u32 m0, m0, 0
    s_add_u32 s35, s33, 0
    s_add_u32 s35, s35, s53
    buffer_load_dwordx4 v1, s[8:11], s35 offen lds
    s_add_u32 m0, s50, s54
    s_add_u32 m0, m0, 1024
    s_add_u32 s35, s33, 1024
    s_add_u32 s35, s35, s53
    buffer_load_dwordx4 v1, s[8:11], s35 offen lds
    s_add_u32 m0, s50, s54
    s_add_u32 m0, m0, 2048
    s_add_u32 s35, s34, 0
    s_add_u32 s35, s35, s53
    buffer_load_dwordx4 v1, s[8:11], s35 offen lds
    s_add_u32 m0, s50, s54
    s_add_u32 m0, m0, 3072
    s_add_u32 s35, s34, 1024
    s_add_u32 s35, s35, s53
    buffer_load_dwordx4 v1, s[8:11], s35 offen lds
    s_add_u32 s53, s53, 2048
    s_mov_b32 s50, 40960
    s_add_u32 m0, s50, s32
    s_add_u32 m0, m0, 0
    s_add_u32 s35, s31, 0
    s_add_u32 s35, s35, s53
    buffer_load_dwordx4 v1, s[12:15], s35 offen lds
    s_add_u32 m0, s50, s32
    s_add_u32 m0, m0, 4096
    s_add_u32 s35, s31, 20480
    s_add_u32 s35, s35, s53
    buffer_load_dwordx4 v1, s[12:15], s35 offen lds
    s_add_u32 m0, s50, s32
    s_add_u32 m0, m0, 8192
    s_add_u32 s35, s31, 40960
    s_add_u32 s35, s35, s53
    buffer_load_dwordx4 v1, s[12:15], s35 offen lds
    s_add_u32 m0, s50, s32
    s_add_u32 m0, m0, 12288
    s_add_u32 s35, s47, 0
    s_add_u32 s35, s35, s53
    buffer_load_dwordx4 v1, s[12:15], s35 offen lds
    s_add_u32 m0, s50, s32
    s_add_u32 m0, m0, 16384
    s_add_u32 s35, s47, 40960
    s_add_u32 s35, s35, s53
    buffer_load_dwordx4 v1, s[12:15], s35 offen lds
    s_cmp_ge_u32 s28, 2
    s_cbranch_scc1 K1_SKA_18112
    s_add_u32 m0, s50, s32
    s_add_u32 m0, m0, 20480
    s_add_u32 s35, s47, 81920
    s_add_u32 s35, s35, s53
    buffer_load_dwordx4 v1, s[12:15], s35 offen lds
K1_SKA_18112:
    s_add_u32 m0, s50, s54
    s_add_u32 m0, m0, 0
    s_add_u32 s35, s33, 0
    s_add_u32 s35, s35, s53
    buffer_load_dwordx4 v1, s[8:11], s35 offen lds
    s_add_u32 m0, s50, s54
    s_add_u32 m0, m0, 1024
    s_add_u32 s35, s33, 1024
    s_add_u32 s35, s35, s53
    buffer_load_dwordx4 v1, s[8:11], s35 offen lds
    s_add_u32 m0, s50, s54
    s_add_u32 m0, m0, 2048
    s_add_u32 s35, s34, 0
    s_add_u32 s35, s35, s53
    buffer_load_dwordx4 v1, s[8:11], s35 offen lds
    s_add_u32 m0, s50, s54
    s_add_u32 m0, m0, 3072
    s_add_u32 s35, s34, 1024
    s_add_u32 s35, s35, s53
    buffer_load_dwordx4 v1, s[8:11], s35 offen lds
    s_add_u32 s53, s53, 2048
    s_mov_b32 s50, 81920
    s_add_u32 m0, s50, s32
    s_add_u32 m0, m0, 0
    s_add_u32 s35, s31, 0
    s_add_u32 s35, s35, s53
    buffer_load_dwordx4 v1, s[12:15], s35 offen lds
    s_add_u32 m0, s50, s32
    s_add_u32 m0, m0, 4096
    s_add_u32 s35, s31, 20480
    s_add_u32 s35, s35, s53
    buffer_load_dwordx4 v1, s[12:15], s35 offen lds
    s_add_u32 m0, s50, s32
    s_add_u32 m0, m0, 8192
    s_add_u32 s35, s31, 40960
    s_add_u32 s35, s35, s53
    buffer_load_dwordx4 v1, s[12:15], s35 offen lds
    s_add_u32 m0, s50, s32
    s_add_u32 m0, m0, 12288
    s_add_u32 s35, s47, 0
    s_add_u32 s35, s35, s53
    buffer_load_dwordx4 v1, s[12:15], s35 offen lds
    s_add_u32 m0, s50, s32
    s_add_u32 m0, m0, 16384
    s_add_u32 s35, s47, 40960
    s_add_u32 s35, s35, s53
    buffer_load_dwordx4 v1, s[12:15], s35 offen lds
    s_cmp_ge_u32 s28, 2
    s_cbranch_scc1 K1_SKA_23619
    s_add_u32 m0, s50, s32
    s_add_u32 m0, m0, 20480
    s_add_u32 s35, s47, 81920
    s_add_u32 s35, s35, s53
    buffer_load_dwordx4 v1, s[12:15], s35 offen lds
K1_SKA_23619:
    s_add_u32 m0, s50, s54
    s_add_u32 m0, m0, 0
    s_add_u32 s35, s33, 0
    s_add_u32 s35, s35, s53
    buffer_load_dwordx4 v1, s[8:11], s35 offen lds
    s_add_u32 m0, s50, s54
    s_add_u32 m0, m0, 1024
    s_add_u32 s35, s33, 1024
    s_add_u32 s35, s35, s53
    buffer_load_dwordx4 v1, s[8:11], s35 offen lds
    s_add_u32 m0, s50, s54
    s_add_u32 m0, m0, 2048
    s_add_u32 s35, s34, 0
    s_add_u32 s35, s35, s53
    buffer_load_dwordx4 v1, s[8:11], s35 offen lds
    s_add_u32 m0, s50, s54
    s_add_u32 m0, m0, 3072
    s_add_u32 s35, s34, 1024
    s_add_u32 s35, s35, s53
    buffer_load_dwordx4 v1, s[8:11], s35 offen lds
    s_add_u32 s53, s53, 2048
    s_mov_b32 s50, 0
    s_mov_b32 s51, 40960
    v_add_u32 v2, s50, v1
    v_add_u32 v3, s50, v7
    v_add_u32 v8, s51, v1
    v_add_u32 v9, s51, v7
    v_mov_b32 v12, 0
    v_mov_b32 v13, 0
    v_mov_b32 v14, 0
    v_mov_b32 v15, 0
    v_mov_b32 v16, 0
    v_mov_b32 v17, 0
    v_mov_b32 v18, 0
    v_mov_b32 v19, 0
    v_mov_b32 v20, 0
    v_mov_b32 v21, 0
    v_mov_b32 v22, 0
    v_mov_b32 v23, 0
    v_mov_b32 v24, 0
    v_mov_b32 v25, 0
    v_mov_b32 v26, 0
    v_mov_b32 v27, 0
    v_mov_b32 v28, 0
    v_mov_b32 v29, 0
    v_mov_b32 v30, 0
    v_mov_b32 v31, 0
    v_mov_b32 v32, 0
    v_mov_b32 v33, 0
    v_mov_b32 v34, 0
    v_mov_b32 v35, 0
    v_mov_b32 v36, 0
    v_mov_b32 v37, 0
    v_mov_b32 v38, 0
    v_mov_b32 v39, 0
    v_mov_b32 v40, 0
    v_mov_b32 v41, 0
    v_mov_b32 v42, 0
    v_mov_b32 v43, 0
    v_mov_b32 v44, 0
    v_mov_b32 v45, 0
    v_mov_b32 v46, 0
    v_mov_b32 v47, 0
    v_mov_b32 v48, 0
    v_mov_b32 v49, 0
    v_mov_b32 v50, 0
    v_mov_b32 v51, 0
    v_mov_b32 v52, 0
    v_mov_b32 v53, 0
    v_mov_b32 v54, 0
    v_mov_b32 v55, 0
    v_mov_b32 v56, 0
    v_mov_b32 v57, 0
    v_mov_b32 v58, 0
    v_mov_b32 v59, 0
    v_mov_b32 v60, 0
    v_mov_b32 v61, 0
    v_mov_b32 v62, 0
    v_mov_b32 v63, 0
    v_mov_b32 v64, 0
    v_mov_b32 v65, 0
    v_mov_b32 v66, 0
    v_mov_b32 v67, 0
    v_mov_b32 v68, 0
    v_mov_b32 v69, 0
    v_mov_b32 v70, 0
    v_mov_b32 v71, 0
    v_mov_b32 v72, 0
    v_mov_b32 v73, 0
    v_mov_b32 v74, 0
    v_mov_b32 v75, 0
    v_mov_b32 v76, 0
    v_mov_b32 v77, 0
    v_mov_b32 v78, 0
    v_mov_b32 v79, 0
    v_mov_b32 v80, 0
    v_mov_b32 v81, 0
    v_mov_b32 v82, 0
    v_mov_b32 v83, 0
    v_mov_b32 v84, 0
    v_mov_b32 v85, 0
    v_mov_b32 v86, 0
    v_mov_b32 v87, 0
    v_mov_b32 v88, 0
    v_mov_b32 v89, 0
    v_mov_b32 v90, 0
    v_mov_b32 v91, 0
    v_mov_b32 v92, 0
    v_mov_b32 v93, 0
    v_mov_b32 v94, 0
    v_mov_b32 v95, 0
    v_mov_b32 v96, 0
    v_mov_b32 v97, 0
    v_mov_b32 v98, 0
    v_mov_b32 v99, 0
    s_waitcnt vmcnt(18)
    s_barrier
    ds_read_b128 v[204:207], v3 offset:0
    ds_read_b128 v[208:211], v3 offset:2048
    ds_read_b128 v[108:111], v2 offset:0
    ds_read_b128 v[112:115], v2 offset:2048
    ds_read_b128 v[116:119], v2 offset:4096
    ds_read_b128 v[120:123], v2 offset:6144
    ds_read_b128 v[124:127], v2 offset:8192
    ds_read_b128 v[128:131], v2 offset:10240
    ds_read_b128 v[132:135], v2 offset:12288
    ds_read_b128 v[136:139], v2 offset:14336
    ds_read_b128 v[140:143], v2 offset:16384
    ds_read_b128 v[144:147], v2 offset:18432
    ds_read_b128 v[148:151], v2 offset:20480
    s_mov_b32 s55, 7
K1_LOOPA:
    s_waitcnt lgkmcnt(0)
    v_mfma_f32_16x16x32_bf16 v[12:15], v[204:207], v[108:111], v[12:15]
    ds_read_b128 v[212:215], v3 offset:1024
    v_mfma_f32_16x16x32_bf16 v[56:59], v[208:211], v[108:111], v[56:59]
    ds_read_b128 v[216:219], v3 offset:3072
    v_mfma_f32_16x16x32_bf16 v[16:19], v[204:207], v[112:115], v[16:19]
    ds_read_b128 v[156:159], v2 offset:1024
    v_mfma_f32_16x16x32_bf16 v[60:63], v[208:211], v[112:115], v[60:63]
    ds_read_b128 v[160:163], v2 offset:3072
    v_mfma_f32_16x16x32_bf16 v[20:23], v[204:207], v[116:119], v[20:23]
    ds_read_b128 v[164:167], v2 offset:5120
    v_mfma_f32_16x16x32_bf16 v[64:67], v[208:211], v[116:119], v[64:67]
    ds_read_b128 v[168:171], v2 offset:7168
    v_mfma_f32_16x16x32_bf16 v[24:27], v[204:207], v[120:123], v[24:27]
    ds_read_b128 v[172:175], v2 offset:9216
    v_mfma_f32_16x16x32_bf16 v[68:71], v[208:211], v[120:123], v[68:71]
    ds_read_b128 v[176:179], v2 offset:11264
    v_mfma_f32_16x16x32_bf16 v[28:31], v[204:207], v[124:127], v[28:31]
    ds_read_b128 v[180:183], v2 offset:13312
    v_mfma_f32_16x16x32_bf16 v[72:75], v[208:211], v[124:127], v[72:75]
    ds_read_b128 v[184:187], v2 offset:15360
    v_mfma_f32_16x16x32_bf16 v[32:35], v[204:207], v[128:131], v[32:35]
    ds_read_b128 v[188:191], v2 offset:17408
    v_mfma_f32_16x16x32_bf16 v[76:79], v[208:211], v[128:131], v[76:79]
    ds_read_b128 v[192:195], v2 offset:19456
    v_mfma_f32_16x16x32_bf16 v[36:39], v[132:135], v[204:207], v[36:39]
    ds_read_b128 v[196:199], v2 offset:21504
    v_mfma_f32_16x16x32_bf16 v[80:83], v[132:135], v[208:211], v[80:83]
    v_mfma_f32_16x16x32_bf16 v[40:43], v[136:139], v[204:207], v[40:43]
    v_mfma_f32_16x16x32_bf16 v[84:87], v[136:139], v[208:211], v[84:87]
    v_mfma_f32_16x16x32_bf16 v[44:47], v[140:143], v[204:207], v[44:47]
    v_mfma_f32_16x16x32_bf16 v[88:91], v[140:143], v[208:211], v[88:91]
    v_mfma_f32_16x16x32_bf16 v[48:51], v[144:147], v[204:207], v[48:51]
    v_mfma_f32_16x16x32_bf16 v[92:95], v[144:147], v[208:211], v[92:95]
    v_mfma_f32_16x16x32_bf16 v[52:55], v[148:151], v[204:207], v[52:55]
    v_mfma_f32_16x16x32_bf16 v[96:99], v[148:151], v[208:211], v[96:99]
    s_waitcnt vmcnt(9) lgkmcnt(0)
    s_barrier
    v_mfma_f32_16x16x32_bf16 v[12:15], v[212:215], v[156:159], v[12:15]
    ds_read_b128 v[204:207], v9 offset:0
    v_mfma_f32_16x16x32_bf16 v[56:59], v[216:219], v[156:159], v[56:59]
    ds_read_b128 v[208:211], v9 offset:2048
    v_mfma_f32_16x16x32_bf16 v[16:19], v[212:215], v[160:163], v[16:19]
    ds_read_b128 v[108:111], v8 offset:0
    v_mfma_f32_16x16x32_bf16 v[60:63], v[216:219], v[160:163], v[60:63]
    ds_read_b128 v[112:115], v8 offset:2048
    v_mfma_f32_16x16x32_bf16 v[20:23], v[212:215], v[164:167], v[20:23]
    ds_read_b128 v[116:119], v8 offset:4096
    v_mfma_f32_16x16x32_bf16 v[64:67], v[216:219], v[164:167], v[64:67]
    ds_read_b128 v[120:123], v8 offset:6144
    v_mfma_f32_16x16x32_bf16 v[24:27], v[212:215], v[168:171], v[24:27]
    ds_read_b128 v[124:127], v8 offset:8192
    v_mfma_f32_16x16x32_bf16 v[68:71], v[216:219], v[168:171], v[68:71]
    ds_read_b128 v[128:131], v8 offset:10240
    v_mfma_f32_16x16x32_bf16 v[28:31], v[212:215], v[172:175], v[28:31]
    ds_read_b128 v[132:135], v8 offset:12288
    v_mfma_f32_16x16x32_bf16 v[72:75], v[216:219], v[172:175], v[72:75]
    ds_read_b128 v[136:139], v8 offset:14336
    v_mfma_f32_16x16x32_bf16 v[32:35], v[212:215], v[176:179], v[32:35]
    ds_read_b128 v[140:143], v8 offset:16384
    v_mfma_f32_16x16x32_bf16 v[76:79], v[216:219], v[176:179], v[76:79]
    ds_read_b128 v[144:147], v8 offset:18432
    v_mfma_f32_16x16x32_bf16 v[36:39], v[180:183], v[212:215], v[36:39]
    ds_read_b128 v[148:151], v8 offset:20480
    v_mfma_f32_16x16x32_bf16 v[80:83], v[180:183], v[216:219], v[80:83]
    s_add_u32 m0, s50, s32
    s_add_u32 m0, m0, 0
    s_add_u32 s35, s31, 0
    s_add_u32 s35, s35, s53
    buffer_load_dwordx4 v1, s[12:15], s35 offen lds
    v_mfma_f32_16x16x32_bf16 v[40:43], v[184:187], v[212:215], v[40:43]
    s_add_u32 m0, s50, s32
    s_add_u32 m0, m0, 4096
    s_add_u32 s35, s31, 20480
    s_add_u32 s35, s35, s53
    buffer_load_dwordx4 v1, s[12:15], s35 offen lds
    v_mfma_f32_16x16x32_bf16 v[84:87], v[184:187], v[216:219], v[84:87]
    s_add_u32 m0, s50, s32
    s_add_u32 m0, m0, 8192
    s_add_u32 s35, s31, 40960
    s_add_u32 s35, s35, s53
    buffer_load_dwordx4 v1, s[12:15], s35 offen lds
    v_mfma_f32_16x16x32_bf16 v[44:47], v[188:191], v[212:215], v[44:47]
    s_add_u32 m0, s50, s32
    s_add_u32 m0, m0, 12288
    s_add_u32 s35, s47, 0
    s_add_u32 s35, s35, s53
    buffer_load_dwordx4 v1, s[12:15], s35 offen lds
    v_mfma_f32_16x16x32_bf16 v[88:91], v[188:191], v[216:219], v[88:91]
    s_add_u32 m0, s50, s32
    s_add_u32 m0, m0, 16384
    s_add_u32 s35, s47, 40960
    s_add_u32 s35, s35, s53
    buffer_load_dwordx4 v1, s[12:15], s35 offen lds
    v_mfma_f32_16x16x32_bf16 v[48:51], v[192:195], v[212:215], v[48:51]
    s_cmp_ge_u32 s28, 2
    s_cbranch_scc1 K1_SKA_43926
    s_add_u32 m0, s50, s32
    s_add_u32 m0, m0, 20480
    s_add_u32 s35, s47, 81920
    s_add_u32 s35, s35, s53
    buffer_load_dwordx4 v1, s[12:15], s35 offen lds
K1_SKA_43926:
    v_mfma_f32_16x16x32_bf16 v[92:95], v[192:195], v[216:219], v[92:95]
    s_add_u32 m0, s50, s54
    s_add_u32 m0, m0, 0
    s_add_u32 s35, s33, 0
    s_add_u32 s35, s35, s53
    buffer_load_dwordx4 v1, s[8:11], s35 offen lds
    v_mfma_f32_16x16x32_bf16 v[52:55], v[196:199], v[212:215], v[52:55]
    s_add_u32 m0, s50, s54
    s_add_u32 m0, m0, 1024
    s_add_u32 s35, s33, 1024
    s_add_u32 s35, s35, s53
    buffer_load_dwordx4 v1, s[8:11], s35 offen lds
    v_mfma_f32_16x16x32_bf16 v[96:99], v[196:199], v[216:219], v[96:99]
    s_add_u32 m0, s50, s54
    s_add_u32 m0, m0, 2048
    s_add_u32 s35, s34, 0
    s_add_u32 s35, s35, s53
    buffer_load_dwordx4 v1, s[8:11], s35 offen lds
    s_add_u32 m0, s50, s54
    s_add_u32 m0, m0, 3072
    s_add_u32 s35, s34, 1024
    s_add_u32 s35, s35, s53
    buffer_load_dwordx4 v1, s[8:11], s35 offen lds
    s_mov_b32 s50, s51
    s_add_u32 s51, s51, 40960
    s_cmp_eq_u32 s51, 122880
    s_cselect_b32 s51, 0, s51
    s_add_u32 s53, s53, 2048
    v_add_u32 v2, s50, v1
    v_add_u32 v3, s50, v7
    v_add_u32 v8, s51, v1
    v_add_u32 v9, s51, v7
    s_sub_u32 s55, s55, 1
    s_cmp_lg_u32 s55, 0
    s_cbranch_scc1 K1_LOOPA
    v_lshrrev_b32 v220, 3, v0
    v_and_b32 v221, 7, v0
    s_lshl_b32 s3, s68, 6
    v_add_u32 v220, s3, v220
    v_mul_u32_u24 v220, 1280, v220
    v_lshl_add_u32 v220, v221, 4, v220
    s_lshl_b32 s3, s69, 7
    s_add_u32 s4, s3, 40960
    s_add_u32 m0, s32, 138240
    s_mul_i32 s5, s2, 200
    buffer_load_dwordx4 v220, s[76:79], s3 offen lds
    s_add_u32 m0, s32, 142336
    v_add_u32 v221, s5, v0
    buffer_load_dwordx4 v220, s[76:79], s4 offen lds
    v_lshlrev_b32 v220, 4, v221
    s_add_u32 m0, s32, 146432
    s_nop 0
    buffer_load_dwordx4 v220, s[80:83], 0 offen lds
    s_add_u32 m0, s32, 150528
    s_nop 0
    buffer_load_dwordx4 v220, s[84:87], 0 offen lds
    s_waitcnt lgkmcnt(0)
    v_mfma_f32_16x16x32_bf16 v[12:15], v[204:207], v[108:111], v[12:15]
    ds_read_b128 v[212:215], v3 offset:1024
    v_mfma_f32_16x16x32_bf16 v[56:59], v[208:211], v[108:111], v[56:59]
    ds_read_b128 v[216:219], v3 offset:3072
    v_mfma_f32_16x16x32_bf16 v[16:19], v[204:207], v[112:115], v[16:19]
    ds_read_b128 v[156:159], v2 offset:1024
    v_mfma_f32_16x16x32_bf16 v[60:63], v[208:211], v[112:115], v[60:63]
    ds_read_b128 v[160:163], v2 offset:3072
    v_mfma_f32_16x16x32_bf16 v[20:23], v[204:207], v[116:119], v[20:23]
    ds_read_b128 v[164:167], v2 offset:5120
    v_mfma_f32_16x16x32_bf16 v[64:67], v[208:211], v[116:119], v[64:67]
    ds_read_b128 v[168:171], v2 offset:7168
    v_mfma_f32_16x16x32_bf16 v[24:27], v[204:207], v[120:123], v[24:27]
    ds_read_b128 v[172:175], v2 offset:9216
    v_mfma_f32_16x16x32_bf16 v[68:71], v[208:211], v[120:123], v[68:71]
    ds_read_b128 v[176:179], v2 offset:11264
    v_mfma_f32_16x16x32_bf16 v[28:31], v[204:207], v[124:127], v[28:31]
    ds_read_b128 v[180:183], v2 offset:13312
    v_mfma_f32_16x16x32_bf16 v[72:75], v[208:211], v[124:127], v[72:75]
    ds_read_b128 v[184:187], v2 offset:15360
    v_mfma_f32_16x16x32_bf16 v[32:35], v[204:207], v[128:131], v[32:35]
    ds_read_b128 v[188:191], v2 offset:17408
    v_mfma_f32_16x16x32_bf16 v[76:79], v[208:211], v[128:131], v[76:79]
    ds_read_b128 v[192:195], v2 offset:19456
    v_mfma_f32_16x16x32_bf16 v[36:39], v[132:135], v[204:207], v[36:39]
    ds_read_b128 v[196:199], v2 offset:21504
    v_mfma_f32_16x16x32_bf16 v[80:83], v[132:135], v[208:211], v[80:83]
    v_mfma_f32_16x16x32_bf16 v[40:43], v[136:139], v[204:207], v[40:43]
    v_mfma_f32_16x16x32_bf16 v[84:87], v[136:139], v[208:211], v[84:87]
    v_mfma_f32_16x16x32_bf16 v[44:47], v[140:143], v[204:207], v[44:47]
    v_mfma_f32_16x16x32_bf16 v[88:91], v[140:143], v[208:211], v[88:91]
    v_mfma_f32_16x16x32_bf16 v[48:51], v[144:147], v[204:207], v[48:51]
    v_mfma_f32_16x16x32_bf16 v[92:95], v[144:147], v[208:211], v[92:95]
    v_mfma_f32_16x16x32_bf16 v[52:55], v[148:151], v[204:207], v[52:55]
    v_mfma_f32_16x16x32_bf16 v[96:99], v[148:151], v[208:211], v[96:99]
    s_waitcnt vmcnt(13) lgkmcnt(0)
    s_barrier
    v_mfma_f32_16x16x32_bf16 v[12:15], v[212:215], v[156:159], v[12:15]
    ds_read_b128 v[204:207], v9 offset:0
    v_mfma_f32_16x16x32_bf16 v[56:59], v[216:219], v[156:159], v[56:59]
    ds_read_b128 v[208:211], v9 offset:2048
    v_mfma_f32_16x16x32_bf16 v[16:19], v[212:215], v[160:163], v[16:19]
    ds_read_b128 v[108:111], v8 offset:0
    v_mfma_f32_16x16x32_bf16 v[60:63], v[216:219], v[160:163], v[60:63]
    ds_read_b128 v[112:115], v8 offset:2048
    v_mfma_f32_16x16x32_bf16 v[20:23], v[212:215], v[164:167], v[20:23]
    ds_read_b128 v[116:119], v8 offset:4096
    v_mfma_f32_16x16x32_bf16 v[64:67], v[216:219], v[164:167], v[64:67]
    ds_read_b128 v[120:123], v8 offset:6144
    v_mfma_f32_16x16x32_bf16 v[24:27], v[212:215], v[168:171], v[24:27]
    ds_read_b128 v[124:127], v8 offset:8192
    v_mfma_f32_16x16x32_bf16 v[68:71], v[216:219], v[168:171], v[68:71]
    ds_read_b128 v[128:131], v8 offset:10240
    v_mfma_f32_16x16x32_bf16 v[28:31], v[212:215], v[172:175], v[28:31]
    ds_read_b128 v[132:135], v8 offset:12288
    v_mfma_f32_16x16x32_bf16 v[72:75], v[216:219], v[172:175], v[72:75]
    ds_read_b128 v[136:139], v8 offset:14336
    v_mfma_f32_16x16x32_bf16 v[32:35], v[212:215], v[176:179], v[32:35]
    ds_read_b128 v[140:143], v8 offset:16384
    v_mfma_f32_16x16x32_bf16 v[76:79], v[216:219], v[176:179], v[76:79]
    ds_read_b128 v[144:147], v8 offset:18432
    v_mfma_f32_16x16x32_bf16 v[36:39], v[180:183], v[212:215], v[36:39]
    ds_read_b128 v[148:151], v8 offset:20480
    v_mfma_f32_16x16x32_bf16 v[80:83], v[180:183], v[216:219], v[80:83]
    v_mfma_f32_16x16x32_bf16 v[40:43], v[184:187], v[212:215], v[40:43]
    v_mfma_f32_16x16x32_bf16 v[84:87], v[184:187], v[216:219], v[84:87]
    v_mfma_f32_16x16x32_bf16 v[44:47], v[188:191], v[212:215], v[44:47]
    v_mfma_f32_16x16x32_bf16 v[88:91], v[188:191], v[216:219], v[88:91]
    v_mfma_f32_16x16x32_bf16 v[48:51], v[192:195], v[212:215], v[48:51]
    v_mfma_f32_16x16x32_bf16 v[92:95], v[192:195], v[216:219], v[92:95]
    v_mfma_f32_16x16x32_bf16 v[52:55], v[196:199], v[212:215], v[52:55]
    v_mfma_f32_16x16x32_bf16 v[96:99], v[196:199], v[216:219], v[96:99]
    s_mov_b32 s50, s51
    s_add_u32 s51, s51, 40960
    s_cmp_eq_u32 s51, 122880
    s_cselect_b32 s51, 0, s51
    s_add_u32 s53, s53, 2048
    v_add_u32 v2, s50, v1
    v_add_u32 v3, s50, v7
    v_add_u32 v8, s51, v1
    v_add_u32 v9, s51, v7
    s_waitcnt lgkmcnt(0)
    v_mfma_f32_16x16x32_bf16 v[12:15], v[204:207], v[108:111], v[12:15]
    ds_read_b128 v[212:215], v3 offset:1024
    v_mfma_f32_16x16x32_bf16 v[56:59], v[208:211], v[108:111], v[56:59]
    ds_read_b128 v[216:219], v3 offset:3072
    v_mfma_f32_16x16x32_bf16 v[16:19], v[204:207], v[112:115], v[16:19]
    ds_read_b128 v[156:159], v2 offset:1024
    v_mfma_f32_16x16x32_bf16 v[60:63], v[208:211], v[112:115], v[60:63]
    ds_read_b128 v[160:163], v2 offset:3072
    v_mfma_f32_16x16x32_bf16 v[20:23], v[204:207], v[116:119], v[20:23]
    ds_read_b128 v[164:167], v2 offset:5120
    v_mfma_f32_16x16x32_bf16 v[64:67], v[208:211], v[116:119], v[64:67]
    ds_read_b128 v[168:171], v2 offset:7168
    v_mfma_f32_16x16x32_bf16 v[24:27], v[204:207], v[120:123], v[24:27]
    ds_read_b128 v[172:175], v2 offset:9216
    v_mfma_f32_16x16x32_bf16 v[68:71], v[208:211], v[120:123], v[68:71]
    ds_read_b128 v[176:179], v2 offset:11264
    v_mfma_f32_16x16x32_bf16 v[28:31], v[204:207], v[124:127], v[28:31]
    ds_read_b128 v[180:183], v2 offset:13312
    v_mfma_f32_16x16x32_bf16 v[72:75], v[208:211], v[124:127], v[72:75]
    ds_read_b128 v[184:187], v2 offset:15360
    v_mfma_f32_16x16x32_bf16 v[32:35], v[204:207], v[128:131], v[32:35]
    ds_read_b128 v[188:191], v2 offset:17408
    v_mfma_f32_16x16x32_bf16 v[76:79], v[208:211], v[128:131], v[76:79]
    ds_read_b128 v[192:195], v2 offset:19456
    v_mfma_f32_16x16x32_bf16 v[36:39], v[132:135], v[204:207], v[36:39]
    ds_read_b128 v[196:199], v2 offset:21504
    v_mfma_f32_16x16x32_bf16 v[80:83], v[132:135], v[208:211], v[80:83]
    v_mfma_f32_16x16x32_bf16 v[40:43], v[136:139], v[204:207], v[40:43]
    v_mfma_f32_16x16x32_bf16 v[84:87], v[136:139], v[208:211], v[84:87]
    v_mfma_f32_16x16x32_bf16 v[44:47], v[140:143], v[204:207], v[44:47]
    v_mfma_f32_16x16x32_bf16 v[88:91], v[140:143], v[208:211], v[88:91]
    v_mfma_f32_16x16x32_bf16 v[48:51], v[144:147], v[204:207], v[48:51]
    v_mfma_f32_16x16x32_bf16 v[92:95], v[144:147], v[208:211], v[92:95]
    v_mfma_f32_16x16x32_bf16 v[52:55], v[148:151], v[204:207], v[52:55]
    v_mfma_f32_16x16x32_bf16 v[96:99], v[148:151], v[208:211], v[96:99]
    s_waitcnt vmcnt(4) lgkmcnt(0)
    s_barrier
    v_mfma_f32_16x16x32_bf16 v[12:15], v[212:215], v[156:159], v[12:15]
    ds_read_b128 v[204:207], v9 offset:0
    v_mfma_f32_16x16x32_bf16 v[56:59], v[216:219], v[156:159], v[56:59]
    ds_read_b128 v[208:211], v9 offset:2048
    v_mfma_f32_16x16x32_bf16 v[16:19], v[212:215], v[160:163], v[16:19]
    ds_read_b128 v[108:111], v8 offset:0
    v_mfma_f32_16x16x32_bf16 v[60:63], v[216:219], v[160:163], v[60:63]
    ds_read_b128 v[112:115], v8 offset:2048
    v_mfma_f32_16x16x32_bf16 v[20:23], v[212:215], v[164:167], v[20:23]
    ds_read_b128 v[116:119], v8 offset:4096
    v_mfma_f32_16x16x32_bf16 v[64:67], v[216:219], v[164:167], v[64:67]
    ds_read_b128 v[120:123], v8 offset:6144
    v_mfma_f32_16x16x32_bf16 v[24:27], v[212:215], v[168:171], v[24:27]
    ds_read_b128 v[124:127], v8 offset:8192
    v_mfma_f32_16x16x32_bf16 v[68:71], v[216:219], v[168:171], v[68:71]
    ds_read_b128 v[128:131], v8 offset:10240
    v_mfma_f32_16x16x32_bf16 v[28:31], v[212:215], v[172:175], v[28:31]
    ds_read_b128 v[132:135], v8 offset:12288
    v_mfma_f32_16x16x32_bf16 v[72:75], v[216:219], v[172:175], v[72:75]
    ds_read_b128 v[136:139], v8 offset:14336
    v_mfma_f32_16x16x32_bf16 v[32:35], v[212:215], v[176:179], v[32:35]
    ds_read_b128 v[140:143], v8 offset:16384
    v_mfma_f32_16x16x32_bf16 v[76:79], v[216:219], v[176:179], v[76:79]
    ds_read_b128 v[144:147], v8 offset:18432
    v_mfma_f32_16x16x32_bf16 v[36:39], v[180:183], v[212:215], v[36:39]
    ds_read_b128 v[148:151], v8 offset:20480
    v_mfma_f32_16x16x32_bf16 v[80:83], v[180:183], v[216:219], v[80:83]
    v_mfma_f32_16x16x32_bf16 v[40:43], v[184:187], v[212:215], v[40:43]
    v_mfma_f32_16x16x32_bf16 v[84:87], v[184:187], v[216:219], v[84:87]
    v_mfma_f32_16x16x32_bf16 v[44:47], v[188:191], v[212:215], v[44:47]
    v_mfma_f32_16x16x32_bf16 v[88:91], v[188:191], v[216:219], v[88:91]
    v_mfma_f32_16x16x32_bf16 v[48:51], v[192:195], v[212:215], v[48:51]
    v_mfma_f32_16x16x32_bf16 v[92:95], v[192:195], v[216:219], v[92:95]
    v_mfma_f32_16x16x32_bf16 v[52:55], v[196:199], v[212:215], v[52:55]
    v_mfma_f32_16x16x32_bf16 v[96:99], v[196:199], v[216:219], v[96:99]
    s_mov_b32 s50, s51
    s_add_u32 s51, s51, 40960
    s_cmp_eq_u32 s51, 122880
    s_cselect_b32 s51, 0, s51
    s_add_u32 s53, s53, 2048
    v_add_u32 v2, s50, v1
    v_add_u32 v3, s50, v7
    v_add_u32 v8, s51, v1
    v_add_u32 v9, s51, v7
    s_waitcnt lgkmcnt(0)
    v_mfma_f32_16x16x32_bf16 v[12:15], v[204:207], v[108:111], v[12:15]
    ds_read_b128 v[212:215], v3 offset:1024
    v_mfma_f32_16x16x32_bf16 v[56:59], v[208:211], v[108:111], v[56:59]
    ds_read_b128 v[216:219], v3 offset:3072
    v_mfma_f32_16x16x32_bf16 v[16:19], v[204:207], v[112:115], v[16:19]
    ds_read_b128 v[156:159], v2 offset:1024
    v_mfma_f32_16x16x32_bf16 v[60:63], v[208:211], v[112:115], v[60:63]
    ds_read_b128 v[160:163], v2 offset:3072
    v_mfma_f32_16x16x32_bf16 v[20:23], v[204:207], v[116:119], v[20:23]
    ds_read_b128 v[164:167], v2 offset:5120
    v_mfma_f32_16x16x32_bf16 v[64:67], v[208:211], v[116:119], v[64:67]
    ds_read_b128 v[168:171], v2 offset:7168
    v_mfma_f32_16x16x32_bf16 v[24:27], v[204:207], v[120:123], v[24:27]
    ds_read_b128 v[172:175], v2 offset:9216
    v_mfma_f32_16x16x32_bf16 v[68:71], v[208:211], v[120:123], v[68:71]
    ds_read_b128 v[176:179], v2 offset:11264
    v_mfma_f32_16x16x32_bf16 v[28:31], v[204:207], v[124:127], v[28:31]
    ds_read_b128 v[180:183], v2 offset:13312
    v_mfma_f32_16x16x32_bf16 v[72:75], v[208:211], v[124:127], v[72:75]
    ds_read_b128 v[184:187], v2 offset:15360
    v_mfma_f32_16x16x32_bf16 v[32:35], v[204:207], v[128:131], v[32:35]
    ds_read_b128 v[188:191], v2 offset:17408
    v_mfma_f32_16x16x32_bf16 v[76:79], v[208:211], v[128:131], v[76:79]
    ds_read_b128 v[192:195], v2 offset:19456
    v_mfma_f32_16x16x32_bf16 v[36:39], v[132:135], v[204:207], v[36:39]
    ds_read_b128 v[196:199], v2 offset:21504
    v_mfma_f32_16x16x32_bf16 v[80:83], v[132:135], v[208:211], v[80:83]
    v_mfma_f32_16x16x32_bf16 v[40:43], v[136:139], v[204:207], v[40:43]
    v_mfma_f32_16x16x32_bf16 v[84:87], v[136:139], v[208:211], v[84:87]
    v_mfma_f32_16x16x32_bf16 v[44:47], v[140:143], v[204:207], v[44:47]
    v_mfma_f32_16x16x32_bf16 v[88:91], v[140:143], v[208:211], v[88:91]
    v_mfma_f32_16x16x32_bf16 v[48:51], v[144:147], v[204:207], v[48:51]
    v_mfma_f32_16x16x32_bf16 v[92:95], v[144:147], v[208:211], v[92:95]
    v_mfma_f32_16x16x32_bf16 v[52:55], v[148:151], v[204:207], v[52:55]
    v_mfma_f32_16x16x32_bf16 v[96:99], v[148:151], v[208:211], v[96:99]
    s_waitcnt lgkmcnt(0)
    v_mfma_f32_16x16x32_bf16 v[12:15], v[212:215], v[156:159], v[12:15]
    v_mfma_f32_16x16x32_bf16 v[56:59], v[216:219], v[156:159], v[56:59]
    v_mfma_f32_16x16x32_bf16 v[16:19], v[212:215], v[160:163], v[16:19]
    v_mfma_f32_16x16x32_bf16 v[60:63], v[216:219], v[160:163], v[60:63]
    v_mfma_f32_16x16x32_bf16 v[20:23], v[212:215], v[164:167], v[20:23]
    v_mfma_f32_16x16x32_bf16 v[64:67], v[216:219], v[164:167], v[64:67]
    v_mfma_f32_16x16x32_bf16 v[24:27], v[212:215], v[168:171], v[24:27]
    v_mfma_f32_16x16x32_bf16 v[68:71], v[216:219], v[168:171], v[68:71]
    v_mfma_f32_16x16x32_bf16 v[28:31], v[212:215], v[172:175], v[28:31]
    v_mfma_f32_16x16x32_bf16 v[72:75], v[216:219], v[172:175], v[72:75]
    v_mfma_f32_16x16x32_bf16 v[32:35], v[212:215], v[176:179], v[32:35]
    v_mfma_f32_16x16x32_bf16 v[76:79], v[216:219], v[176:179], v[76:79]
    v_mfma_f32_16x16x32_bf16 v[36:39], v[180:183], v[212:215], v[36:39]
    v_mfma_f32_16x16x32_bf16 v[80:83], v[180:183], v[216:219], v[80:83]
    v_mfma_f32_16x16x32_bf16 v[40:43], v[184:187], v[212:215], v[40:43]
    v_mfma_f32_16x16x32_bf16 v[84:87], v[184:187], v[216:219], v[84:87]
    v_mfma_f32_16x16x32_bf16 v[44:47], v[188:191], v[212:215], v[44:47]
    v_mfma_f32_16x16x32_bf16 v[88:91], v[188:191], v[216:219], v[88:91]
    v_mfma_f32_16x16x32_bf16 v[48:51], v[192:195], v[212:215], v[48:51]
    v_mfma_f32_16x16x32_bf16 v[92:95], v[192:195], v[216:219], v[92:95]
    v_mfma_f32_16x16x32_bf16 v[52:55], v[196:199], v[212:215], v[52:55]
    v_mfma_f32_16x16x32_bf16 v[96:99], v[196:199], v[216:219], v[96:99]
    v_lshlrev_b32 v7, 6, v5
    v_add_u32 v7, 122880, v7
    s_lshl_b32 s3, s28, 3
    v_add_u32 v8, s3, v6
    v_mul_u32_u24 v8, 384, v8
    v_lshl_add_u32 v8, v5, 3, v8
    v_add_u32 v9, 1536, v8
    s_nop 7
    ds_read_b128 v[108:111], v7 offset:0
    ds_read_b128 v[112:115], v7 offset:16
    ds_read_b128 v[116:119], v7 offset:32
    ds_read_b128 v[120:123], v7 offset:1024
    ds_read_b128 v[124:127], v7 offset:1040
    ds_read_b128 v[128:131], v7 offset:1056
    ds_read_b128 v[132:135], v7 offset:2048
    ds_read_b128 v[136:139], v7 offset:2064
    ds_read_b128 v[140:143], v7 offset:2080
    s_barrier
    s_waitcnt lgkmcnt(0)
    v_sub_f32 v118, 0, v114
    v_sub_f32 v130, 0, v126
    v_sub_f32 v142, 0, v138
    v_fmac_f32 v13, v110, v12
    v_fmac_f32 v57, v110, v56
    v_fmac_f32 v21, v122, v20
    v_fmac_f32 v65, v122, v64
    v_fmac_f32 v29, v134, v28
    v_fmac_f32 v73, v134, v72
    v_fmac_f32 v17, v110, v16
    v_fmac_f32 v61, v110, v60
    v_fmac_f32 v25, v122, v24
    v_fmac_f32 v69, v122, v68
    v_fmac_f32 v33, v134, v32
    v_fmac_f32 v77, v134, v76
    v_fmac_f32 v13, v118, v16
    v_fmac_f32 v57, v118, v60
    v_fmac_f32 v21, v130, v24
    v_fmac_f32 v65, v130, v68
    v_fmac_f32 v29, v142, v32
    v_fmac_f32 v73, v142, v76
    v_fmac_f32 v17, v114, v12
    v_fmac_f32 v61, v114, v56
    v_fmac_f32 v25, v126, v20
    v_fmac_f32 v69, v126, v64
    v_fmac_f32 v33, v138, v28
    v_fmac_f32 v77, v138, v72
    v_fmac_f32 v14, v110, v13
    v_fmac_f32 v58, v110, v57
    v_fmac_f32 v22, v122, v21
    v_fmac_f32 v66, v122, v65
    v_fmac_f32 v30, v134, v29
    v_fmac_f32 v74, v134, v73
    v_fmac_f32 v18, v110, v17
    v_fmac_f32 v62, v110, v61
    v_fmac_f32 v26, v122, v25
    v_fmac_f32 v70, v122, v69
    v_fmac_f32 v34, v134, v33
    v_fmac_f32 v78, v134, v77
    v_fmac_f32 v14, v118, v17
    v_fmac_f32 v58, v118, v61
    v_fmac_f32 v22, v130, v25
    v_fmac_f32 v66, v130, v69
    v_fmac_f32 v30, v142, v33
    v_fmac_f32 v74, v142, v77
    v_fmac_f32 v18, v114, v13
    v_fmac_f32 v62, v114, v57
    v_fmac_f32 v26, v126, v21
    v_fmac_f32 v70, v126, v65
    v_fmac_f32 v34, v138, v29
    v_fmac_f32 v78, v138, v73
    v_fmac_f32 v15, v110, v14
    v_fmac_f32 v59, v110, v58
    v_fmac_f32 v23, v122, v22
    v_fmac_f32 v67, v122, v66
    v_fmac_f32 v31, v134, v30
    v_fmac_f32 v75, v134, v74
    v_fmac_f32 v19, v110, v18
    v_fmac_f32 v63, v110, v62
    v_fmac_f32 v27, v122, v26
    v_fmac_f32 v71, v122, v70
    v_fmac_f32 v35, v134, v34
    v_fmac_f32 v79, v134, v78
    v_fmac_f32 v15, v118, v18
    v_fmac_f32 v59, v118, v62
    v_fmac_f32 v23, v130, v26
    v_fmac_f32 v67, v130, v70
    v_fmac_f32 v31, v142, v34
    v_fmac_f32 v75, v142, v78
    v_fmac_f32 v19, v114, v14
    v_fmac_f32 v63, v114, v58
    v_fmac_f32 v27, v126, v22
    v_fmac_f32 v71, v126, v66
    v_fmac_f32 v35, v138, v30
    v_fmac_f32 v79, v138, v74
    ds_write2_b32 v8, v15, v19 offset0:0 offset1:1
    ds_write2_b32 v9, v59, v63 offset0:0 offset1:1
    ds_write2_b32 v8, v23, v27 offset0:32 offset1:33
    ds_write2_b32 v9, v67, v71 offset0:32 offset1:33
    ds_write2_b32 v8, v31, v35 offset0:64 offset1:65
    ds_write2_b32 v9, v75, v79 offset0:64 offset1:65
    s_mul_i32 s3, s28, 12
    v_add_u32 v247, s3, v4
    v_lshlrev_b32 v244, 3, v247
    v_lshrrev_b32 v245, 4, v247
    v_lshlrev_b32 v245, 12, v245
    v_and_b32 v246, 15, v247
    v_lshl_add_u32 v245, v246, 4, v245
    v_lshlrev_b32 v247, 6, v247
    v_add_u32 v247, 122880, v247
    s_lshl_b32 s42, s30, 12
    s_lshl_b32 s3, s29, 8
    s_add_u32 s3, s3, s42
    s_waitcnt lgkmcnt(0)
    s_barrier
    s_mov_b64 exec, 0xfff
    ds_read_b32 v236, v247 offset:20
    ds_read_b32 v237, v247 offset:36
    ds_read_b64 v[238:239], v247 offset:40
    ds_read_b64 v[168:169], v244 offset:0
    ds_read_b64 v[170:171], v244 offset:384
    ds_read_b64 v[172:173], v244 offset:768
    ds_read_b64 v[174:175], v244 offset:1152
    ds_read_b64 v[176:177], v244 offset:1536
    ds_read_b64 v[178:179], v244 offset:1920
    ds_read_b64 v[180:181], v244 offset:2304
    ds_read_b64 v[182:183], v244 offset:2688
    ds_read_b64 v[184:185], v244 offset:3072
    ds_read_b64 v[186:187], v244 offset:3456
    ds_read_b64 v[188:189], v244 offset:3840
    ds_read_b64 v[190:191], v244 offset:4224
    ds_read_b64 v[192:193], v244 offset:4608
    ds_read_b64 v[194:195], v244 offset:4992
    ds_read_b64 v[196:197], v244 offset:5376
    ds_read_b64 v[198:199], v244 offset:5760
    ds_read_b64 v[200:201], v244 offset:6144
    ds_read_b64 v[202:203], v244 offset:6528
    ds_read_b64 v[204:205], v244 offset:6912
    ds_read_b64 v[206:207], v244 offset:7296
    ds_read_b64 v[208:209], v244 offset:7680
    ds_read_b64 v[210:211], v244 offset:8064
    ds_read_b64 v[212:213], v244 offset:8448
    ds_read_b64 v[214:215], v244 offset:8832
    ds_read_b64 v[216:217], v244 offset:9216
    ds_read_b64 v[218:219], v244 offset:9600
    ds_read_b64 v[220:221], v244 offset:9984
    ds_read_b64 v[222:223], v244 offset:10368
    ds_read_b64 v[224:225], v244 offset:10752
    ds_read_b64 v[226:227], v244 offset:11136
    ds_read_b64 v[228:229], v244 offset:11520
    ds_read_b64 v[230:231], v244 offset:11904
    v_mov_b32 v234, 0
    v_mov_b32 v235, 0
    ds_write_b64 v244, v[234:235] offset:12288
    v_mov_b32 v241, 1
    v_mov_b32 v243, 1
    s_waitcnt lgkmcnt(1)
    ds_write_b64 v244, v[168:169] offset:12672
    v_pk_fma_f32 v[234:235], v[236:237], v[168:169], v[170:171] op_sel:[0,0,0] op_sel_hi:[0,1,1]
    v_pk_fma_f32 v[234:235], v[236:237], v[168:169], v[234:235] op_sel:[1,1,0] op_sel_hi:[1,0,1] neg_lo:[1,0,0] neg_hi:[0,0,0]
    ds_write_b64 v244, v[234:235] offset:13056
    v_pk_fma_f32 v[232:233], v[236:237], v[234:235], v[172:173] op_sel:[0,0,0] op_sel_hi:[0,1,1]
    v_pk_fma_f32 v[232:233], v[236:237], v[234:235], v[232:233] op_sel:[1,1,0] op_sel_hi:[1,0,1] neg_lo:[1,0,0] neg_hi:[0,0,0]
    ds_write_b64 v244, v[232:233] offset:13440
    v_pk_fma_f32 v[234:235], v[236:237], v[232:233], v[174:175] op_sel:[0,0,0] op_sel_hi:[0,1,1]
    v_pk_fma_f32 v[234:235], v[236:237], v[232:233], v[234:235] op_sel:[1,1,0] op_sel_hi:[1,0,1] neg_lo:[1,0,0] neg_hi:[0,0,0]
    ds_write_b64 v244, v[234:235] offset:13824
    v_pk_fma_f32 v[232:233], v[236:237], v[234:235], v[176:177] op_sel:[0,0,0] op_sel_hi:[0,1,1]
    v_pk_fma_f32 v[232:233], v[236:237], v[234:235], v[232:233] op_sel:[1,1,0] op_sel_hi:[1,0,1] neg_lo:[1,0,0] neg_hi:[0,0,0]
    ds_write_b64 v244, v[232:233] offset:14208
    v_pk_fma_f32 v[234:235], v[236:237], v[232:233], v[178:179] op_sel:[0,0,0] op_sel_hi:[0,1,1]
    v_pk_fma_f32 v[234:235], v[236:237], v[232:233], v[234:235] op_sel:[1,1,0] op_sel_hi:[1,0,1] neg_lo:[1,0,0] neg_hi:[0,0,0]
    ds_write_b64 v244, v[234:235] offset:14592
    v_pk_fma_f32 v[232:233], v[236:237], v[234:235], v[180:181] op_sel:[0,0,0] op_sel_hi:[0,1,1]
    v_pk_fma_f32 v[232:233], v[236:237], v[234:235], v[232:233] op_sel:[1,1,0] op_sel_hi:[1,0,1] neg_lo:[1,0,0] neg_hi:[0,0,0]
    ds_write_b64 v244, v[232:233] offset:14976
    v_pk_fma_f32 v[234:235], v[236:237], v[232:233], v[182:183] op_sel:[0,0,0] op_sel_hi:[0,1,1]
    v_pk_fma_f32 v[234:235], v[236:237], v[232:233], v[234:235] op_sel:[1,1,0] op_sel_hi:[1,0,1] neg_lo:[1,0,0] neg_hi:[0,0,0]
    ds_write_b64 v244, v[234:235] offset:15360
    v_pk_fma_f32 v[232:233], v[236:237], v[234:235], v[184:185] op_sel:[0,0,0] op_sel_hi:[0,1,1]
    v_pk_fma_f32 v[232:233], v[236:237], v[234:235], v[232:233] op_sel:[1,1,0] op_sel_hi:[1,0,1] neg_lo:[1,0,0] neg_hi:[0,0,0]
    ds_write_b64 v244, v[232:233] offset:15744
    v_pk_fma_f32 v[234:235], v[236:237], v[232:233], v[186:187] op_sel:[0,0,0] op_sel_hi:[0,1,1]
    v_pk_fma_f32 v[234:235], v[236:237], v[232:233], v[234:235] op_sel:[1,1,0] op_sel_hi:[1,0,1] neg_lo:[1,0,0] neg_hi:[0,0,0]
    ds_write_b64 v244, v[234:235] offset:16128
    v_pk_fma_f32 v[232:233], v[236:237], v[234:235], v[188:189] op_sel:[0,0,0] op_sel_hi:[0,1,1]
    v_pk_fma_f32 v[232:233], v[236:237], v[234:235], v[232:233] op_sel:[1,1,0] op_sel_hi:[1,0,1] neg_lo:[1,0,0] neg_hi:[0,0,0]
    ds_write_b64 v244, v[232:233] offset:16512
    v_pk_fma_f32 v[234:235], v[236:237], v[232:233], v[190:191] op_sel:[0,0,0] op_sel_hi:[0,1,1]
    v_pk_fma_f32 v[234:235], v[236:237], v[232:233], v[234:235] op_sel:[1,1,0] op_sel_hi:[1,0,1] neg_lo:[1,0,0] neg_hi:[0,0,0]
    ds_write_b64 v244, v[234:235] offset:16896
    v_pk_fma_f32 v[232:233], v[236:237], v[234:235], v[192:193] op_sel:[0,0,0] op_sel_hi:[0,1,1]
    v_pk_fma_f32 v[232:233], v[236:237], v[234:235], v[232:233] op_sel:[1,1,0] op_sel_hi:[1,0,1] neg_lo:[1,0,0] neg_hi:[0,0,0]
    ds_write_b64 v244, v[232:233] offset:17280
    v_pk_fma_f32 v[234:235], v[236:237], v[232:233], v[194:195] op_sel:[0,0,0] op_sel_hi:[0,1,1]
    v_pk_fma_f32 v[234:235], v[236:237], v[232:233], v[234:235] op_sel:[1,1,0] op_sel_hi:[1,0,1] neg_lo:[1,0,0] neg_hi:[0,0,0]
    ds_write_b64 v244, v[234:235] offset:17664
    v_pk_fma_f32 v[232:233], v[236:237], v[234:235], v[196:197] op_sel:[0,0,0] op_sel_hi:[0,1,1]
    v_pk_fma_f32 v[232:233], v[236:237], v[234:235], v[232:233] op_sel:[1,1,0] op_sel_hi:[1,0,1] neg_lo:[1,0,0] neg_hi:[0,0,0]
    ds_write_b64 v244, v[232:233] offset:18048
    v_pk_fma_f32 v[234:235], v[236:237], v[232:233], v[198:199] op_sel:[0,0,0] op_sel_hi:[0,1,1]
    v_pk_fma_f32 v[234:235], v[236:237], v[232:233], v[234:235] op_sel:[1,1,0] op_sel_hi:[1,0,1] neg_lo:[1,0,0] neg_hi:[0,0,0]
    ds_write_b64 v244, v[234:235] offset:18432
    v_pk_fma_f32 v[232:233], v[236:237], v[234:235], v[200:201] op_sel:[0,0,0] op_sel_hi:[0,1,1]
    v_pk_fma_f32 v[232:233], v[236:237], v[234:235], v[232:233] op_sel:[1,1,0] op_sel_hi:[1,0,1] neg_lo:[1,0,0] neg_hi:[0,0,0]
    ds_write_b64 v244, v[232:233] offset:18816
    v_pk_fma_f32 v[234:235], v[236:237], v[232:233], v[202:203] op_sel:[0,0,0] op_sel_hi:[0,1,1]
    v_pk_fma_f32 v[234:235], v[236:237], v[232:233], v[234:235] op_sel:[1,1,0] op_sel_hi:[1,0,1] neg_lo:[1,0,0] neg_hi:[0,0,0]
    ds_write_b64 v244, v[234:235] offset:19200
    v_pk_fma_f32 v[232:233], v[236:237], v[234:235], v[204:205] op_sel:[0,0,0] op_sel_hi:[0,1,1]
    v_pk_fma_f32 v[232:233], v[236:237], v[234:235], v[232:233] op_sel:[1,1,0] op_sel_hi:[1,0,1] neg_lo:[1,0,0] neg_hi:[0,0,0]
    ds_write_b64 v244, v[232:233] offset:19584
    v_pk_fma_f32 v[234:235], v[236:237], v[232:233], v[206:207] op_sel:[0,0,0] op_sel_hi:[0,1,1]
    v_pk_fma_f32 v[234:235], v[236:237], v[232:233], v[234:235] op_sel:[1,1,0] op_sel_hi:[1,0,1] neg_lo:[1,0,0] neg_hi:[0,0,0]
    ds_write_b64 v244, v[234:235] offset:19968
    v_pk_fma_f32 v[232:233], v[236:237], v[234:235], v[208:209] op_sel:[0,0,0] op_sel_hi:[0,1,1]
    v_pk_fma_f32 v[232:233], v[236:237], v[234:235], v[232:233] op_sel:[1,1,0] op_sel_hi:[1,0,1] neg_lo:[1,0,0] neg_hi:[0,0,0]
    ds_write_b64 v244, v[232:233] offset:20352
    v_pk_fma_f32 v[234:235], v[236:237], v[232:233], v[210:211] op_sel:[0,0,0] op_sel_hi:[0,1,1]
    v_pk_fma_f32 v[234:235], v[236:237], v[232:233], v[234:235] op_sel:[1,1,0] op_sel_hi:[1,0,1] neg_lo:[1,0,0] neg_hi:[0,0,0]
    ds_write_b64 v244, v[234:235] offset:20736
    v_pk_fma_f32 v[232:233], v[236:237], v[234:235], v[212:213] op_sel:[0,0,0] op_sel_hi:[0,1,1]
    v_pk_fma_f32 v[232:233], v[236:237], v[234:235], v[232:233] op_sel:[1,1,0] op_sel_hi:[1,0,1] neg_lo:[1,0,0] neg_hi:[0,0,0]
    ds_write_b64 v244, v[232:233] offset:21120
    v_pk_fma_f32 v[234:235], v[236:237], v[232:233], v[214:215] op_sel:[0,0,0] op_sel_hi:[0,1,1]
    v_pk_fma_f32 v[234:235], v[236:237], v[232:233], v[234:235] op_sel:[1,1,0] op_sel_hi:[1,0,1] neg_lo:[1,0,0] neg_hi:[0,0,0]
    ds_write_b64 v244, v[234:235] offset:21504
    v_pk_fma_f32 v[232:233], v[236:237], v[234:235], v[216:217] op_sel:[0,0,0] op_sel_hi:[0,1,1]
    v_pk_fma_f32 v[232:233], v[236:237], v[234:235], v[232:233] op_sel:[1,1,0] op_sel_hi:[1,0,1] neg_lo:[1,0,0] neg_hi:[0,0,0]
    ds_write_b64 v244, v[232:233] offset:21888
    v_pk_fma_f32 v[234:235], v[236:237], v[232:233], v[218:219] op_sel:[0,0,0] op_sel_hi:[0,1,1]
    v_pk_fma_f32 v[234:235], v[236:237], v[232:233], v[234:235] op_sel:[1,1,0] op_sel_hi:[1,0,1] neg_lo:[1,0,0] neg_hi:[0,0,0]
    ds_write_b64 v244, v[234:235] offset:22272
    v_pk_fma_f32 v[232:233], v[236:237], v[234:235], v[220:221] op_sel:[0,0,0] op_sel_hi:[0,1,1]
    v_pk_fma_f32 v[232:233], v[236:237], v[234:235], v[232:233] op_sel:[1,1,0] op_sel_hi:[1,0,1] neg_lo:[1,0,0] neg_hi:[0,0,0]
    ds_write_b64 v244, v[232:233] offset:22656
    v_pk_fma_f32 v[234:235], v[236:237], v[232:233], v[222:223] op_sel:[0,0,0] op_sel_hi:[0,1,1]
    v_pk_fma_f32 v[234:235], v[236:237], v[232:233], v[234:235] op_sel:[1,1,0] op_sel_hi:[1,0,1] neg_lo:[1,0,0] neg_hi:[0,0,0]
    ds_write_b64 v244, v[234:235] offset:23040
    v_pk_fma_f32 v[232:233], v[236:237], v[234:235], v[224:225] op_sel:[0,0,0] op_sel_hi:[0,1,1]
    v_pk_fma_f32 v[232:233], v[236:237], v[234:235], v[232:233] op_sel:[1,1,0] op_sel_hi:[1,0,1] neg_lo:[1,0,0] neg_hi:[0,0,0]
    ds_write_b64 v244, v[232:233] offset:23424
    v_pk_fma_f32 v[234:235], v[236:237], v[232:233], v[226:227] op_sel:[0,0,0] op_sel_hi:[0,1,1]
    v_pk_fma_f32 v[234:235], v[236:237], v[232:233], v[234:235] op_sel:[1,1,0] op_sel_hi:[1,0,1] neg_lo:[1,0,0] neg_hi:[0,0,0]
    ds_write_b64 v244, v[234:235] offset:23808
    v_pk_fma_f32 v[232:233], v[236:237], v[234:235], v[228:229] op_sel:[0,0,0] op_sel_hi:[0,1,1]
    v_pk_fma_f32 v[232:233], v[236:237], v[234:235], v[232:233] op_sel:[1,1,0] op_sel_hi:[1,0,1] neg_lo:[1,0,0] neg_hi:[0,0,0]
    ds_write_b64 v244, v[232:233] offset:24192
    v_pk_fma_f32 v[234:235], v[236:237], v[232:233], v[230:231] op_sel:[0,0,0] op_sel_hi:[0,1,1]
    v_pk_fma_f32 v[234:235], v[236:237], v[232:233], v[234:235] op_sel:[1,1,0] op_sel_hi:[1,0,1] neg_lo:[1,0,0] neg_hi:[0,0,0]
    v_mov_b32 v240, v234
    v_mov_b32 v242, v235
    buffer_store_dwordx4 v[240:243], v245, s[20:23], s3 offen sc0 sc1
    s_mov_b64 exec, -1
    v_pk_mul_f32 v[248:249], v[108:109], v[16:17] op_sel:[1,0] op_sel_hi:[1,1]
    v_pk_mul_f32 v[250:251], v[108:109], v[60:61] op_sel:[1,0] op_sel_hi:[1,1]
    v_pk_mul_f32 v[252:253], v[120:121], v[24:25] op_sel:[1,0] op_sel_hi:[1,1]
    v_pk_mul_f32 v[10:11], v[120:121], v[68:69] op_sel:[1,0] op_sel_hi:[1,1]
    v_pk_mul_f32 v[2:3], v[132:133], v[32:33] op_sel:[1,0] op_sel_hi:[1,1]
    v_pk_mul_f32 v[166:167], v[132:133], v[76:77] op_sel:[1,0] op_sel_hi:[1,1]
    v_pk_mul_f32 v[16:17], v[108:109], v[16:17] op_sel:[0,0] op_sel_hi:[0,1]
    v_pk_mul_f32 v[60:61], v[108:109], v[60:61] op_sel:[0,0] op_sel_hi:[0,1]
    v_pk_mul_f32 v[24:25], v[120:121], v[24:25] op_sel:[0,0] op_sel_hi:[0,1]
    v_pk_mul_f32 v[68:69], v[120:121], v[68:69] op_sel:[0,0] op_sel_hi:[0,1]
    v_pk_mul_f32 v[32:33], v[132:133], v[32:33] op_sel:[0,0] op_sel_hi:[0,1]
    v_pk_mul_f32 v[76:77], v[132:133], v[76:77] op_sel:[0,0] op_sel_hi:[0,1]
    v_pk_fma_f32 v[16:17], v[108:109], v[12:13], v[16:17] op_sel:[1,0,0] op_sel_hi:[1,1,1]
    v_pk_fma_f32 v[60:61], v[108:109], v[56:57], v[60:61] op_sel:[1,0,0] op_sel_hi:[1,1,1]
    v_pk_fma_f32 v[24:25], v[120:121], v[20:21], v[24:25] op_sel:[1,0,0] op_sel_hi:[1,1,1]
    v_pk_fma_f32 v[68:69], v[120:121], v[64:65], v[68:69] op_sel:[1,0,0] op_sel_hi:[1,1,1]
    v_pk_fma_f32 v[32:33], v[132:133], v[28:29], v[32:33] op_sel:[1,0,0] op_sel_hi:[1,1,1]
    v_pk_fma_f32 v[76:77], v[132:133], v[72:73], v[76:77] op_sel:[1,0,0] op_sel_hi:[1,1,1]
    v_pk_fma_f32 v[12:13], v[108:109], v[12:13], v[248:249] op_sel:[0,0,0] op_sel_hi:[0,1,1] neg_lo:[0,0,1] neg_hi:[0,0,1]
    v_pk_fma_f32 v[56:57], v[108:109], v[56:57], v[250:251] op_sel:[0,0,0] op_sel_hi:[0,1,1] neg_lo:[0,0,1] neg_hi:[0,0,1]
    v_pk_fma_f32 v[20:21], v[120:121], v[20:21], v[252:253] op_sel:[0,0,0] op_sel_hi:[0,1,1] neg_lo:[0,0,1] neg_hi:[0,0,1]
    v_pk_fma_f32 v[64:65], v[120:121], v[64:65], v[10:11] op_sel:[0,0,0] op_sel_hi:[0,1,1] neg_lo:[0,0,1] neg_hi:[0,0,1]
    v_pk_fma_f32 v[28:29], v[132:133], v[28:29], v[2:3] op_sel:[0,0,0] op_sel_hi:[0,1,1] neg_lo:[0,0,1] neg_hi:[0,0,1]
    v_pk_fma_f32 v[72:73], v[132:133], v[72:73], v[166:167] op_sel:[0,0,0] op_sel_hi:[0,1,1] neg_lo:[0,0,1] neg_hi:[0,0,1]
    v_pk_mul_f32 v[248:249], v[108:109], v[18:19] op_sel:[1,0] op_sel_hi:[1,1]
    v_pk_mul_f32 v[250:251], v[108:109], v[62:63] op_sel:[1,0] op_sel_hi:[1,1]
    v_pk_mul_f32 v[252:253], v[120:121], v[26:27] op_sel:[1,0] op_sel_hi:[1,1]
    v_pk_mul_f32 v[10:11], v[120:121], v[70:71] op_sel:[1,0] op_sel_hi:[1,1]
    v_pk_mul_f32 v[2:3], v[132:133], v[34:35] op_sel:[1,0] op_sel_hi:[1,1]
    v_pk_mul_f32 v[166:167], v[132:133], v[78:79] op_sel:[1,0] op_sel_hi:[1,1]
    v_pk_mul_f32 v[18:19], v[108:109], v[18:19] op_sel:[0,0] op_sel_hi:[0,1]
    v_pk_mul_f32 v[62:63], v[108:109], v[62:63] op_sel:[0,0] op_sel_hi:[0,1]
    v_pk_mul_f32 v[26:27], v[120:121], v[26:27] op_sel:[0,0] op_sel_hi:[0,1]
    v_pk_mul_f32 v[70:71], v[120:121], v[70:71] op_sel:[0,0] op_sel_hi:[0,1]
    v_pk_mul_f32 v[34:35], v[132:133], v[34:35] op_sel:[0,0] op_sel_hi:[0,1]
    v_pk_mul_f32 v[78:79], v[132:133], v[78:79] op_sel:[0,0] op_sel_hi:[0,1]
    v_pk_fma_f32 v[18:19], v[108:109], v[14:15], v[18:19] op_sel:[1,0,0] op_sel_hi:[1,1,1]
    v_pk_fma_f32 v[62:63], v[108:109], v[58:59], v[62:63] op_sel:[1,0,0] op_sel_hi:[1,1,1]
    v_pk_fma_f32 v[26:27], v[120:121], v[22:23], v[26:27] op_sel:[1,0,0] op_sel_hi:[1,1,1]
    v_pk_fma_f32 v[70:71], v[120:121], v[66:67], v[70:71] op_sel:[1,0,0] op_sel_hi:[1,1,1]
    v_pk_fma_f32 v[34:35], v[132:133], v[30:31], v[34:35] op_sel:[1,0,0] op_sel_hi:[1,1,1]
    v_pk_fma_f32 v[78:79], v[132:133], v[74:75], v[78:79] op_sel:[1,0,0] op_sel_hi:[1,1,1]
    v_pk_fma_f32 v[14:15], v[108:109], v[14:15], v[248:249] op_sel:[0,0,0] op_sel_hi:[0,1,1] neg_lo:[0,0,1] neg_hi:[0,0,1]
    v_pk_fma_f32 v[58:59], v[108:109], v[58:59], v[250:251] op_sel:[0,0,0] op_sel_hi:[0,1,1] neg_lo:[0,0,1] neg_hi:[0,0,1]
    v_pk_fma_f32 v[22:23], v[120:121], v[22:23], v[252:253] op_sel:[0,0,0] op_sel_hi:[0,1,1] neg_lo:[0,0,1] neg_hi:[0,0,1]
    v_pk_fma_f32 v[66:67], v[120:121], v[66:67], v[10:11] op_sel:[0,0,0] op_sel_hi:[0,1,1] neg_lo:[0,0,1] neg_hi:[0,0,1]
    v_pk_fma_f32 v[30:31], v[132:133], v[30:31], v[2:3] op_sel:[0,0,0] op_sel_hi:[0,1,1] neg_lo:[0,0,1] neg_hi:[0,0,1]
    v_pk_fma_f32 v[74:75], v[132:133], v[74:75], v[166:167] op_sel:[0,0,0] op_sel_hi:[0,1,1] neg_lo:[0,0,1] neg_hi:[0,0,1]
    v_lshlrev_b32 v7, 4, v5
    v_and_b32 v10, 1, v6
    v_lshl_add_u32 v7, v10, 3, v7
    v_lshrrev_b32 v10, 1, v6
    v_lshl_add_u32 v7, v10, 8, v7
    s_mul_i32 s36, s45, 49152
    s_lshl_b32 s4, s46, 9
    s_add_u32 s36, s36, s4
    s_add_u32 s37, s36, 49152
    s_mov_b32 s4, 0xbfb8aa3b
    s_mov_b32 s5, s4
    v_cvt_pk_bf16_f32 v144, v36, v37
    v_cvt_pk_bf16_f32 v145, v38, v39
    v_cvt_pk_bf16_f32 v156, v40, v41
    v_cvt_pk_bf16_f32 v157, v42, v43
    v_lshlrev_b32 v36, 16, v144
    v_and_b32 v37, 0xffff0000, v144
    v_lshlrev_b32 v38, 16, v145
    v_and_b32 v39, 0xffff0000, v145
    v_lshlrev_b32 v40, 16, v156
    v_and_b32 v41, 0xffff0000, v156
    v_lshlrev_b32 v42, 16, v157
    v_and_b32 v43, 0xffff0000, v157
    v_pk_mul_f32 v[146:147], v[36:37], s[4:5]
    v_pk_mul_f32 v[148:149], v[38:39], s[4:5]
    v_pk_mul_f32 v[158:159], v[40:41], s[4:5]
    v_pk_mul_f32 v[160:161], v[42:43], s[4:5]
    v_exp_f32 v146, v146
    v_exp_f32 v147, v147
    v_exp_f32 v148, v148
    v_exp_f32 v149, v149
    v_exp_f32 v158, v158
    v_exp_f32 v159, v159
    v_exp_f32 v160, v160
    v_exp_f32 v161, v161
    v_pk_add_f32 v[146:147], v[146:147], 1.0 op_sel_hi:[1,0]
    v_pk_add_f32 v[148:149], v[148:149], 1.0 op_sel_hi:[1,0]
    v_pk_add_f32 v[158:159], v[158:159], 1.0 op_sel_hi:[1,0]
    v_pk_add_f32 v[160:161], v[160:161], 1.0 op_sel_hi:[1,0]
    v_rcp_f32 v146, v146
    v_rcp_f32 v147, v147
    v_rcp_f32 v148, v148
    v_rcp_f32 v149, v149
    v_rcp_f32 v158, v158
    v_rcp_f32 v159, v159
    v_rcp_f32 v160, v160
    v_rcp_f32 v161, v161
    v_pk_mul_f32 v[146:147], v[146:147], v[36:37] op_sel:[0,0] op_sel_hi:[1,1]
    v_pk_mul_f32 v[148:149], v[148:149], v[38:39] op_sel:[0,0] op_sel_hi:[1,1]
    v_pk_mul_f32 v[158:159], v[158:159], v[40:41] op_sel:[0,0] op_sel_hi:[1,1]
    v_pk_mul_f32 v[160:161], v[160:161], v[42:43] op_sel:[0,0] op_sel_hi:[1,1]
    v_cvt_pk_bf16_f32 v150, v146, v147
    v_cvt_pk_bf16_f32 v151, v148, v149
    v_cvt_pk_bf16_f32 v162, v158, v159
    v_cvt_pk_bf16_f32 v163, v160, v161
    buffer_store_dwordx2 v[150:151], v7, s[56:59], s36 offen offset:0 sc1
    buffer_store_dwordx2 v[162:163], v7, s[56:59], s36 offen offset:512 sc1
    v_cvt_pk_bf16_f32 v144, v44, v45
    v_cvt_pk_bf16_f32 v145, v46, v47
    v_cvt_pk_bf16_f32 v156, v48, v49
    v_cvt_pk_bf16_f32 v157, v50, v51
    v_lshlrev_b32 v44, 16, v144
    v_and_b32 v45, 0xffff0000, v144
    v_lshlrev_b32 v46, 16, v145
    v_and_b32 v47, 0xffff0000, v145
    v_lshlrev_b32 v48, 16, v156
    v_and_b32 v49, 0xffff0000, v156
    v_lshlrev_b32 v50, 16, v157
    v_and_b32 v51, 0xffff0000, v157
    v_pk_mul_f32 v[146:147], v[44:45], s[4:5]
    v_pk_mul_f32 v[148:149], v[46:47], s[4:5]
    v_pk_mul_f32 v[158:159], v[48:49], s[4:5]
    v_pk_mul_f32 v[160:161], v[50:51], s[4:5]
    v_exp_f32 v146, v146
    v_exp_f32 v147, v147
    v_exp_f32 v148, v148
    v_exp_f32 v149, v149
    v_exp_f32 v158, v158
    v_exp_f32 v159, v159
    v_exp_f32 v160, v160
    v_exp_f32 v161, v161
    v_pk_add_f32 v[146:147], v[146:147], 1.0 op_sel_hi:[1,0]
    v_pk_add_f32 v[148:149], v[148:149], 1.0 op_sel_hi:[1,0]
    v_pk_add_f32 v[158:159], v[158:159], 1.0 op_sel_hi:[1,0]
    v_pk_add_f32 v[160:161], v[160:161], 1.0 op_sel_hi:[1,0]
    v_rcp_f32 v146, v146
    v_rcp_f32 v147, v147
    v_rcp_f32 v148, v148
    v_rcp_f32 v149, v149
    v_rcp_f32 v158, v158
    v_rcp_f32 v159, v159
    v_rcp_f32 v160, v160
    v_rcp_f32 v161, v161
    v_pk_mul_f32 v[146:147], v[146:147], v[44:45] op_sel:[0,0] op_sel_hi:[1,1]
    v_pk_mul_f32 v[148:149], v[148:149], v[46:47] op_sel:[0,0] op_sel_hi:[1,1]
    v_pk_mul_f32 v[158:159], v[158:159], v[48:49] op_sel:[0,0] op_sel_hi:[1,1]
    v_pk_mul_f32 v[160:161], v[160:161], v[50:51] op_sel:[0,0] op_sel_hi:[1,1]
    v_cvt_pk_bf16_f32 v150, v146, v147
    v_cvt_pk_bf16_f32 v151, v148, v149
    v_cvt_pk_bf16_f32 v162, v158, v159
    v_cvt_pk_bf16_f32 v163, v160, v161
    buffer_store_dwordx2 v[150:151], v7, s[56:59], s36 offen offset:1024 sc1
    buffer_store_dwordx2 v[162:163], v7, s[56:59], s36 offen offset:1536 sc1
    s_mov_b64 exec, 0xfff
    s_cmp_le_u32 s29, 0
    s_cbranch_scc1 K1_LD0A
    buffer_load_dwordx4 v[168:171], v245, s[20:23], s42 offen offset:0 sc0 sc1
    s_cmp_le_u32 s29, 1
    s_cbranch_scc1 K1_LD0A
    buffer_load_dwordx4 v[172:175], v245, s[20:23], s42 offen offset:256 sc0 sc1
    s_cmp_le_u32 s29, 2
    s_cbranch_scc1 K1_LD0A
    buffer_load_dwordx4 v[176:179], v245, s[20:23], s42 offen offset:512 sc0 sc1
    s_cmp_le_u32 s29, 3
    s_cbranch_scc1 K1_LD0A
    buffer_load_dwordx4 v[180:183], v245, s[20:23], s42 offen offset:768 sc0 sc1
    s_cmp_le_u32 s29, 4
    s_cbranch_scc1 K1_LD0A
    buffer_load_dwordx4 v[184:187], v245, s[20:23], s42 offen offset:1024 sc0 sc1
    s_cmp_le_u32 s29, 5
    s_cbranch_scc1 K1_LD0A
    buffer_load_dwordx4 v[188:191], v245, s[20:23], s42 offen offset:1280 sc0 sc1
    s_cmp_le_u32 s29, 6
    s_cbranch_scc1 K1_LD0A
    buffer_load_dwordx4 v[192:195], v245, s[20:23], s42 offen offset:1536 sc0 sc1
    s_cmp_le_u32 s29, 7
    s_cbranch_scc1 K1_LD0A
    buffer_load_dwordx4 v[196:199], v245, s[20:23], s42 offen offset:1792 sc0 sc1
    s_cmp_le_u32 s29, 8
    s_cbranch_scc1 K1_LD0A
    buffer_load_dwordx4 v[200:203], v245, s[20:23], s42 offen offset:2048 sc0 sc1
    s_cmp_le_u32 s29, 9
    s_cbranch_scc1 K1_LD0A
    buffer_load_dwordx4 v[204:207], v245, s[20:23], s42 offen offset:2304 sc0 sc1
    s_cmp_le_u32 s29, 10
    s_cbranch_scc1 K1_LD0A
    buffer_load_dwordx4 v[208:211], v245, s[20:23], s42 offen offset:2560 sc0 sc1
    s_cmp_le_u32 s29, 11
    s_cbranch_scc1 K1_LD0A
    buffer_load_dwordx4 v[212:215], v245, s[20:23], s42 offen offset:2816 sc0 sc1
    s_cmp_le_u32 s29, 12
    s_cbranch_scc1 K1_LD0A
    buffer_load_dwordx4 v[216:219], v245, s[20:23], s42 offen offset:3072 sc0 sc1
    s_cmp_le_u32 s29, 13
    s_cbranch_scc1 K1_LD0A
    buffer_load_dwordx4 v[220:223], v245, s[20:23], s42 offen offset:3328 sc0 sc1
    s_cmp_le_u32 s29, 14
    s_cbranch_scc1 K1_LD0A
    buffer_load_dwordx4 v[224:227], v245, s[20:23], s42 offen offset:3584 sc0 sc1
K1_LD0A:
    s_mov_b64 exec, -1
    v_cvt_pk_bf16_f32 v144, v52, v53
    v_cvt_pk_bf16_f32 v145, v54, v55
    v_cvt_pk_bf16_f32 v156, v80, v81
    v_cvt_pk_bf16_f32 v157, v82, v83
    v_lshlrev_b32 v52, 16, v144
    v_and_b32 v53, 0xffff0000, v144
    v_lshlrev_b32 v54, 16, v145
    v_and_b32 v55, 0xffff0000, v145
    v_lshlrev_b32 v80, 16, v156
    v_and_b32 v81, 0xffff0000, v156
    v_lshlrev_b32 v82, 16, v157
    v_and_b32 v83, 0xffff0000, v157
    v_pk_mul_f32 v[146:147], v[52:53], s[4:5]
    v_pk_mul_f32 v[148:149], v[54:55], s[4:5]
    v_pk_mul_f32 v[158:159], v[80:81], s[4:5]
    v_pk_mul_f32 v[160:161], v[82:83], s[4:5]
    v_exp_f32 v146, v146
    v_exp_f32 v147, v147
    v_exp_f32 v148, v148
    v_exp_f32 v149, v149
    v_exp_f32 v158, v158
    v_exp_f32 v159, v159
    v_exp_f32 v160, v160
    v_exp_f32 v161, v161
    v_pk_add_f32 v[146:147], v[146:147], 1.0 op_sel_hi:[1,0]
    v_pk_add_f32 v[148:149], v[148:149], 1.0 op_sel_hi:[1,0]
    v_pk_add_f32 v[158:159], v[158:159], 1.0 op_sel_hi:[1,0]
    v_pk_add_f32 v[160:161], v[160:161], 1.0 op_sel_hi:[1,0]
    v_rcp_f32 v146, v146
    v_rcp_f32 v147, v147
    v_rcp_f32 v148, v148
    v_rcp_f32 v149, v149
    v_rcp_f32 v158, v158
    v_rcp_f32 v159, v159
    v_rcp_f32 v160, v160
    v_rcp_f32 v161, v161
    v_pk_mul_f32 v[146:147], v[146:147], v[52:53] op_sel:[0,0] op_sel_hi:[1,1]
    v_pk_mul_f32 v[148:149], v[148:149], v[54:55] op_sel:[0,0] op_sel_hi:[1,1]
    v_pk_mul_f32 v[158:159], v[158:159], v[80:81] op_sel:[0,0] op_sel_hi:[1,1]
    v_pk_mul_f32 v[160:161], v[160:161], v[82:83] op_sel:[0,0] op_sel_hi:[1,1]
    v_cvt_pk_bf16_f32 v150, v146, v147
    v_cvt_pk_bf16_f32 v151, v148, v149
    v_cvt_pk_bf16_f32 v162, v158, v159
    v_cvt_pk_bf16_f32 v163, v160, v161
    buffer_store_dwordx2 v[150:151], v7, s[56:59], s36 offen offset:2048 sc1
    buffer_store_dwordx2 v[162:163], v7, s[56:59], s37 offen offset:0 sc1
    v_cvt_pk_bf16_f32 v144, v84, v85
    v_cvt_pk_bf16_f32 v145, v86, v87
    v_cvt_pk_bf16_f32 v156, v88, v89
    v_cvt_pk_bf16_f32 v157, v90, v91
    v_lshlrev_b32 v84, 16, v144
    v_and_b32 v85, 0xffff0000, v144
    v_lshlrev_b32 v86, 16, v145
    v_and_b32 v87, 0xffff0000, v145
    v_lshlrev_b32 v88, 16, v156
    v_and_b32 v89, 0xffff0000, v156
    v_lshlrev_b32 v90, 16, v157
    v_and_b32 v91, 0xffff0000, v157
    v_pk_mul_f32 v[146:147], v[84:85], s[4:5]
    v_pk_mul_f32 v[148:149], v[86:87], s[4:5]
    v_pk_mul_f32 v[158:159], v[88:89], s[4:5]
    v_pk_mul_f32 v[160:161], v[90:91], s[4:5]
    v_exp_f32 v146, v146
    v_exp_f32 v147, v147
    v_exp_f32 v148, v148
    v_exp_f32 v149, v149
    v_exp_f32 v158, v158
    v_exp_f32 v159, v159
    v_exp_f32 v160, v160
    v_exp_f32 v161, v161
    v_pk_add_f32 v[146:147], v[146:147], 1.0 op_sel_hi:[1,0]
    v_pk_add_f32 v[148:149], v[148:149], 1.0 op_sel_hi:[1,0]
    v_pk_add_f32 v[158:159], v[158:159], 1.0 op_sel_hi:[1,0]
    v_pk_add_f32 v[160:161], v[160:161], 1.0 op_sel_hi:[1,0]
    v_rcp_f32 v146, v146
    v_rcp_f32 v147, v147
    v_rcp_f32 v148, v148
    v_rcp_f32 v149, v149
    v_rcp_f32 v158, v158
    v_rcp_f32 v159, v159
    v_rcp_f32 v160, v160
    v_rcp_f32 v161, v161
    v_pk_mul_f32 v[146:147], v[146:147], v[84:85] op_sel:[0,0] op_sel_hi:[1,1]
    v_pk_mul_f32 v[148:149], v[148:149], v[86:87] op_sel:[0,0] op_sel_hi:[1,1]
    v_pk_mul_f32 v[158:159], v[158:159], v[88:89] op_sel:[0,0] op_sel_hi:[1,1]
    v_pk_mul_f32 v[160:161], v[160:161], v[90:91] op_sel:[0,0] op_sel_hi:[1,1]
    v_cvt_pk_bf16_f32 v150, v146, v147
    v_cvt_pk_bf16_f32 v151, v148, v149
    v_cvt_pk_bf16_f32 v162, v158, v159
    v_cvt_pk_bf16_f32 v163, v160, v161
    buffer_store_dwordx2 v[150:151], v7, s[56:59], s37 offen offset:512 sc1
    buffer_store_dwordx2 v[162:163], v7, s[56:59], s37 offen offset:1024 sc1
    v_cvt_pk_bf16_f32 v144, v92, v93
    v_cvt_pk_bf16_f32 v145, v94, v95
    v_cvt_pk_bf16_f32 v156, v96, v97
    v_cvt_pk_bf16_f32 v157, v98, v99
    v_lshlrev_b32 v92, 16, v144
    v_and_b32 v93, 0xffff0000, v144
    v_lshlrev_b32 v94, 16, v145
    v_and_b32 v95, 0xffff0000, v145
    v_lshlrev_b32 v96, 16, v156
    v_and_b32 v97, 0xffff0000, v156
    v_lshlrev_b32 v98, 16, v157
    v_and_b32 v99, 0xffff0000, v157
    v_pk_mul_f32 v[146:147], v[92:93], s[4:5]
    v_pk_mul_f32 v[148:149], v[94:95], s[4:5]
    v_pk_mul_f32 v[158:159], v[96:97], s[4:5]
    v_pk_mul_f32 v[160:161], v[98:99], s[4:5]
    v_exp_f32 v146, v146
    v_exp_f32 v147, v147
    v_exp_f32 v148, v148
    v_exp_f32 v149, v149
    v_exp_f32 v158, v158
    v_exp_f32 v159, v159
    v_exp_f32 v160, v160
    v_exp_f32 v161, v161
    v_pk_add_f32 v[146:147], v[146:147], 1.0 op_sel_hi:[1,0]
    v_pk_add_f32 v[148:149], v[148:149], 1.0 op_sel_hi:[1,0]
    v_pk_add_f32 v[158:159], v[158:159], 1.0 op_sel_hi:[1,0]
    v_pk_add_f32 v[160:161], v[160:161], 1.0 op_sel_hi:[1,0]
    v_rcp_f32 v146, v146
    v_rcp_f32 v147, v147
    v_rcp_f32 v148, v148
    v_rcp_f32 v149, v149
    v_rcp_f32 v158, v158
    v_rcp_f32 v159, v159
    v_rcp_f32 v160, v160
    v_rcp_f32 v161, v161
    v_pk_mul_f32 v[146:147], v[146:147], v[92:93] op_sel:[0,0] op_sel_hi:[1,1]
    v_pk_mul_f32 v[148:149], v[148:149], v[94:95] op_sel:[0,0] op_sel_hi:[1,1]
    v_pk_mul_f32 v[158:159], v[158:159], v[96:97] op_sel:[0,0] op_sel_hi:[1,1]
    v_pk_mul_f32 v[160:161], v[160:161], v[98:99] op_sel:[0,0] op_sel_hi:[1,1]
    v_cvt_pk_bf16_f32 v150, v146, v147
    v_cvt_pk_bf16_f32 v151, v148, v149
    v_cvt_pk_bf16_f32 v162, v158, v159
    v_cvt_pk_bf16_f32 v163, v160, v161
    buffer_store_dwordx2 v[150:151], v7, s[56:59], s37 offen offset:1536 sc1
    buffer_store_dwordx2 v[162:163], v7, s[56:59], s37 offen offset:2048 sc1
    s_waitcnt vmcnt(11)
    v_lshlrev_b32 v2, 4, v0
    v_add_u32 v2, 146432, v2
    ds_read_b128 v[144:147], v2
    ds_read_b128 v[148:151], v2 offset:4096
    s_mul_i32 s5, s2, 200
    v_add_u32 v3, s5, v0
    v_mul_u32_u24 v10, 0xcccd, v3
    v_lshrrev_b32 v10, 22, v10
    v_mul_u32_u24 v11, 80, v10
    v_sub_u32 v11, v3, v11
    v_lshrrev_b32 v2, 4, v10
    v_mul_u32_u24 v2, 40960, v2
    v_and_b32 v10, 15, v10
    v_lshl_add_u32 v2, v10, 4, v2
    v_lshl_add_u32 v2, v11, 9, v2
    s_mov_b32 s70, 0x05040100
    s_mov_b32 s71, 0x07060302
    s_mov_b32 s72, 0x80008000
    s_add_u32 s76, s6, 0x1310000
    s_addc_u32 s77, s7, 0
    s_and_b32 s77, s77, 0xffff
    s_mov_b32 s78, 0x190000
    s_mov_b32 s79, 0x00020000
    s_waitcnt lgkmcnt(0)
    v_xor_b32 v148, s72, v148
    v_xor_b32 v149, s72, v149
    v_xor_b32 v150, s72, v150
    v_xor_b32 v151, s72, v151
    v_perm_b32 v152, v148, v144, s70
    v_perm_b32 v153, v148, v144, s71
    v_perm_b32 v154, v149, v145, s70
    v_perm_b32 v155, v149, v145, s71
    v_perm_b32 v156, v150, v146, s70
    v_perm_b32 v157, v150, v146, s71
    v_perm_b32 v158, v151, v147, s70
    v_perm_b32 v159, v151, v147, s71
    v_cmp_gt_u32 vcc, 200, v0
    s_and_saveexec_b64 s[74:75], vcc
    s_cbranch_execz K1_NOC2A
    buffer_store_dwordx4 v[152:155], v2, s[76:79], 0 offen
    buffer_store_dwordx4 v[156:159], v2, s[76:79], 0 offen offset:256
K1_NOC2A:
    s_mov_b64 exec, -1
    s_mov_b64 exec, 0xfff
    s_mov_b32 s43, 0
    s_waitcnt vmcnt(6)
    s_branch K1_LOADED2A
K1_POLLA:
    s_cmp_le_u32 s29, 0
    s_cbranch_scc1 K1_LOADEDA
    buffer_load_dwordx4 v[168:171], v245, s[20:23], s42 offen offset:0 sc0 sc1
    s_cmp_le_u32 s29, 1
    s_cbranch_scc1 K1_LOADEDA
    buffer_load_dwordx4 v[172:175], v245, s[20:23], s42 offen offset:256 sc0 sc1
    s_cmp_le_u32 s29, 2
    s_cbranch_scc1 K1_LOADEDA
    buffer_load_dwordx4 v[176:179], v245, s[20:23], s42 offen offset:512 sc0 sc1
    s_cmp_le_u32 s29, 3
    s_cbranch_scc1 K1_LOADEDA
    buffer_load_dwordx4 v[180:183], v245, s[20:23], s42 offen offset:768 sc0 sc1
    s_cmp_le_u32 s29, 4
    s_cbranch_scc1 K1_LOADEDA
    buffer_load_dwordx4 v[184:187], v245, s[20:23], s42 offen offset:1024 sc0 sc1
    s_cmp_le_u32 s29, 5
    s_cbranch_scc1 K1_LOADEDA
    buffer_load_dwordx4 v[188:191], v245, s[20:23], s42 offen offset:1280 sc0 sc1
    s_cmp_le_u32 s29, 6
    s_cbranch_scc1 K1_LOADEDA
    buffer_load_dwordx4 v[192:195], v245, s[20:23], s42 offen offset:1536 sc0 sc1
    s_cmp_le_u32 s29, 7
    s_cbranch_scc1 K1_LOADEDA
    buffer_load_dwordx4 v[196:199], v245, s[20:23], s42 offen offset:1792 sc0 sc1
    s_cmp_le_u32 s29, 8
    s_cbranch_scc1 K1_LOADEDA
    buffer_load_dwordx4 v[200:203], v245, s[20:23], s42 offen offset:2048 sc0 sc1
    s_cmp_le_u32 s29, 9
    s_cbranch_scc1 K1_LOADEDA
    buffer_load_dwordx4 v[204:207], v245, s[20:23], s42 offen offset:2304 sc0 sc1
    s_cmp_le_u32 s29, 10
    s_cbranch_scc1 K1_LOADEDA
    buffer_load_dwordx4 v[208:211], v245, s[20:23], s42 offen offset:2560 sc0 sc1
    s_cmp_le_u32 s29, 11
    s_cbranch_scc1 K1_LOADEDA
    buffer_load_dwordx4 v[212:215], v245, s[20:23], s42 offen offset:2816 sc0 sc1
    s_cmp_le_u32 s29, 12
    s_cbranch_scc1 K1_LOADEDA
    buffer_load_dwordx4 v[216:219], v245, s[20:23], s42 offen offset:3072 sc0 sc1
    s_cmp_le_u32 s29, 13
    s_cbranch_scc1 K1_LOADEDA
    buffer_load_dwordx4 v[220:223], v245, s[20:23], s42 offen offset:3328 sc0 sc1
    s_cmp_le_u32 s29, 14
    s_cbranch_scc1 K1_LOADEDA
    buffer_load_dwordx4 v[224:227], v245, s[20:23], s42 offen offset:3584 sc0 sc1
K1_LOADEDA:
    s_waitcnt vmcnt(0)
K1_LOADED2A:
    v_mov_b32 v246, 0
    s_cmp_le_u32 s29, 0
    s_cbranch_scc1 K1_CHKA
    v_and_b32 v247, v169, v171
    v_xor_b32 v247, 1, v247
    v_or_b32 v246, v246, v247
    s_cmp_le_u32 s29, 1
    s_cbranch_scc1 K1_CHKA
    v_and_b32 v247, v173, v175
    v_xor_b32 v247, 1, v247
    v_or_b32 v246, v246, v247
    s_cmp_le_u32 s29, 2
    s_cbranch_scc1 K1_CHKA
    v_and_b32 v247, v177, v179
    v_xor_b32 v247, 1, v247
    v_or_b32 v246, v246, v247
    s_cmp_le_u32 s29, 3
    s_cbranch_scc1 K1_CHKA
    v_and_b32 v247, v181, v183
    v_xor_b32 v247, 1, v247
    v_or_b32 v246, v246, v247
    s_cmp_le_u32 s29, 4
    s_cbranch_scc1 K1_CHKA
    v_and_b32 v247, v185, v187
    v_xor_b32 v247, 1, v247
    v_or_b32 v246, v246, v247
    s_cmp_le_u32 s29, 5
    s_cbranch_scc1 K1_CHKA
    v_and_b32 v247, v189, v191
    v_xor_b32 v247, 1, v247
    v_or_b32 v246, v246, v247
    s_cmp_le_u32 s29, 6
    s_cbranch_scc1 K1_CHKA
    v_and_b32 v247, v193, v195
    v_xor_b32 v247, 1, v247
    v_or_b32 v246, v246, v247
    s_cmp_le_u32 s29, 7
    s_cbranch_scc1 K1_CHKA
    v_and_b32 v247, v197, v199
    v_xor_b32 v247, 1, v247
    v_or_b32 v246, v246, v247
    s_cmp_le_u32 s29, 8
    s_cbranch_scc1 K1_CHKA
    v_and_b32 v247, v201, v203
    v_xor_b32 v247, 1, v247
    v_or_b32 v246, v246, v247
    s_cmp_le_u32 s29, 9
    s_cbranch_scc1 K1_CHKA
    v_and_b32 v247, v205, v207
    v_xor_b32 v247, 1, v247
    v_or_b32 v246, v246, v247
    s_cmp_le_u32 s29, 10
    s_cbranch_scc1 K1_CHKA
    v_and_b32 v247, v209, v211
    v_xor_b32 v247, 1, v247
    v_or_b32 v246, v246, v247
    s_cmp_le_u32 s29, 11
    s_cbranch_scc1 K1_CHKA
    v_and_b32 v247, v213, v215
    v_xor_b32 v247, 1, v247
    v_or_b32 v246, v246, v247
    s_cmp_le_u32 s29, 12
    s_cbranch_scc1 K1_CHKA
    v_and_b32 v247, v217, v219
    v_xor_b32 v247, 1, v247
    v_or_b32 v246, v246, v247
    s_cmp_le_u32 s29, 13
    s_cbranch_scc1 K1_CHKA
    v_and_b32 v247, v221, v223
    v_xor_b32 v247, 1, v247
    v_or_b32 v246, v246, v247
    s_cmp_le_u32 s29, 14
    s_cbranch_scc1 K1_CHKA
    v_and_b32 v247, v225, v227
    v_xor_b32 v247, 1, v247
    v_or_b32 v246, v246, v247
K1_CHKA:
    v_cmp_ne_u32 vcc, 0, v246
    s_add_u32 s43, s43, 1
    s_cmp_ge_u32 s43, 0x40000
    s_cbranch_scc1 K1_GOTA
    s_nop 4
    s_cbranch_vccnz K1_POLLA
K1_GOTA:
    v_mov_b32 v232, 0
    v_mov_b32 v233, 0
    s_cmp_le_u32 s29, 0
    s_cbranch_scc1 K1_CARRYA
    v_mov_b32 v169, v170
    v_pk_fma_f32 v[234:235], v[238:239], v[232:233], v[168:169] op_sel:[0,0,0] op_sel_hi:[0,1,1]
    v_pk_fma_f32 v[234:235], v[238:239], v[232:233], v[234:235] op_sel:[1,1,0] op_sel_hi:[1,0,1] neg_lo:[1,0,0] neg_hi:[0,0,0]
    v_mov_b32 v232, v234
    v_mov_b32 v233, v235
    s_cmp_le_u32 s29, 1
    s_cbranch_scc1 K1_CARRYA
    v_mov_b32 v173, v174
    v_pk_fma_f32 v[234:235], v[238:239], v[232:233], v[172:173] op_sel:[0,0,0] op_sel_hi:[0,1,1]
    v_pk_fma_f32 v[234:235], v[238:239], v[232:233], v[234:235] op_sel:[1,1,0] op_sel_hi:[1,0,1] neg_lo:[1,0,0] neg_hi:[0,0,0]
    v_mov_b32 v232, v234
    v_mov_b32 v233, v235
    s_cmp_le_u32 s29, 2
    s_cbranch_scc1 K1_CARRYA
    v_mov_b32 v177, v178
    v_pk_fma_f32 v[234:235], v[238:239], v[232:233], v[176:177] op_sel:[0,0,0] op_sel_hi:[0,1,1]
    v_pk_fma_f32 v[234:235], v[238:239], v[232:233], v[234:235] op_sel:[1,1,0] op_sel_hi:[1,0,1] neg_lo:[1,0,0] neg_hi:[0,0,0]
    v_mov_b32 v232, v234
    v_mov_b32 v233, v235
    s_cmp_le_u32 s29, 3
    s_cbranch_scc1 K1_CARRYA
    v_mov_b32 v181, v182
    v_pk_fma_f32 v[234:235], v[238:239], v[232:233], v[180:181] op_sel:[0,0,0] op_sel_hi:[0,1,1]
    v_pk_fma_f32 v[234:235], v[238:239], v[232:233], v[234:235] op_sel:[1,1,0] op_sel_hi:[1,0,1] neg_lo:[1,0,0] neg_hi:[0,0,0]
    v_mov_b32 v232, v234
    v_mov_b32 v233, v235
    s_cmp_le_u32 s29, 4
    s_cbranch_scc1 K1_CARRYA
    v_mov_b32 v185, v186
    v_pk_fma_f32 v[234:235], v[238:239], v[232:233], v[184:185] op_sel:[0,0,0] op_sel_hi:[0,1,1]
    v_pk_fma_f32 v[234:235], v[238:239], v[232:233], v[234:235] op_sel:[1,1,0] op_sel_hi:[1,0,1] neg_lo:[1,0,0] neg_hi:[0,0,0]
    v_mov_b32 v232, v234
    v_mov_b32 v233, v235
    s_cmp_le_u32 s29, 5
    s_cbranch_scc1 K1_CARRYA
    v_mov_b32 v189, v190
    v_pk_fma_f32 v[234:235], v[238:239], v[232:233], v[188:189] op_sel:[0,0,0] op_sel_hi:[0,1,1]
    v_pk_fma_f32 v[234:235], v[238:239], v[232:233], v[234:235] op_sel:[1,1,0] op_sel_hi:[1,0,1] neg_lo:[1,0,0] neg_hi:[0,0,0]
    v_mov_b32 v232, v234
    v_mov_b32 v233, v235
    s_cmp_le_u32 s29, 6
    s_cbranch_scc1 K1_CARRYA
    v_mov_b32 v193, v194
    v_pk_fma_f32 v[234:235], v[238:239], v[232:233], v[192:193] op_sel:[0,0,0] op_sel_hi:[0,1,1]
    v_pk_fma_f32 v[234:235], v[238:239], v[232:233], v[234:235] op_sel:[1,1,0] op_sel_hi:[1,0,1] neg_lo:[1,0,0] neg_hi:[0,0,0]
    v_mov_b32 v232, v234
    v_mov_b32 v233, v235
    s_cmp_le_u32 s29, 7
    s_cbranch_scc1 K1_CARRYA
    v_mov_b32 v197, v198
    v_pk_fma_f32 v[234:235], v[238:239], v[232:233], v[196:197] op_sel:[0,0,0] op_sel_hi:[0,1,1]
    v_pk_fma_f32 v[234:235], v[238:239], v[232:233], v[234:235] op_sel:[1,1,0] op_sel_hi:[1,0,1] neg_lo:[1,0,0] neg_hi:[0,0,0]
    v_mov_b32 v232, v234
    v_mov_b32 v233, v235
    s_cmp_le_u32 s29, 8
    s_cbranch_scc1 K1_CARRYA
    v_mov_b32 v201, v202
    v_pk_fma_f32 v[234:235], v[238:239], v[232:233], v[200:201] op_sel:[0,0,0] op_sel_hi:[0,1,1]
    v_pk_fma_f32 v[234:235], v[238:239], v[232:233], v[234:235] op_sel:[1,1,0] op_sel_hi:[1,0,1] neg_lo:[1,0,0] neg_hi:[0,0,0]
    v_mov_b32 v232, v234
    v_mov_b32 v233, v235
    s_cmp_le_u32 s29, 9
    s_cbranch_scc1 K1_CARRYA
    v_mov_b32 v205, v206
    v_pk_fma_f32 v[234:235], v[238:239], v[232:233], v[204:205] op_sel:[0,0,0] op_sel_hi:[0,1,1]
    v_pk_fma_f32 v[234:235], v[238:239], v[232:233], v[234:235] op_sel:[1,1,0] op_sel_hi:[1,0,1] neg_lo:[1,0,0] neg_hi:[0,0,0]
    v_mov_b32 v232, v234
    v_mov_b32 v233, v235
    s_cmp_le_u32 s29, 10
    s_cbranch_scc1 K1_CARRYA
    v_mov_b32 v209, v210
    v_pk_fma_f32 v[234:235], v[238:239], v[232:233], v[208:209] op_sel:[0,0,0] op_sel_hi:[0,1,1]
    v_pk_fma_f32 v[234:235], v[238:239], v[232:233], v[234:235] op_sel:[1,1,0] op_sel_hi:[1,0,1] neg_lo:[1,0,0] neg_hi:[0,0,0]
    v_mov_b32 v232, v234
    v_mov_b32 v233, v235
    s_cmp_le_u32 s29, 11
    s_cbranch_scc1 K1_CARRYA
    v_mov_b32 v213, v214
    v_pk_fma_f32 v[234:235], v[238:239], v[232:233], v[212:213] op_sel:[0,0,0] op_sel_hi:[0,1,1]
    v_pk_fma_f32 v[234:235], v[238:239], v[232:233], v[234:235] op_sel:[1,1,0] op_sel_hi:[1,0,1] neg_lo:[1,0,0] neg_hi:[0,0,0]
    v_mov_b32 v232, v234
    v_mov_b32 v233, v235
    s_cmp_le_u32 s29, 12
    s_cbranch_scc1 K1_CARRYA
    v_mov_b32 v217, v218
    v_pk_fma_f32 v[234:235], v[238:239], v[232:233], v[216:217] op_sel:[0,0,0] op_sel_hi:[0,1,1]
    v_pk_fma_f32 v[234:235], v[238:239], v[232:233], v[234:235] op_sel:[1,1,0] op_sel_hi:[1,0,1] neg_lo:[1,0,0] neg_hi:[0,0,0]
    v_mov_b32 v232, v234
    v_mov_b32 v233, v235
    s_cmp_le_u32 s29, 13
    s_cbranch_scc1 K1_CARRYA
    v_mov_b32 v221, v222
    v_pk_fma_f32 v[234:235], v[238:239], v[232:233], v[220:221] op_sel:[0,0,0] op_sel_hi:[0,1,1]
    v_pk_fma_f32 v[234:235], v[238:239], v[232:233], v[234:235] op_sel:[1,1,0] op_sel_hi:[1,0,1] neg_lo:[1,0,0] neg_hi:[0,0,0]
    v_mov_b32 v232, v234
    v_mov_b32 v233, v235
    s_cmp_le_u32 s29, 14
    s_cbranch_scc1 K1_CARRYA
    v_mov_b32 v225, v226
    v_pk_fma_f32 v[234:235], v[238:239], v[232:233], v[224:225] op_sel:[0,0,0] op_sel_hi:[0,1,1]
    v_pk_fma_f32 v[234:235], v[238:239], v[232:233], v[234:235] op_sel:[1,1,0] op_sel_hi:[1,0,1] neg_lo:[1,0,0] neg_hi:[0,0,0]
    v_mov_b32 v232, v234
    v_mov_b32 v233, v235
K1_CARRYA:
    ds_write_b64 v244, v[232:233] offset:24576
    s_mov_b64 exec, -1
    s_lshl_b32 s3, s28, 6
    s_add_u32 s3, s3, 125952
    v_lshlrev_b32 v9, 8, v5
    v_lshl_add_u32 v9, v6, 3, v9
    v_add_u32 v9, s3, v9
    ds_read_b64 v[188:189], v9 offset:0
    ds_read_b64 v[190:191], v9 offset:32
    ds_read_b64 v[192:193], v9 offset:4096
    ds_read_b64 v[194:195], v9 offset:4128
    ds_read_b64 v[196:197], v9 offset:8192
    ds_read_b64 v[198:199], v9 offset:8224
    v_lshlrev_b32 v10, 3, v5
    v_lshlrev_b32 v7, 6, v6
    v_lshrrev_b32 v9, 2, v5
    v_lshl_add_u32 v7, v9, 8, v7
    v_and_b32 v9, 3, v5
    v_lshl_add_u32 v7, v9, 2, v7
    s_mul_i32 s44, s28, 6144
    s_add_u32 s44, s44, 25600
    v_add_u32 v7, s44, v7
    v_add_u32 v11, s44, v1
    s_mul_i32 s36, s45, 40960
    s_lshl_b32 s4, s30, 10
    s_add_u32 s36, s36, s4
    s_add_u32 s37, s36, 40960
    s_waitcnt lgkmcnt(0)
    s_barrier
    ds_read_b64 v[168:169], v8 offset:12288
    ds_read_b64 v[170:171], v8 offset:13824
    ds_read_b64 v[172:173], v8 offset:12416
    ds_read_b64 v[174:175], v8 offset:13952
    ds_read_b64 v[176:177], v8 offset:12544
    ds_read_b64 v[178:179], v8 offset:14080
    ds_read_b64 v[212:213], v10 offset:24576
    ds_read_b64 v[214:215], v10 offset:24704
    ds_read_b64 v[216:217], v10 offset:24832
    s_waitcnt lgkmcnt(0)
    v_pk_fma_f32 v[168:169], v[188:189], v[212:213], v[168:169] op_sel:[0,0,0] op_sel_hi:[0,1,1]
    v_pk_fma_f32 v[170:171], v[190:191], v[212:213], v[170:171] op_sel:[0,0,0] op_sel_hi:[0,1,1]
    v_pk_fma_f32 v[172:173], v[192:193], v[214:215], v[172:173] op_sel:[0,0,0] op_sel_hi:[0,1,1]
    v_pk_fma_f32 v[174:175], v[194:195], v[214:215], v[174:175] op_sel:[0,0,0] op_sel_hi:[0,1,1]
    v_pk_fma_f32 v[176:177], v[196:197], v[216:217], v[176:177] op_sel:[0,0,0] op_sel_hi:[0,1,1]
    v_pk_fma_f32 v[178:179], v[198:199], v[216:217], v[178:179] op_sel:[0,0,0] op_sel_hi:[0,1,1]
    v_pk_fma_f32 v[168:169], v[188:189], v[212:213], v[168:169] op_sel:[1,1,0] op_sel_hi:[1,0,1] neg_lo:[1,0,0] neg_hi:[0,0,0]
    v_pk_fma_f32 v[170:171], v[190:191], v[212:213], v[170:171] op_sel:[1,1,0] op_sel_hi:[1,0,1] neg_lo:[1,0,0] neg_hi:[0,0,0]
    v_pk_fma_f32 v[172:173], v[192:193], v[214:215], v[172:173] op_sel:[1,1,0] op_sel_hi:[1,0,1] neg_lo:[1,0,0] neg_hi:[0,0,0]
    v_pk_fma_f32 v[174:175], v[194:195], v[214:215], v[174:175] op_sel:[1,1,0] op_sel_hi:[1,0,1] neg_lo:[1,0,0] neg_hi:[0,0,0]
    v_pk_fma_f32 v[176:177], v[196:197], v[216:217], v[176:177] op_sel:[1,1,0] op_sel_hi:[1,0,1] neg_lo:[1,0,0] neg_hi:[0,0,0]
    v_pk_fma_f32 v[178:179], v[198:199], v[216:217], v[178:179] op_sel:[1,1,0] op_sel_hi:[1,0,1] neg_lo:[1,0,0] neg_hi:[0,0,0]
    v_pk_mul_f32 v[188:189], v[108:109], v[168:169] op_sel:[0,0] op_sel_hi:[0,1]
    v_pk_mul_f32 v[190:191], v[108:109], v[170:171] op_sel:[0,0] op_sel_hi:[0,1]
    v_pk_mul_f32 v[192:193], v[120:121], v[172:173] op_sel:[0,0] op_sel_hi:[0,1]
    v_pk_mul_f32 v[194:195], v[120:121], v[174:175] op_sel:[0,0] op_sel_hi:[0,1]
    v_pk_mul_f32 v[196:197], v[132:133], v[176:177] op_sel:[0,0] op_sel_hi:[0,1]
    v_pk_mul_f32 v[198:199], v[132:133], v[178:179] op_sel:[0,0] op_sel_hi:[0,1]
    v_pk_fma_f32 v[188:189], v[108:109], v[168:169], v[188:189] op_sel:[1,1,0] op_sel_hi:[1,0,1] neg_lo:[1,0,0] neg_hi:[0,0,0]
    v_pk_fma_f32 v[190:191], v[108:109], v[170:171], v[190:191] op_sel:[1,1,0] op_sel_hi:[1,0,1] neg_lo:[1,0,0] neg_hi:[0,0,0]
    v_pk_fma_f32 v[192:193], v[120:121], v[172:173], v[192:193] op_sel:[1,1,0] op_sel_hi:[1,0,1] neg_lo:[1,0,0] neg_hi:[0,0,0]
    v_pk_fma_f32 v[194:195], v[120:121], v[174:175], v[194:195] op_sel:[1,1,0] op_sel_hi:[1,0,1] neg_lo:[1,0,0] neg_hi:[0,0,0]
    v_pk_fma_f32 v[196:197], v[132:133], v[176:177], v[196:197] op_sel:[1,1,0] op_sel_hi:[1,0,1] neg_lo:[1,0,0] neg_hi:[0,0,0]
    v_pk_fma_f32 v[198:199], v[132:133], v[178:179], v[198:199] op_sel:[1,1,0] op_sel_hi:[1,0,1] neg_lo:[1,0,0] neg_hi:[0,0,0]
    v_pk_fma_f32 v[12:13], v[110:111], v[188:189], v[12:13] op_sel:[0,0,0] op_sel_hi:[1,0,1]
    v_pk_fma_f32 v[56:57], v[110:111], v[190:191], v[56:57] op_sel:[0,0,0] op_sel_hi:[1,0,1]
    v_pk_fma_f32 v[20:21], v[122:123], v[192:193], v[20:21] op_sel:[0,0,0] op_sel_hi:[1,0,1]
    v_pk_fma_f32 v[64:65], v[122:123], v[194:195], v[64:65] op_sel:[0,0,0] op_sel_hi:[1,0,1]
    v_pk_fma_f32 v[28:29], v[134:135], v[196:197], v[28:29] op_sel:[0,0,0] op_sel_hi:[1,0,1]
    v_pk_fma_f32 v[72:73], v[134:135], v[198:199], v[72:73] op_sel:[0,0,0] op_sel_hi:[1,0,1]
    v_pk_fma_f32 v[16:17], v[110:111], v[188:189], v[16:17] op_sel:[0,1,0] op_sel_hi:[1,1,1]
    v_pk_fma_f32 v[60:61], v[110:111], v[190:191], v[60:61] op_sel:[0,1,0] op_sel_hi:[1,1,1]
    v_pk_fma_f32 v[24:25], v[122:123], v[192:193], v[24:25] op_sel:[0,1,0] op_sel_hi:[1,1,1]
    v_pk_fma_f32 v[68:69], v[122:123], v[194:195], v[68:69] op_sel:[0,1,0] op_sel_hi:[1,1,1]
    v_pk_fma_f32 v[32:33], v[134:135], v[196:197], v[32:33] op_sel:[0,1,0] op_sel_hi:[1,1,1]
    v_pk_fma_f32 v[76:77], v[134:135], v[198:199], v[76:77] op_sel:[0,1,0] op_sel_hi:[1,1,1]
    v_pk_fma_f32 v[12:13], v[114:115], v[188:189], v[12:13] op_sel:[0,1,0] op_sel_hi:[1,1,1] neg_lo:[1,0,0] neg_hi:[1,0,0]
    v_pk_fma_f32 v[56:57], v[114:115], v[190:191], v[56:57] op_sel:[0,1,0] op_sel_hi:[1,1,1] neg_lo:[1,0,0] neg_hi:[1,0,0]
    v_pk_fma_f32 v[20:21], v[126:127], v[192:193], v[20:21] op_sel:[0,1,0] op_sel_hi:[1,1,1] neg_lo:[1,0,0] neg_hi:[1,0,0]
    v_pk_fma_f32 v[64:65], v[126:127], v[194:195], v[64:65] op_sel:[0,1,0] op_sel_hi:[1,1,1] neg_lo:[1,0,0] neg_hi:[1,0,0]
    v_pk_fma_f32 v[28:29], v[138:139], v[196:197], v[28:29] op_sel:[0,1,0] op_sel_hi:[1,1,1] neg_lo:[1,0,0] neg_hi:[1,0,0]
    v_pk_fma_f32 v[72:73], v[138:139], v[198:199], v[72:73] op_sel:[0,1,0] op_sel_hi:[1,1,1] neg_lo:[1,0,0] neg_hi:[1,0,0]
    v_pk_fma_f32 v[16:17], v[114:115], v[188:189], v[16:17] op_sel:[0,0,0] op_sel_hi:[1,0,1]
    v_pk_fma_f32 v[60:61], v[114:115], v[190:191], v[60:61] op_sel:[0,0,0] op_sel_hi:[1,0,1]
    v_pk_fma_f32 v[24:25], v[126:127], v[192:193], v[24:25] op_sel:[0,0,0] op_sel_hi:[1,0,1]
    v_pk_fma_f32 v[68:69], v[126:127], v[194:195], v[68:69] op_sel:[0,0,0] op_sel_hi:[1,0,1]
    v_pk_fma_f32 v[32:33], v[138:139], v[196:197], v[32:33] op_sel:[0,0,0] op_sel_hi:[1,0,1]
    v_pk_fma_f32 v[76:77], v[138:139], v[198:199], v[76:77] op_sel:[0,0,0] op_sel_hi:[1,0,1]
    v_pk_fma_f32 v[14:15], v[112:113], v[188:189], v[14:15] op_sel:[0,0,0] op_sel_hi:[1,0,1]
    v_pk_fma_f32 v[58:59], v[112:113], v[190:191], v[58:59] op_sel:[0,0,0] op_sel_hi:[1,0,1]
    v_pk_fma_f32 v[22:23], v[124:125], v[192:193], v[22:23] op_sel:[0,0,0] op_sel_hi:[1,0,1]
    v_pk_fma_f32 v[66:67], v[124:125], v[194:195], v[66:67] op_sel:[0,0,0] op_sel_hi:[1,0,1]
    v_pk_fma_f32 v[30:31], v[136:137], v[196:197], v[30:31] op_sel:[0,0,0] op_sel_hi:[1,0,1]
    v_pk_fma_f32 v[74:75], v[136:137], v[198:199], v[74:75] op_sel:[0,0,0] op_sel_hi:[1,0,1]
    v_pk_fma_f32 v[18:19], v[112:113], v[188:189], v[18:19] op_sel:[0,1,0] op_sel_hi:[1,1,1]
    v_pk_fma_f32 v[62:63], v[112:113], v[190:191], v[62:63] op_sel:[0,1,0] op_sel_hi:[1,1,1]
    v_pk_fma_f32 v[26:27], v[124:125], v[192:193], v[26:27] op_sel:[0,1,0] op_sel_hi:[1,1,1]
    v_pk_fma_f32 v[70:71], v[124:125], v[194:195], v[70:71] op_sel:[0,1,0] op_sel_hi:[1,1,1]
    v_pk_fma_f32 v[34:35], v[136:137], v[196:197], v[34:35] op_sel:[0,1,0] op_sel_hi:[1,1,1]
    v_pk_fma_f32 v[78:79], v[136:137], v[198:199], v[78:79] op_sel:[0,1,0] op_sel_hi:[1,1,1]
    v_pk_fma_f32 v[14:15], v[116:117], v[188:189], v[14:15] op_sel:[0,1,0] op_sel_hi:[1,1,1] neg_lo:[1,0,0] neg_hi:[1,0,0]
    v_pk_fma_f32 v[58:59], v[116:117], v[190:191], v[58:59] op_sel:[0,1,0] op_sel_hi:[1,1,1] neg_lo:[1,0,0] neg_hi:[1,0,0]
    v_pk_fma_f32 v[22:23], v[128:129], v[192:193], v[22:23] op_sel:[0,1,0] op_sel_hi:[1,1,1] neg_lo:[1,0,0] neg_hi:[1,0,0]
    v_pk_fma_f32 v[66:67], v[128:129], v[194:195], v[66:67] op_sel:[0,1,0] op_sel_hi:[1,1,1] neg_lo:[1,0,0] neg_hi:[1,0,0]
    v_pk_fma_f32 v[30:31], v[140:141], v[196:197], v[30:31] op_sel:[0,1,0] op_sel_hi:[1,1,1] neg_lo:[1,0,0] neg_hi:[1,0,0]
    v_pk_fma_f32 v[74:75], v[140:141], v[198:199], v[74:75] op_sel:[0,1,0] op_sel_hi:[1,1,1] neg_lo:[1,0,0] neg_hi:[1,0,0]
    v_pk_fma_f32 v[18:19], v[116:117], v[188:189], v[18:19] op_sel:[0,0,0] op_sel_hi:[1,0,1]
    v_pk_fma_f32 v[62:63], v[116:117], v[190:191], v[62:63] op_sel:[0,0,0] op_sel_hi:[1,0,1]
    v_pk_fma_f32 v[26:27], v[128:129], v[192:193], v[26:27] op_sel:[0,0,0] op_sel_hi:[1,0,1]
    v_pk_fma_f32 v[70:71], v[128:129], v[194:195], v[70:71] op_sel:[0,0,0] op_sel_hi:[1,0,1]
    v_pk_fma_f32 v[34:35], v[140:141], v[196:197], v[34:35] op_sel:[0,0,0] op_sel_hi:[1,0,1]
    v_pk_fma_f32 v[78:79], v[140:141], v[198:199], v[78:79] op_sel:[0,0,0] op_sel_hi:[1,0,1]
    v_cvt_pk_bf16_f32 v12, v12, v16
    v_cvt_pk_bf16_f32 v56, v56, v60
    v_cvt_pk_bf16_f32 v20, v20, v24
    v_cvt_pk_bf16_f32 v64, v64, v68
    v_cvt_pk_bf16_f32 v28, v28, v32
    v_cvt_pk_bf16_f32 v72, v72, v76
    ds_write_b32 v7, v12 offset:0
    ds_write_b32 v7, v56 offset:3072
    ds_write_b32 v7, v20 offset:1024
    ds_write_b32 v7, v64 offset:4096
    ds_write_b32 v7, v28 offset:2048
    ds_write_b32 v7, v72 offset:5120
    v_cvt_pk_bf16_f32 v13, v13, v17
    v_cvt_pk_bf16_f32 v57, v57, v61
    v_cvt_pk_bf16_f32 v21, v21, v25
    v_cvt_pk_bf16_f32 v65, v65, v69
    v_cvt_pk_bf16_f32 v29, v29, v33
    v_cvt_pk_bf16_f32 v73, v73, v77
    ds_write_b32 v7, v13 offset:16
    ds_write_b32 v7, v57 offset:3088
    ds_write_b32 v7, v21 offset:1040
    ds_write_b32 v7, v65 offset:4112
    ds_write_b32 v7, v29 offset:2064
    ds_write_b32 v7, v73 offset:5136
    v_cvt_pk_bf16_f32 v14, v14, v18
    v_cvt_pk_bf16_f32 v58, v58, v62
    v_cvt_pk_bf16_f32 v22, v22, v26
    v_cvt_pk_bf16_f32 v66, v66, v70
    v_cvt_pk_bf16_f32 v30, v30, v34
    v_cvt_pk_bf16_f32 v74, v74, v78
    ds_write_b32 v7, v14 offset:32
    ds_write_b32 v7, v58 offset:3104
    ds_write_b32 v7, v22 offset:1056
    ds_write_b32 v7, v66 offset:4128
    ds_write_b32 v7, v30 offset:2080
    ds_write_b32 v7, v74 offset:5152
    v_cvt_pk_bf16_f32 v15, v15, v19
    v_cvt_pk_bf16_f32 v59, v59, v63
    v_cvt_pk_bf16_f32 v23, v23, v27
    v_cvt_pk_bf16_f32 v67, v67, v71
    v_cvt_pk_bf16_f32 v31, v31, v35
    v_cvt_pk_bf16_f32 v75, v75, v79
    ds_write_b32 v7, v15 offset:48
    ds_write_b32 v7, v59 offset:3120
    ds_write_b32 v7, v23 offset:1072
    ds_write_b32 v7, v67 offset:4144
    ds_write_b32 v7, v31 offset:2096
    ds_write_b32 v7, v75 offset:5168
    s_waitcnt lgkmcnt(0)
    ds_read_b128 v[168:171], v11 offset:0
    ds_read_b128 v[172:175], v11 offset:1024
    ds_read_b128 v[176:179], v11 offset:2048
    ds_read_b128 v[180:183], v11 offset:3072
    ds_read_b128 v[184:187], v11 offset:4096
    ds_read_b128 v[188:191], v11 offset:5120
    s_waitcnt lgkmcnt(5)
    buffer_store_dwordx4 v[168:171], v1, s[24:27], s36 offen offset:0 sc1
    s_waitcnt lgkmcnt(4)
    buffer_store_dwordx4 v[172:175], v1, s[24:27], s36 offen offset:1024 sc1
    s_waitcnt lgkmcnt(3)
    buffer_store_dwordx4 v[176:179], v1, s[24:27], s36 offen offset:2048 sc1
    s_waitcnt lgkmcnt(2)
    buffer_store_dwordx4 v[180:183], v1, s[24:27], s37 offen offset:0 sc1
    s_waitcnt lgkmcnt(1)
    buffer_store_dwordx4 v[184:187], v1, s[24:27], s37 offen offset:1024 sc1
    s_waitcnt lgkmcnt(0)
    buffer_store_dwordx4 v[188:191], v1, s[24:27], s37 offen offset:2048 sc1
    s_cmp_ge_u32 s2, 240
    s_cbranch_scc1 K1_NOW2A
    v_and_b32 v2, 15, v0
    v_lshrrev_b32 v3, 4, v0
    v_and_b32 v3, 7, v3
    v_lshrrev_b32 v10, 7, v0
    v_lshlrev_b32 v11, 10, v3
    v_lshl_add_u32 v11, v2, 1, v11
    v_lshl_add_u32 v11, v10, 5, v11
    v_add_u32 v11, 138240, v11
    ds_read_u16 v144, v11 offset:0
    ds_read_u16 v145, v11 offset:128
    ds_read_u16 v146, v11 offset:256
    ds_read_u16 v147, v11 offset:384
    ds_read_u16 v148, v11 offset:512
    ds_read_u16 v149, v11 offset:640
    ds_read_u16 v150, v11 offset:768
    ds_read_u16 v151, v11 offset:896
    ds_read_u16 v152, v11 offset:64
    ds_read_u16 v153, v11 offset:192
    ds_read_u16 v154, v11 offset:320
    ds_read_u16 v155, v11 offset:448
    ds_read_u16 v156, v11 offset:576
    ds_read_u16 v157, v11 offset:704
    ds_read_u16 v158, v11 offset:832
    ds_read_u16 v159, v11 offset:960
    v_mul_u32_u24 v10, 49152, v10
    v_lshl_add_u32 v10, v3, 8, v10
    v_lshl_add_u32 v10, v2, 4, v10
    s_add_u32 s76, s6, 0x460000
    s_addc_u32 s77, s7, 0
    s_and_b32 s77, s77, 0xffff
    s_mov_b32 s78, 0x1e0000
    s_mov_b32 s79, 0x00020000
    s_lshl_b32 s3, s68, 11
    s_mul_i32 s4, s69, 196608
    s_add_u32 s3, s3, s4
    s_add_u32 s4, s3, 98304
    s_waitcnt lgkmcnt(0)
    v_lshl_or_b32 v160, v145, 16, v144
    v_lshl_or_b32 v161, v147, 16, v146
    v_lshl_or_b32 v162, v149, 16, v148
    v_lshl_or_b32 v163, v151, 16, v150
    v_lshl_or_b32 v164, v153, 16, v152
    v_lshl_or_b32 v165, v155, 16, v154
    v_lshl_or_b32 v166, v157, 16, v156
    v_lshl_or_b32 v167, v159, 16, v158
    buffer_store_dwordx4 v[160:163], v10, s[76:79], s3 offen
    buffer_store_dwordx4 v[164:167], v10, s[76:79], s4 offen
K1_NOW2A:
    s_endpgm
K1_TYPEB:
    s_lshl_b32 s3, s30, 10
    s_cmp_ge_u32 s28, 2
    s_cbranch_scc1 K1_NOCB
    s_add_u32 s35, s3, s32
    s_add_u32 m0, s32, 122880
    s_nop 0
    buffer_load_dwordx4 v1, s[16:19], s35 offen lds
K1_NOCB:
    s_lshl_b32 s3, s30, 12
    s_add_u32 s3, s3, 40960
    s_add_u32 s3, s3, s32
    s_add_u32 m0, s32, 125952
    s_add_u32 s35, s3, 0
    buffer_load_dwordx4 v1, s[16:19], s35 offen lds
    s_add_u32 m0, s32, 130048
    s_add_u32 s35, s3, 4096
    buffer_load_dwordx4 v1, s[16:19], s35 offen lds
    s_mov_b32 s53, 0
    s_mov_b32 s50, 0
    s_add_u32 m0, s50, s32
    s_add_u32 m0, m0, 0
    s_add_u32 s35, s31, 0
    s_add_u32 s35, s35, s53
    buffer_load_dwordx4 v1, s[12:15], s35 offen lds
    s_add_u32 m0, s50, s32
    s_add_u32 m0, m0, 4096
    s_add_u32 s35, s31, 20480
    s_add_u32 s35, s35, s53
    buffer_load_dwordx4 v1, s[12:15], s35 offen lds
    s_add_u32 m0, s50, s32
    s_add_u32 m0, m0, 8192
    s_add_u32 s35, s47, 0
    s_add_u32 s35, s35, s53
    buffer_load_dwordx4 v1, s[12:15], s35 offen lds
    s_add_u32 m0, s50, s32
    s_add_u32 m0, m0, 12288
    s_add_u32 s35, s47, 40960
    s_add_u32 s35, s35, s53
    buffer_load_dwordx4 v1, s[12:15], s35 offen lds
    s_add_u32 m0, s50, s32
    s_add_u32 m0, m0, 16384
    s_add_u32 s35, s47, 81920
    s_add_u32 s35, s35, s53
    buffer_load_dwordx4 v1, s[12:15], s35 offen lds
    s_cmp_ge_u32 s28, 2
    s_cbranch_scc1 K1_SKB_191105
    s_add_u32 m0, s50, s32
    s_add_u32 m0, m0, 20480
    s_add_u32 s35, s47, 122880
    s_add_u32 s35, s35, s53
    buffer_load_dwordx4 v1, s[12:15], s35 offen lds
K1_SKB_191105:
    s_add_u32 m0, s50, s54
    s_add_u32 m0, m0, 0
    s_add_u32 s35, s33, 0
    s_add_u32 s35, s35, s53
    buffer_load_dwordx4 v1, s[8:11], s35 offen lds
    s_add_u32 m0, s50, s54
    s_add_u32 m0, m0, 1024
    s_add_u32 s35, s33, 1024
    s_add_u32 s35, s35, s53
    buffer_load_dwordx4 v1, s[8:11], s35 offen lds
    s_add_u32 m0, s50, s54
    s_add_u32 m0, m0, 2048
    s_add_u32 s35, s34, 0
    s_add_u32 s35, s35, s53
    buffer_load_dwordx4 v1, s[8:11], s35 offen lds
    s_add_u32 m0, s50, s54
    s_add_u32 m0, m0, 3072
    s_add_u32 s35, s34, 1024
    s_add_u32 s35, s35, s53
    buffer_load_dwordx4 v1, s[8:11], s35 offen lds
    s_add_u32 s53, s53, 2048
    s_mov_b32 s50, 40960
    s_add_u32 m0, s50, s32
    s_add_u32 m0, m0, 0
    s_add_u32 s35, s31, 0
    s_add_u32 s35, s35, s53
    buffer_load_dwordx4 v1, s[12:15], s35 offen lds
    s_add_u32 m0, s50, s32
    s_add_u32 m0, m0, 4096
    s_add_u32 s35, s31, 20480
    s_add_u32 s35, s35, s53
    buffer_load_dwordx4 v1, s[12:15], s35 offen lds
    s_add_u32 m0, s50, s32
    s_add_u32 m0, m0, 8192
    s_add_u32 s35, s47, 0
    s_add_u32 s35, s35, s53
    buffer_load_dwordx4 v1, s[12:15], s35 offen lds
    s_add_u32 m0, s50, s32
    s_add_u32 m0, m0, 12288
    s_add_u32 s35, s47, 40960
    s_add_u32 s35, s35, s53
    buffer_load_dwordx4 v1, s[12:15], s35 offen lds
    s_add_u32 m0, s50, s32
    s_add_u32 m0, m0, 16384
    s_add_u32 s35, s47, 81920
    s_add_u32 s35, s35, s53
    buffer_load_dwordx4 v1, s[12:15], s35 offen lds
    s_cmp_ge_u32 s28, 2
    s_cbranch_scc1 K1_SKB_196612
    s_add_u32 m0, s50, s32
    s_add_u32 m0, m0, 20480
    s_add_u32 s35, s47, 122880
    s_add_u32 s35, s35, s53
    buffer_load_dwordx4 v1, s[12:15], s35 offen lds
K1_SKB_196612:
    s_add_u32 m0, s50, s54
    s_add_u32 m0, m0, 0
    s_add_u32 s35, s33, 0
    s_add_u32 s35, s35, s53
    buffer_load_dwordx4 v1, s[8:11], s35 offen lds
    s_add_u32 m0, s50, s54
    s_add_u32 m0, m0, 1024
    s_add_u32 s35, s33, 1024
    s_add_u32 s35, s35, s53
    buffer_load_dwordx4 v1, s[8:11], s35 offen lds
    s_add_u32 m0, s50, s54
    s_add_u32 m0, m0, 2048
    s_add_u32 s35, s34, 0
    s_add_u32 s35, s35, s53
    buffer_load_dwordx4 v1, s[8:11], s35 offen lds
    s_add_u32 m0, s50, s54
    s_add_u32 m0, m0, 3072
    s_add_u32 s35, s34, 1024
    s_add_u32 s35, s35, s53
    buffer_load_dwordx4 v1, s[8:11], s35 offen lds
    s_add_u32 s53, s53, 2048
    s_mov_b32 s50, 81920
    s_add_u32 m0, s50, s32
    s_add_u32 m0, m0, 0
    s_add_u32 s35, s31, 0
    s_add_u32 s35, s35, s53
    buffer_load_dwordx4 v1, s[12:15], s35 offen lds
    s_add_u32 m0, s50, s32
    s_add_u32 m0, m0, 4096
    s_add_u32 s35, s31, 20480
    s_add_u32 s35, s35, s53
    buffer_load_dwordx4 v1, s[12:15], s35 offen lds
    s_add_u32 m0, s50, s32
    s_add_u32 m0, m0, 8192
    s_add_u32 s35, s47, 0
    s_add_u32 s35, s35, s53
    buffer_load_dwordx4 v1, s[12:15], s35 offen lds
    s_add_u32 m0, s50, s32
    s_add_u32 m0, m0, 12288
    s_add_u32 s35, s47, 40960
    s_add_u32 s35, s35, s53
    buffer_load_dwordx4 v1, s[12:15], s35 offen lds
    s_add_u32 m0, s50, s32
    s_add_u32 m0, m0, 16384
    s_add_u32 s35, s47, 81920
    s_add_u32 s35, s35, s53
    buffer_load_dwordx4 v1, s[12:15], s35 offen lds
    s_cmp_ge_u32 s28, 2
    s_cbranch_scc1 K1_SKB_202119
    s_add_u32 m0, s50, s32
    s_add_u32 m0, m0, 20480
    s_add_u32 s35, s47, 122880
    s_add_u32 s35, s35, s53
    buffer_load_dwordx4 v1, s[12:15], s35 offen lds
K1_SKB_202119:
    s_add_u32 m0, s50, s54
    s_add_u32 m0, m0, 0
    s_add_u32 s35, s33, 0
    s_add_u32 s35, s35, s53
    buffer_load_dwordx4 v1, s[8:11], s35 offen lds
    s_add_u32 m0, s50, s54
    s_add_u32 m0, m0, 1024
    s_add_u32 s35, s33, 1024
    s_add_u32 s35, s35, s53
    buffer_load_dwordx4 v1, s[8:11], s35 offen lds
    s_add_u32 m0, s50, s54
    s_add_u32 m0, m0, 2048
    s_add_u32 s35, s34, 0
    s_add_u32 s35, s35, s53
    buffer_load_dwordx4 v1, s[8:11], s35 offen lds
    s_add_u32 m0, s50, s54
    s_add_u32 m0, m0, 3072
    s_add_u32 s35, s34, 1024
    s_add_u32 s35, s35, s53
    buffer_load_dwordx4 v1, s[8:11], s35 offen lds
    s_add_u32 s53, s53, 2048
    s_mov_b32 s50, 0
    s_mov_b32 s51, 40960
    v_add_u32 v2, s50, v1
    v_add_u32 v3, s50, v7
    v_add_u32 v8, s51, v1
    v_add_u32 v9, s51, v7
    v_mov_b32 v12, 0
    v_mov_b32 v13, 0
    v_mov_b32 v14, 0
    v_mov_b32 v15, 0
    v_mov_b32 v16, 0
    v_mov_b32 v17, 0
    v_mov_b32 v18, 0
    v_mov_b32 v19, 0
    v_mov_b32 v20, 0
    v_mov_b32 v21, 0
    v_mov_b32 v22, 0
    v_mov_b32 v23, 0
    v_mov_b32 v24, 0
    v_mov_b32 v25, 0
    v_mov_b32 v26, 0
    v_mov_b32 v27, 0
    v_mov_b32 v28, 0
    v_mov_b32 v29, 0
    v_mov_b32 v30, 0
    v_mov_b32 v31, 0
    v_mov_b32 v32, 0
    v_mov_b32 v33, 0
    v_mov_b32 v34, 0
    v_mov_b32 v35, 0
    v_mov_b32 v36, 0
    v_mov_b32 v37, 0
    v_mov_b32 v38, 0
    v_mov_b32 v39, 0
    v_mov_b32 v40, 0
    v_mov_b32 v41, 0
    v_mov_b32 v42, 0
    v_mov_b32 v43, 0
    v_mov_b32 v44, 0
    v_mov_b32 v45, 0
    v_mov_b32 v46, 0
    v_mov_b32 v47, 0
    v_mov_b32 v48, 0
    v_mov_b32 v49, 0
    v_mov_b32 v50, 0
    v_mov_b32 v51, 0
    v_mov_b32 v52, 0
    v_mov_b32 v53, 0
    v_mov_b32 v54, 0
    v_mov_b32 v55, 0
    v_mov_b32 v56, 0
    v_mov_b32 v57, 0
    v_mov_b32 v58, 0
    v_mov_b32 v59, 0
    v_mov_b32 v60, 0
    v_mov_b32 v61, 0
    v_mov_b32 v62, 0
    v_mov_b32 v63, 0
    v_mov_b32 v64, 0
    v_mov_b32 v65, 0
    v_mov_b32 v66, 0
    v_mov_b32 v67, 0
    v_mov_b32 v68, 0
    v_mov_b32 v69, 0
    v_mov_b32 v70, 0
    v_mov_b32 v71, 0
    v_mov_b32 v72, 0
    v_mov_b32 v73, 0
    v_mov_b32 v74, 0
    v_mov_b32 v75, 0
    v_mov_b32 v76, 0
    v_mov_b32 v77, 0
    v_mov_b32 v78, 0
    v_mov_b32 v79, 0
    v_mov_b32 v80, 0
    v_mov_b32 v81, 0
    v_mov_b32 v82, 0
    v_mov_b32 v83, 0
    v_mov_b32 v84, 0
    v_mov_b32 v85, 0
    v_mov_b32 v86, 0
    v_mov_b32 v87, 0
    v_mov_b32 v88, 0
    v_mov_b32 v89, 0
    v_mov_b32 v90, 0
    v_mov_b32 v91, 0
    v_mov_b32 v92, 0
    v_mov_b32 v93, 0
    v_mov_b32 v94, 0
    v_mov_b32 v95, 0
    v_mov_b32 v96, 0
    v_mov_b32 v97, 0
    v_mov_b32 v98, 0
    v_mov_b32 v99, 0
    s_waitcnt vmcnt(18)
    s_barrier
    ds_read_b128 v[204:207], v3 offset:0
    ds_read_b128 v[208:211], v3 offset:2048
    ds_read_b128 v[108:111], v2 offset:0
    ds_read_b128 v[112:115], v2 offset:2048
    ds_read_b128 v[116:119], v2 offset:4096
    ds_read_b128 v[120:123], v2 offset:6144
    ds_read_b128 v[124:127], v2 offset:8192
    ds_read_b128 v[128:131], v2 offset:10240
    ds_read_b128 v[132:135], v2 offset:12288
    ds_read_b128 v[136:139], v2 offset:14336
    ds_read_b128 v[140:143], v2 offset:16384
    ds_read_b128 v[144:147], v2 offset:18432
    ds_read_b128 v[148:151], v2 offset:20480
    s_mov_b32 s55, 7
K1_LOOPB:
    s_waitcnt lgkmcnt(0)
    v_mfma_f32_16x16x32_bf16 v[12:15], v[204:207], v[108:111], v[12:15]
    ds_read_b128 v[212:215], v3 offset:1024
    v_mfma_f32_16x16x32_bf16 v[56:59], v[208:211], v[108:111], v[56:59]
    ds_read_b128 v[216:219], v3 offset:3072
    v_mfma_f32_16x16x32_bf16 v[16:19], v[204:207], v[112:115], v[16:19]
    ds_read_b128 v[156:159], v2 offset:1024
    v_mfma_f32_16x16x32_bf16 v[60:63], v[208:211], v[112:115], v[60:63]
    ds_read_b128 v[160:163], v2 offset:3072
    v_mfma_f32_16x16x32_bf16 v[20:23], v[204:207], v[116:119], v[20:23]
    ds_read_b128 v[164:167], v2 offset:5120
    v_mfma_f32_16x16x32_bf16 v[64:67], v[208:211], v[116:119], v[64:67]
    ds_read_b128 v[168:171], v2 offset:7168
    v_mfma_f32_16x16x32_bf16 v[24:27], v[204:207], v[120:123], v[24:27]
    ds_read_b128 v[172:175], v2 offset:9216
    v_mfma_f32_16x16x32_bf16 v[68:71], v[208:211], v[120:123], v[68:71]
    ds_read_b128 v[176:179], v2 offset:11264
    v_mfma_f32_16x16x32_bf16 v[28:31], v[124:127], v[204:207], v[28:31]
    ds_read_b128 v[180:183], v2 offset:13312
    v_mfma_f32_16x16x32_bf16 v[72:75], v[124:127], v[208:211], v[72:75]
    ds_read_b128 v[184:187], v2 offset:15360
    v_mfma_f32_16x16x32_bf16 v[32:35], v[128:131], v[204:207], v[32:35]
    ds_read_b128 v[188:191], v2 offset:17408
    v_mfma_f32_16x16x32_bf16 v[76:79], v[128:131], v[208:211], v[76:79]
    ds_read_b128 v[192:195], v2 offset:19456
    v_mfma_f32_16x16x32_bf16 v[36:39], v[132:135], v[204:207], v[36:39]
    ds_read_b128 v[196:199], v2 offset:21504
    v_mfma_f32_16x16x32_bf16 v[80:83], v[132:135], v[208:211], v[80:83]
    v_mfma_f32_16x16x32_bf16 v[40:43], v[136:139], v[204:207], v[40:43]
    v_mfma_f32_16x16x32_bf16 v[84:87], v[136:139], v[208:211], v[84:87]
    v_mfma_f32_16x16x32_bf16 v[44:47], v[140:143], v[204:207], v[44:47]
    v_mfma_f32_16x16x32_bf16 v[88:91], v[140:143], v[208:211], v[88:91]
    v_mfma_f32_16x16x32_bf16 v[48:51], v[144:147], v[204:207], v[48:51]
    v_mfma_f32_16x16x32_bf16 v[92:95], v[144:147], v[208:211], v[92:95]
    v_mfma_f32_16x16x32_bf16 v[52:55], v[148:151], v[204:207], v[52:55]
    v_mfma_f32_16x16x32_bf16 v[96:99], v[148:151], v[208:211], v[96:99]
    s_waitcnt vmcnt(9) lgkmcnt(0)
    s_barrier
    v_mfma_f32_16x16x32_bf16 v[12:15], v[212:215], v[156:159], v[12:15]
    ds_read_b128 v[204:207], v9 offset:0
    v_mfma_f32_16x16x32_bf16 v[56:59], v[216:219], v[156:159], v[56:59]
    ds_read_b128 v[208:211], v9 offset:2048
    v_mfma_f32_16x16x32_bf16 v[16:19], v[212:215], v[160:163], v[16:19]
    ds_read_b128 v[108:111], v8 offset:0
    v_mfma_f32_16x16x32_bf16 v[60:63], v[216:219], v[160:163], v[60:63]
    ds_read_b128 v[112:115], v8 offset:2048
    v_mfma_f32_16x16x32_bf16 v[20:23], v[212:215], v[164:167], v[20:23]
    ds_read_b128 v[116:119], v8 offset:4096
    v_mfma_f32_16x16x32_bf16 v[64:67], v[216:219], v[164:167], v[64:67]
    ds_read_b128 v[120:123], v8 offset:6144
    v_mfma_f32_16x16x32_bf16 v[24:27], v[212:215], v[168:171], v[24:27]
    ds_read_b128 v[124:127], v8 offset:8192
    v_mfma_f32_16x16x32_bf16 v[68:71], v[216:219], v[168:171], v[68:71]
    ds_read_b128 v[128:131], v8 offset:10240
    v_mfma_f32_16x16x32_bf16 v[28:31], v[172:175], v[212:215], v[28:31]
    ds_read_b128 v[132:135], v8 offset:12288
    v_mfma_f32_16x16x32_bf16 v[72:75], v[172:175], v[216:219], v[72:75]
    ds_read_b128 v[136:139], v8 offset:14336
    v_mfma_f32_16x16x32_bf16 v[32:35], v[176:179], v[212:215], v[32:35]
    ds_read_b128 v[140:143], v8 offset:16384
    v_mfma_f32_16x16x32_bf16 v[76:79], v[176:179], v[216:219], v[76:79]
    ds_read_b128 v[144:147], v8 offset:18432
    v_mfma_f32_16x16x32_bf16 v[36:39], v[180:183], v[212:215], v[36:39]
    ds_read_b128 v[148:151], v8 offset:20480
    v_mfma_f32_16x16x32_bf16 v[80:83], v[180:183], v[216:219], v[80:83]
    s_add_u32 m0, s50, s32
    s_add_u32 m0, m0, 0
    s_add_u32 s35, s31, 0
    s_add_u32 s35, s35, s53
    buffer_load_dwordx4 v1, s[12:15], s35 offen lds
    v_mfma_f32_16x16x32_bf16 v[40:43], v[184:187], v[212:215], v[40:43]
    s_add_u32 m0, s50, s32
    s_add_u32 m0, m0, 4096
    s_add_u32 s35, s31, 20480
    s_add_u32 s35, s35, s53
    buffer_load_dwordx4 v1, s[12:15], s35 offen lds
    v_mfma_f32_16x16x32_bf16 v[84:87], v[184:187], v[216:219], v[84:87]
    s_add_u32 m0, s50, s32
    s_add_u32 m0, m0, 8192
    s_add_u32 s35, s47, 0
    s_add_u32 s35, s35, s53
    buffer_load_dwordx4 v1, s[12:15], s35 offen lds
    v_mfma_f32_16x16x32_bf16 v[44:47], v[188:191], v[212:215], v[44:47]
    s_add_u32 m0, s50, s32
    s_add_u32 m0, m0, 12288
    s_add_u32 s35, s47, 40960
    s_add_u32 s35, s35, s53
    buffer_load_dwordx4 v1, s[12:15], s35 offen lds
    v_mfma_f32_16x16x32_bf16 v[88:91], v[188:191], v[216:219], v[88:91]
    s_add_u32 m0, s50, s32
    s_add_u32 m0, m0, 16384
    s_add_u32 s35, s47, 81920
    s_add_u32 s35, s35, s53
    buffer_load_dwordx4 v1, s[12:15], s35 offen lds
    v_mfma_f32_16x16x32_bf16 v[48:51], v[192:195], v[212:215], v[48:51]
    s_cmp_ge_u32 s28, 2
    s_cbranch_scc1 K1_SKB_222426
    s_add_u32 m0, s50, s32
    s_add_u32 m0, m0, 20480
    s_add_u32 s35, s47, 122880
    s_add_u32 s35, s35, s53
    buffer_load_dwordx4 v1, s[12:15], s35 offen lds
K1_SKB_222426:
    v_mfma_f32_16x16x32_bf16 v[92:95], v[192:195], v[216:219], v[92:95]
    s_add_u32 m0, s50, s54
    s_add_u32 m0, m0, 0
    s_add_u32 s35, s33, 0
    s_add_u32 s35, s35, s53
    buffer_load_dwordx4 v1, s[8:11], s35 offen lds
    v_mfma_f32_16x16x32_bf16 v[52:55], v[196:199], v[212:215], v[52:55]
    s_add_u32 m0, s50, s54
    s_add_u32 m0, m0, 1024
    s_add_u32 s35, s33, 1024
    s_add_u32 s35, s35, s53
    buffer_load_dwordx4 v1, s[8:11], s35 offen lds
    v_mfma_f32_16x16x32_bf16 v[96:99], v[196:199], v[216:219], v[96:99]
    s_add_u32 m0, s50, s54
    s_add_u32 m0, m0, 2048
    s_add_u32 s35, s34, 0
    s_add_u32 s35, s35, s53
    buffer_load_dwordx4 v1, s[8:11], s35 offen lds
    s_add_u32 m0, s50, s54
    s_add_u32 m0, m0, 3072
    s_add_u32 s35, s34, 1024
    s_add_u32 s35, s35, s53
    buffer_load_dwordx4 v1, s[8:11], s35 offen lds
    s_mov_b32 s50, s51
    s_add_u32 s51, s51, 40960
    s_cmp_eq_u32 s51, 122880
    s_cselect_b32 s51, 0, s51
    s_add_u32 s53, s53, 2048
    v_add_u32 v2, s50, v1
    v_add_u32 v3, s50, v7
    v_add_u32 v8, s51, v1
    v_add_u32 v9, s51, v7
    s_sub_u32 s55, s55, 1
    s_cmp_lg_u32 s55, 0
    s_cbranch_scc1 K1_LOOPB
    v_lshrrev_b32 v220, 3, v0
    v_and_b32 v221, 7, v0
    s_lshl_b32 s3, s68, 6
    v_add_u32 v220, s3, v220
    v_mul_u32_u24 v220, 1280, v220
    v_lshl_add_u32 v220, v221, 4, v220
    s_lshl_b32 s3, s69, 7
    s_add_u32 s4, s3, 40960
    s_add_u32 m0, s32, 138240
    s_mul_i32 s5, s2, 200
    buffer_load_dwordx4 v220, s[76:79], s3 offen lds
    s_add_u32 m0, s32, 142336
    v_add_u32 v221, s5, v0
    buffer_load_dwordx4 v220, s[76:79], s4 offen lds
    v_lshlrev_b32 v220, 4, v221
    s_add_u32 m0, s32, 146432
    s_nop 0
    buffer_load_dwordx4 v220, s[80:83], 0 offen lds
    s_add_u32 m0, s32, 150528
    s_nop 0
    buffer_load_dwordx4 v220, s[84:87], 0 offen lds
    s_waitcnt lgkmcnt(0)
    v_mfma_f32_16x16x32_bf16 v[12:15], v[204:207], v[108:111], v[12:15]
    ds_read_b128 v[212:215], v3 offset:1024
    v_mfma_f32_16x16x32_bf16 v[56:59], v[208:211], v[108:111], v[56:59]
    ds_read_b128 v[216:219], v3 offset:3072
    v_mfma_f32_16x16x32_bf16 v[16:19], v[204:207], v[112:115], v[16:19]
    ds_read_b128 v[156:159], v2 offset:1024
    v_mfma_f32_16x16x32_bf16 v[60:63], v[208:211], v[112:115], v[60:63]
    ds_read_b128 v[160:163], v2 offset:3072
    v_mfma_f32_16x16x32_bf16 v[20:23], v[204:207], v[116:119], v[20:23]
    ds_read_b128 v[164:167], v2 offset:5120
    v_mfma_f32_16x16x32_bf16 v[64:67], v[208:211], v[116:119], v[64:67]
    ds_read_b128 v[168:171], v2 offset:7168
    v_mfma_f32_16x16x32_bf16 v[24:27], v[204:207], v[120:123], v[24:27]
    ds_read_b128 v[172:175], v2 offset:9216
    v_mfma_f32_16x16x32_bf16 v[68:71], v[208:211], v[120:123], v[68:71]
    ds_read_b128 v[176:179], v2 offset:11264
    v_mfma_f32_16x16x32_bf16 v[28:31], v[124:127], v[204:207], v[28:31]
    ds_read_b128 v[180:183], v2 offset:13312
    v_mfma_f32_16x16x32_bf16 v[72:75], v[124:127], v[208:211], v[72:75]
    ds_read_b128 v[184:187], v2 offset:15360
    v_mfma_f32_16x16x32_bf16 v[32:35], v[128:131], v[204:207], v[32:35]
    ds_read_b128 v[188:191], v2 offset:17408
    v_mfma_f32_16x16x32_bf16 v[76:79], v[128:131], v[208:211], v[76:79]
    ds_read_b128 v[192:195], v2 offset:19456
    v_mfma_f32_16x16x32_bf16 v[36:39], v[132:135], v[204:207], v[36:39]
    ds_read_b128 v[196:199], v2 offset:21504
    v_mfma_f32_16x16x32_bf16 v[80:83], v[132:135], v[208:211], v[80:83]
    v_mfma_f32_16x16x32_bf16 v[40:43], v[136:139], v[204:207], v[40:43]
    v_mfma_f32_16x16x32_bf16 v[84:87], v[136:139], v[208:211], v[84:87]
    v_mfma_f32_16x16x32_bf16 v[44:47], v[140:143], v[204:207], v[44:47]
    v_mfma_f32_16x16x32_bf16 v[88:91], v[140:143], v[208:211], v[88:91]
    v_mfma_f32_16x16x32_bf16 v[48:51], v[144:147], v[204:207], v[48:51]
    v_mfma_f32_16x16x32_bf16 v[92:95], v[144:147], v[208:211], v[92:95]
    v_mfma_f32_16x16x32_bf16 v[52:55], v[148:151], v[204:207], v[52:55]
    v_mfma_f32_16x16x32_bf16 v[96:99], v[148:151], v[208:211], v[96:99]
    s_waitcnt vmcnt(13) lgkmcnt(0)
    s_barrier
    v_mfma_f32_16x16x32_bf16 v[12:15], v[212:215], v[156:159], v[12:15]
    ds_read_b128 v[204:207], v9 offset:0
    v_mfma_f32_16x16x32_bf16 v[56:59], v[216:219], v[156:159], v[56:59]
    ds_read_b128 v[208:211], v9 offset:2048
    v_mfma_f32_16x16x32_bf16 v[16:19], v[212:215], v[160:163], v[16:19]
    ds_read_b128 v[108:111], v8 offset:0
    v_mfma_f32_16x16x32_bf16 v[60:63], v[216:219], v[160:163], v[60:63]
    ds_read_b128 v[112:115], v8 offset:2048
    v_mfma_f32_16x16x32_bf16 v[20:23], v[212:215], v[164:167], v[20:23]
    ds_read_b128 v[116:119], v8 offset:4096
    v_mfma_f32_16x16x32_bf16 v[64:67], v[216:219], v[164:167], v[64:67]
    ds_read_b128 v[120:123], v8 offset:6144
    v_mfma_f32_16x16x32_bf16 v[24:27], v[212:215], v[168:171], v[24:27]
    ds_read_b128 v[124:127], v8 offset:8192
    v_mfma_f32_16x16x32_bf16 v[68:71], v[216:219], v[168:171], v[68:71]
    ds_read_b128 v[128:131], v8 offset:10240
    v_mfma_f32_16x16x32_bf16 v[28:31], v[172:175], v[212:215], v[28:31]
    ds_read_b128 v[132:135], v8 offset:12288
    v_mfma_f32_16x16x32_bf16 v[72:75], v[172:175], v[216:219], v[72:75]
    ds_read_b128 v[136:139], v8 offset:14336
    v_mfma_f32_16x16x32_bf16 v[32:35], v[176:179], v[212:215], v[32:35]
    ds_read_b128 v[140:143], v8 offset:16384
    v_mfma_f32_16x16x32_bf16 v[76:79], v[176:179], v[216:219], v[76:79]
    ds_read_b128 v[144:147], v8 offset:18432
    v_mfma_f32_16x16x32_bf16 v[36:39], v[180:183], v[212:215], v[36:39]
    ds_read_b128 v[148:151], v8 offset:20480
    v_mfma_f32_16x16x32_bf16 v[80:83], v[180:183], v[216:219], v[80:83]
    v_mfma_f32_16x16x32_bf16 v[40:43], v[184:187], v[212:215], v[40:43]
    v_mfma_f32_16x16x32_bf16 v[84:87], v[184:187], v[216:219], v[84:87]
    v_mfma_f32_16x16x32_bf16 v[44:47], v[188:191], v[212:215], v[44:47]
    v_mfma_f32_16x16x32_bf16 v[88:91], v[188:191], v[216:219], v[88:91]
    v_mfma_f32_16x16x32_bf16 v[48:51], v[192:195], v[212:215], v[48:51]
    v_mfma_f32_16x16x32_bf16 v[92:95], v[192:195], v[216:219], v[92:95]
    v_mfma_f32_16x16x32_bf16 v[52:55], v[196:199], v[212:215], v[52:55]
    v_mfma_f32_16x16x32_bf16 v[96:99], v[196:199], v[216:219], v[96:99]
    s_mov_b32 s50, s51
    s_add_u32 s51, s51, 40960
    s_cmp_eq_u32 s51, 122880
    s_cselect_b32 s51, 0, s51
    s_add_u32 s53, s53, 2048
    v_add_u32 v2, s50, v1
    v_add_u32 v3, s50, v7
    v_add_u32 v8, s51, v1
    v_add_u32 v9, s51, v7
    s_waitcnt lgkmcnt(0)
    v_mfma_f32_16x16x32_bf16 v[12:15], v[204:207], v[108:111], v[12:15]
    ds_read_b128 v[212:215], v3 offset:1024
    v_mfma_f32_16x16x32_bf16 v[56:59], v[208:211], v[108:111], v[56:59]
    ds_read_b128 v[216:219], v3 offset:3072
    v_mfma_f32_16x16x32_bf16 v[16:19], v[204:207], v[112:115], v[16:19]
    ds_read_b128 v[156:159], v2 offset:1024
    v_mfma_f32_16x16x32_bf16 v[60:63], v[208:211], v[112:115], v[60:63]
    ds_read_b128 v[160:163], v2 offset:3072
    v_mfma_f32_16x16x32_bf16 v[20:23], v[204:207], v[116:119], v[20:23]
    ds_read_b128 v[164:167], v2 offset:5120
    v_mfma_f32_16x16x32_bf16 v[64:67], v[208:211], v[116:119], v[64:67]
    ds_read_b128 v[168:171], v2 offset:7168
    v_mfma_f32_16x16x32_bf16 v[24:27], v[204:207], v[120:123], v[24:27]
    ds_read_b128 v[172:175], v2 offset:9216
    v_mfma_f32_16x16x32_bf16 v[68:71], v[208:211], v[120:123], v[68:71]
    ds_read_b128 v[176:179], v2 offset:11264
    v_mfma_f32_16x16x32_bf16 v[28:31], v[124:127], v[204:207], v[28:31]
    ds_read_b128 v[180:183], v2 offset:13312
    v_mfma_f32_16x16x32_bf16 v[72:75], v[124:127], v[208:211], v[72:75]
    ds_read_b128 v[184:187], v2 offset:15360
    v_mfma_f32_16x16x32_bf16 v[32:35], v[128:131], v[204:207], v[32:35]
    ds_read_b128 v[188:191], v2 offset:17408
    v_mfma_f32_16x16x32_bf16 v[76:79], v[128:131], v[208:211], v[76:79]
    ds_read_b128 v[192:195], v2 offset:19456
    v_mfma_f32_16x16x32_bf16 v[36:39], v[132:135], v[204:207], v[36:39]
    ds_read_b128 v[196:199], v2 offset:21504
    v_mfma_f32_16x16x32_bf16 v[80:83], v[132:135], v[208:211], v[80:83]
    v_mfma_f32_16x16x32_bf16 v[40:43], v[136:139], v[204:207], v[40:43]
    v_mfma_f32_16x16x32_bf16 v[84:87], v[136:139], v[208:211], v[84:87]
    v_mfma_f32_16x16x32_bf16 v[44:47], v[140:143], v[204:207], v[44:47]
    v_mfma_f32_16x16x32_bf16 v[88:91], v[140:143], v[208:211], v[88:91]
    v_mfma_f32_16x16x32_bf16 v[48:51], v[144:147], v[204:207], v[48:51]
    v_mfma_f32_16x16x32_bf16 v[92:95], v[144:147], v[208:211], v[92:95]
    v_mfma_f32_16x16x32_bf16 v[52:55], v[148:151], v[204:207], v[52:55]
    v_mfma_f32_16x16x32_bf16 v[96:99], v[148:151], v[208:211], v[96:99]
    s_waitcnt vmcnt(4) lgkmcnt(0)
    s_barrier
    v_mfma_f32_16x16x32_bf16 v[12:15], v[212:215], v[156:159], v[12:15]
    ds_read_b128 v[204:207], v9 offset:0
    v_mfma_f32_16x16x32_bf16 v[56:59], v[216:219], v[156:159], v[56:59]
    ds_read_b128 v[208:211], v9 offset:2048
    v_mfma_f32_16x16x32_bf16 v[16:19], v[212:215], v[160:163], v[16:19]
    ds_read_b128 v[108:111], v8 offset:0
    v_mfma_f32_16x16x32_bf16 v[60:63], v[216:219], v[160:163], v[60:63]
    ds_read_b128 v[112:115], v8 offset:2048
    v_mfma_f32_16x16x32_bf16 v[20:23], v[212:215], v[164:167], v[20:23]
    ds_read_b128 v[116:119], v8 offset:4096
    v_mfma_f32_16x16x32_bf16 v[64:67], v[216:219], v[164:167], v[64:67]
    ds_read_b128 v[120:123], v8 offset:6144
    v_mfma_f32_16x16x32_bf16 v[24:27], v[212:215], v[168:171], v[24:27]
    ds_read_b128 v[124:127], v8 offset:8192
    v_mfma_f32_16x16x32_bf16 v[68:71], v[216:219], v[168:171], v[68:71]
    ds_read_b128 v[128:131], v8 offset:10240
    v_mfma_f32_16x16x32_bf16 v[28:31], v[172:175], v[212:215], v[28:31]
    ds_read_b128 v[132:135], v8 offset:12288
    v_mfma_f32_16x16x32_bf16 v[72:75], v[172:175], v[216:219], v[72:75]
    ds_read_b128 v[136:139], v8 offset:14336
    v_mfma_f32_16x16x32_bf16 v[32:35], v[176:179], v[212:215], v[32:35]
    ds_read_b128 v[140:143], v8 offset:16384
    v_mfma_f32_16x16x32_bf16 v[76:79], v[176:179], v[216:219], v[76:79]
    ds_read_b128 v[144:147], v8 offset:18432
    v_mfma_f32_16x16x32_bf16 v[36:39], v[180:183], v[212:215], v[36:39]
    ds_read_b128 v[148:151], v8 offset:20480
    v_mfma_f32_16x16x32_bf16 v[80:83], v[180:183], v[216:219], v[80:83]
    v_mfma_f32_16x16x32_bf16 v[40:43], v[184:187], v[212:215], v[40:43]
    v_mfma_f32_16x16x32_bf16 v[84:87], v[184:187], v[216:219], v[84:87]
    v_mfma_f32_16x16x32_bf16 v[44:47], v[188:191], v[212:215], v[44:47]
    v_mfma_f32_16x16x32_bf16 v[88:91], v[188:191], v[216:219], v[88:91]
    v_mfma_f32_16x16x32_bf16 v[48:51], v[192:195], v[212:215], v[48:51]
    v_mfma_f32_16x16x32_bf16 v[92:95], v[192:195], v[216:219], v[92:95]
    v_mfma_f32_16x16x32_bf16 v[52:55], v[196:199], v[212:215], v[52:55]
    v_mfma_f32_16x16x32_bf16 v[96:99], v[196:199], v[216:219], v[96:99]
    s_mov_b32 s50, s51
    s_add_u32 s51, s51, 40960
    s_cmp_eq_u32 s51, 122880
    s_cselect_b32 s51, 0, s51
    s_add_u32 s53, s53, 2048
    v_add_u32 v2, s50, v1
    v_add_u32 v3, s50, v7
    v_add_u32 v8, s51, v1
    v_add_u32 v9, s51, v7
    s_waitcnt lgkmcnt(0)
    v_mfma_f32_16x16x32_bf16 v[12:15], v[204:207], v[108:111], v[12:15]
    ds_read_b128 v[212:215], v3 offset:1024
    v_mfma_f32_16x16x32_bf16 v[56:59], v[208:211], v[108:111], v[56:59]
    ds_read_b128 v[216:219], v3 offset:3072
    v_mfma_f32_16x16x32_bf16 v[16:19], v[204:207], v[112:115], v[16:19]
    ds_read_b128 v[156:159], v2 offset:1024
    v_mfma_f32_16x16x32_bf16 v[60:63], v[208:211], v[112:115], v[60:63]
    ds_read_b128 v[160:163], v2 offset:3072
    v_mfma_f32_16x16x32_bf16 v[20:23], v[204:207], v[116:119], v[20:23]
    ds_read_b128 v[164:167], v2 offset:5120
    v_mfma_f32_16x16x32_bf16 v[64:67], v[208:211], v[116:119], v[64:67]
    ds_read_b128 v[168:171], v2 offset:7168
    v_mfma_f32_16x16x32_bf16 v[24:27], v[204:207], v[120:123], v[24:27]
    ds_read_b128 v[172:175], v2 offset:9216
    v_mfma_f32_16x16x32_bf16 v[68:71], v[208:211], v[120:123], v[68:71]
    ds_read_b128 v[176:179], v2 offset:11264
    v_mfma_f32_16x16x32_bf16 v[28:31], v[124:127], v[204:207], v[28:31]
    ds_read_b128 v[180:183], v2 offset:13312
    v_mfma_f32_16x16x32_bf16 v[72:75], v[124:127], v[208:211], v[72:75]
    ds_read_b128 v[184:187], v2 offset:15360
    v_mfma_f32_16x16x32_bf16 v[32:35], v[128:131], v[204:207], v[32:35]
    ds_read_b128 v[188:191], v2 offset:17408
    v_mfma_f32_16x16x32_bf16 v[76:79], v[128:131], v[208:211], v[76:79]
    ds_read_b128 v[192:195], v2 offset:19456
    v_mfma_f32_16x16x32_bf16 v[36:39], v[132:135], v[204:207], v[36:39]
    ds_read_b128 v[196:199], v2 offset:21504
    v_mfma_f32_16x16x32_bf16 v[80:83], v[132:135], v[208:211], v[80:83]
    v_mfma_f32_16x16x32_bf16 v[40:43], v[136:139], v[204:207], v[40:43]
    v_mfma_f32_16x16x32_bf16 v[84:87], v[136:139], v[208:211], v[84:87]
    v_mfma_f32_16x16x32_bf16 v[44:47], v[140:143], v[204:207], v[44:47]
    v_mfma_f32_16x16x32_bf16 v[88:91], v[140:143], v[208:211], v[88:91]
    v_mfma_f32_16x16x32_bf16 v[48:51], v[144:147], v[204:207], v[48:51]
    v_mfma_f32_16x16x32_bf16 v[92:95], v[144:147], v[208:211], v[92:95]
    v_mfma_f32_16x16x32_bf16 v[52:55], v[148:151], v[204:207], v[52:55]
    v_mfma_f32_16x16x32_bf16 v[96:99], v[148:151], v[208:211], v[96:99]
    s_waitcnt lgkmcnt(0)
    v_mfma_f32_16x16x32_bf16 v[12:15], v[212:215], v[156:159], v[12:15]
    v_mfma_f32_16x16x32_bf16 v[56:59], v[216:219], v[156:159], v[56:59]
    v_mfma_f32_16x16x32_bf16 v[16:19], v[212:215], v[160:163], v[16:19]
    v_mfma_f32_16x16x32_bf16 v[60:63], v[216:219], v[160:163], v[60:63]
    v_mfma_f32_16x16x32_bf16 v[20:23], v[212:215], v[164:167], v[20:23]
    v_mfma_f32_16x16x32_bf16 v[64:67], v[216:219], v[164:167], v[64:67]
    v_mfma_f32_16x16x32_bf16 v[24:27], v[212:215], v[168:171], v[24:27]
    v_mfma_f32_16x16x32_bf16 v[68:71], v[216:219], v[168:171], v[68:71]
    v_mfma_f32_16x16x32_bf16 v[28:31], v[172:175], v[212:215], v[28:31]
    v_mfma_f32_16x16x32_bf16 v[72:75], v[172:175], v[216:219], v[72:75]
    v_mfma_f32_16x16x32_bf16 v[32:35], v[176:179], v[212:215], v[32:35]
    v_mfma_f32_16x16x32_bf16 v[76:79], v[176:179], v[216:219], v[76:79]
    v_mfma_f32_16x16x32_bf16 v[36:39], v[180:183], v[212:215], v[36:39]
    v_mfma_f32_16x16x32_bf16 v[80:83], v[180:183], v[216:219], v[80:83]
    v_mfma_f32_16x16x32_bf16 v[40:43], v[184:187], v[212:215], v[40:43]
    v_mfma_f32_16x16x32_bf16 v[84:87], v[184:187], v[216:219], v[84:87]
    v_mfma_f32_16x16x32_bf16 v[44:47], v[188:191], v[212:215], v[44:47]
    v_mfma_f32_16x16x32_bf16 v[88:91], v[188:191], v[216:219], v[88:91]
    v_mfma_f32_16x16x32_bf16 v[48:51], v[192:195], v[212:215], v[48:51]
    v_mfma_f32_16x16x32_bf16 v[92:95], v[192:195], v[216:219], v[92:95]
    v_mfma_f32_16x16x32_bf16 v[52:55], v[196:199], v[212:215], v[52:55]
    v_mfma_f32_16x16x32_bf16 v[96:99], v[196:199], v[216:219], v[96:99]
    v_lshlrev_b32 v7, 6, v5
    v_add_u32 v7, 122880, v7
    s_lshl_b32 s3, s28, 3
    v_add_u32 v8, s3, v6
    v_mul_u32_u24 v8, 256, v8
    v_lshl_add_u32 v8, v5, 3, v8
    v_add_u32 v9, 1024, v8
    s_nop 7
    ds_read_b128 v[108:111], v7 offset:0
    ds_read_b128 v[112:115], v7 offset:16
    ds_read_b128 v[116:119], v7 offset:32
    ds_read_b128 v[120:123], v7 offset:1024
    ds_read_b128 v[124:127], v7 offset:1040
    ds_read_b128 v[128:131], v7 offset:1056
    s_barrier
    s_waitcnt lgkmcnt(0)
    v_sub_f32 v118, 0, v114
    v_sub_f32 v130, 0, v126
    v_fmac_f32 v13, v110, v12
    v_fmac_f32 v57, v110, v56
    v_fmac_f32 v21, v122, v20
    v_fmac_f32 v65, v122, v64
    v_fmac_f32 v17, v110, v16
    v_fmac_f32 v61, v110, v60
    v_fmac_f32 v25, v122, v24
    v_fmac_f32 v69, v122, v68
    v_fmac_f32 v13, v118, v16
    v_fmac_f32 v57, v118, v60
    v_fmac_f32 v21, v130, v24
    v_fmac_f32 v65, v130, v68
    v_fmac_f32 v17, v114, v12
    v_fmac_f32 v61, v114, v56
    v_fmac_f32 v25, v126, v20
    v_fmac_f32 v69, v126, v64
    v_fmac_f32 v14, v110, v13
    v_fmac_f32 v58, v110, v57
    v_fmac_f32 v22, v122, v21
    v_fmac_f32 v66, v122, v65
    v_fmac_f32 v18, v110, v17
    v_fmac_f32 v62, v110, v61
    v_fmac_f32 v26, v122, v25
    v_fmac_f32 v70, v122, v69
    v_fmac_f32 v14, v118, v17
    v_fmac_f32 v58, v118, v61
    v_fmac_f32 v22, v130, v25
    v_fmac_f32 v66, v130, v69
    v_fmac_f32 v18, v114, v13
    v_fmac_f32 v62, v114, v57
    v_fmac_f32 v26, v126, v21
    v_fmac_f32 v70, v126, v65
    v_fmac_f32 v15, v110, v14
    v_fmac_f32 v59, v110, v58
    v_fmac_f32 v23, v122, v22
    v_fmac_f32 v67, v122, v66
    v_fmac_f32 v19, v110, v18
    v_fmac_f32 v63, v110, v62
    v_fmac_f32 v27, v122, v26
    v_fmac_f32 v71, v122, v70
    v_fmac_f32 v15, v118, v18
    v_fmac_f32 v59, v118, v62
    v_fmac_f32 v23, v130, v26
    v_fmac_f32 v67, v130, v70
    v_fmac_f32 v19, v114, v14
    v_fmac_f32 v63, v114, v58
    v_fmac_f32 v27, v126, v22
    v_fmac_f32 v71, v126, v66
    ds_write2_b32 v8, v15, v19 offset0:0 offset1:1
    ds_write2_b32 v9, v59, v63 offset0:0 offset1:1
    ds_write2_b32 v8, v23, v27 offset0:32 offset1:33
    ds_write2_b32 v9, v67, v71 offset0:32 offset1:33
    s_mul_i32 s3, s28, 8
    v_add_u32 v247, s3, v4
    v_lshlrev_b32 v244, 3, v247
    v_lshrrev_b32 v245, 4, v247
    v_lshlrev_b32 v245, 12, v245
    v_and_b32 v246, 15, v247
    v_lshl_add_u32 v245, v246, 4, v245
    v_lshlrev_b32 v247, 6, v247
    v_add_u32 v247, 122880, v247
    s_lshl_b32 s42, s30, 12
    s_lshl_b32 s3, s29, 8
    s_add_u32 s3, s3, s42
    s_waitcnt lgkmcnt(0)
    s_barrier
    s_mov_b64 exec, 0xff
    ds_read_b32 v236, v247 offset:20
    ds_read_b32 v237, v247 offset:36
    ds_read_b64 v[238:239], v247 offset:40
    ds_read_b64 v[168:169], v244 offset:0
    ds_read_b64 v[170:171], v244 offset:256
    ds_read_b64 v[172:173], v244 offset:512
    ds_read_b64 v[174:175], v244 offset:768
    ds_read_b64 v[176:177], v244 offset:1024
    ds_read_b64 v[178:179], v244 offset:1280
    ds_read_b64 v[180:181], v244 offset:1536
    ds_read_b64 v[182:183], v244 offset:1792
    ds_read_b64 v[184:185], v244 offset:2048
    ds_read_b64 v[186:187], v244 offset:2304
    ds_read_b64 v[188:189], v244 offset:2560
    ds_read_b64 v[190:191], v244 offset:2816
    ds_read_b64 v[192:193], v244 offset:3072
    ds_read_b64 v[194:195], v244 offset:3328
    ds_read_b64 v[196:197], v244 offset:3584
    ds_read_b64 v[198:199], v244 offset:3840
    ds_read_b64 v[200:201], v244 offset:4096
    ds_read_b64 v[202:203], v244 offset:4352
    ds_read_b64 v[204:205], v244 offset:4608
    ds_read_b64 v[206:207], v244 offset:4864
    ds_read_b64 v[208:209], v244 offset:5120
    ds_read_b64 v[210:211], v244 offset:5376
    ds_read_b64 v[212:213], v244 offset:5632
    ds_read_b64 v[214:215], v244 offset:5888
    ds_read_b64 v[216:217], v244 offset:6144
    ds_read_b64 v[218:219], v244 offset:6400
    ds_read_b64 v[220:221], v244 offset:6656
    ds_read_b64 v[222:223], v244 offset:6912
    ds_read_b64 v[224:225], v244 offset:7168
    ds_read_b64 v[226:227], v244 offset:7424
    ds_read_b64 v[228:229], v244 offset:7680
    ds_read_b64 v[230:231], v244 offset:7936
    v_mov_b32 v234, 0
    v_mov_b32 v235, 0
    ds_write_b64 v244, v[234:235] offset:12288
    v_mov_b32 v241, 1
    v_mov_b32 v243, 1
    s_waitcnt lgkmcnt(1)
    ds_write_b64 v244, v[168:169] offset:12544
    v_pk_fma_f32 v[234:235], v[236:237], v[168:169], v[170:171] op_sel:[0,0,0] op_sel_hi:[0,1,1]
    v_pk_fma_f32 v[234:235], v[236:237], v[168:169], v[234:235] op_sel:[1,1,0] op_sel_hi:[1,0,1] neg_lo:[1,0,0] neg_hi:[0,0,0]
    ds_write_b64 v244, v[234:235] offset:12800
    v_pk_fma_f32 v[232:233], v[236:237], v[234:235], v[172:173] op_sel:[0,0,0] op_sel_hi:[0,1,1]
    v_pk_fma_f32 v[232:233], v[236:237], v[234:235], v[232:233] op_sel:[1,1,0] op_sel_hi:[1,0,1] neg_lo:[1,0,0] neg_hi:[0,0,0]
    ds_write_b64 v244, v[232:233] offset:13056
    v_pk_fma_f32 v[234:235], v[236:237], v[232:233], v[174:175] op_sel:[0,0,0] op_sel_hi:[0,1,1]
    v_pk_fma_f32 v[234:235], v[236:237], v[232:233], v[234:235] op_sel:[1,1,0] op_sel_hi:[1,0,1] neg_lo:[1,0,0] neg_hi:[0,0,0]
    ds_write_b64 v244, v[234:235] offset:13312
    v_pk_fma_f32 v[232:233], v[236:237], v[234:235], v[176:177] op_sel:[0,0,0] op_sel_hi:[0,1,1]
    v_pk_fma_f32 v[232:233], v[236:237], v[234:235], v[232:233] op_sel:[1,1,0] op_sel_hi:[1,0,1] neg_lo:[1,0,0] neg_hi:[0,0,0]
    ds_write_b64 v244, v[232:233] offset:13568
    v_pk_fma_f32 v[234:235], v[236:237], v[232:233], v[178:179] op_sel:[0,0,0] op_sel_hi:[0,1,1]
    v_pk_fma_f32 v[234:235], v[236:237], v[232:233], v[234:235] op_sel:[1,1,0] op_sel_hi:[1,0,1] neg_lo:[1,0,0] neg_hi:[0,0,0]
    ds_write_b64 v244, v[234:235] offset:13824
    v_pk_fma_f32 v[232:233], v[236:237], v[234:235], v[180:181] op_sel:[0,0,0] op_sel_hi:[0,1,1]
    v_pk_fma_f32 v[232:233], v[236:237], v[234:235], v[232:233] op_sel:[1,1,0] op_sel_hi:[1,0,1] neg_lo:[1,0,0] neg_hi:[0,0,0]
    ds_write_b64 v244, v[232:233] offset:14080
    v_pk_fma_f32 v[234:235], v[236:237], v[232:233], v[182:183] op_sel:[0,0,0] op_sel_hi:[0,1,1]
    v_pk_fma_f32 v[234:235], v[236:237], v[232:233], v[234:235] op_sel:[1,1,0] op_sel_hi:[1,0,1] neg_lo:[1,0,0] neg_hi:[0,0,0]
    ds_write_b64 v244, v[234:235] offset:14336
    v_pk_fma_f32 v[232:233], v[236:237], v[234:235], v[184:185] op_sel:[0,0,0] op_sel_hi:[0,1,1]
    v_pk_fma_f32 v[232:233], v[236:237], v[234:235], v[232:233] op_sel:[1,1,0] op_sel_hi:[1,0,1] neg_lo:[1,0,0] neg_hi:[0,0,0]
    ds_write_b64 v244, v[232:233] offset:14592
    v_pk_fma_f32 v[234:235], v[236:237], v[232:233], v[186:187] op_sel:[0,0,0] op_sel_hi:[0,1,1]
    v_pk_fma_f32 v[234:235], v[236:237], v[232:233], v[234:235] op_sel:[1,1,0] op_sel_hi:[1,0,1] neg_lo:[1,0,0] neg_hi:[0,0,0]
    ds_write_b64 v244, v[234:235] offset:14848
    v_pk_fma_f32 v[232:233], v[236:237], v[234:235], v[188:189] op_sel:[0,0,0] op_sel_hi:[0,1,1]
    v_pk_fma_f32 v[232:233], v[236:237], v[234:235], v[232:233] op_sel:[1,1,0] op_sel_hi:[1,0,1] neg_lo:[1,0,0] neg_hi:[0,0,0]
    ds_write_b64 v244, v[232:233] offset:15104
    v_pk_fma_f32 v[234:235], v[236:237], v[232:233], v[190:191] op_sel:[0,0,0] op_sel_hi:[0,1,1]
    v_pk_fma_f32 v[234:235], v[236:237], v[232:233], v[234:235] op_sel:[1,1,0] op_sel_hi:[1,0,1] neg_lo:[1,0,0] neg_hi:[0,0,0]
    ds_write_b64 v244, v[234:235] offset:15360
    v_pk_fma_f32 v[232:233], v[236:237], v[234:235], v[192:193] op_sel:[0,0,0] op_sel_hi:[0,1,1]
    v_pk_fma_f32 v[232:233], v[236:237], v[234:235], v[232:233] op_sel:[1,1,0] op_sel_hi:[1,0,1] neg_lo:[1,0,0] neg_hi:[0,0,0]
    ds_write_b64 v244, v[232:233] offset:15616
    v_pk_fma_f32 v[234:235], v[236:237], v[232:233], v[194:195] op_sel:[0,0,0] op_sel_hi:[0,1,1]
    v_pk_fma_f32 v[234:235], v[236:237], v[232:233], v[234:235] op_sel:[1,1,0] op_sel_hi:[1,0,1] neg_lo:[1,0,0] neg_hi:[0,0,0]
    ds_write_b64 v244, v[234:235] offset:15872
    v_pk_fma_f32 v[232:233], v[236:237], v[234:235], v[196:197] op_sel:[0,0,0] op_sel_hi:[0,1,1]
    v_pk_fma_f32 v[232:233], v[236:237], v[234:235], v[232:233] op_sel:[1,1,0] op_sel_hi:[1,0,1] neg_lo:[1,0,0] neg_hi:[0,0,0]
    ds_write_b64 v244, v[232:233] offset:16128
    v_pk_fma_f32 v[234:235], v[236:237], v[232:233], v[198:199] op_sel:[0,0,0] op_sel_hi:[0,1,1]
    v_pk_fma_f32 v[234:235], v[236:237], v[232:233], v[234:235] op_sel:[1,1,0] op_sel_hi:[1,0,1] neg_lo:[1,0,0] neg_hi:[0,0,0]
    ds_write_b64 v244, v[234:235] offset:16384
    v_pk_fma_f32 v[232:233], v[236:237], v[234:235], v[200:201] op_sel:[0,0,0] op_sel_hi:[0,1,1]
    v_pk_fma_f32 v[232:233], v[236:237], v[234:235], v[232:233] op_sel:[1,1,0] op_sel_hi:[1,0,1] neg_lo:[1,0,0] neg_hi:[0,0,0]
    ds_write_b64 v244, v[232:233] offset:16640
    v_pk_fma_f32 v[234:235], v[236:237], v[232:233], v[202:203] op_sel:[0,0,0] op_sel_hi:[0,1,1]
    v_pk_fma_f32 v[234:235], v[236:237], v[232:233], v[234:235] op_sel:[1,1,0] op_sel_hi:[1,0,1] neg_lo:[1,0,0] neg_hi:[0,0,0]
    ds_write_b64 v244, v[234:235] offset:16896
    v_pk_fma_f32 v[232:233], v[236:237], v[234:235], v[204:205] op_sel:[0,0,0] op_sel_hi:[0,1,1]
    v_pk_fma_f32 v[232:233], v[236:237], v[234:235], v[232:233] op_sel:[1,1,0] op_sel_hi:[1,0,1] neg_lo:[1,0,0] neg_hi:[0,0,0]
    ds_write_b64 v244, v[232:233] offset:17152
    v_pk_fma_f32 v[234:235], v[236:237], v[232:233], v[206:207] op_sel:[0,0,0] op_sel_hi:[0,1,1]
    v_pk_fma_f32 v[234:235], v[236:237], v[232:233], v[234:235] op_sel:[1,1,0] op_sel_hi:[1,0,1] neg_lo:[1,0,0] neg_hi:[0,0,0]
    ds_write_b64 v244, v[234:235] offset:17408
    v_pk_fma_f32 v[232:233], v[236:237], v[234:235], v[208:209] op_sel:[0,0,0] op_sel_hi:[0,1,1]
    v_pk_fma_f32 v[232:233], v[236:237], v[234:235], v[232:233] op_sel:[1,1,0] op_sel_hi:[1,0,1] neg_lo:[1,0,0] neg_hi:[0,0,0]
    ds_write_b64 v244, v[232:233] offset:17664
    v_pk_fma_f32 v[234:235], v[236:237], v[232:233], v[210:211] op_sel:[0,0,0] op_sel_hi:[0,1,1]
    v_pk_fma_f32 v[234:235], v[236:237], v[232:233], v[234:235] op_sel:[1,1,0] op_sel_hi:[1,0,1] neg_lo:[1,0,0] neg_hi:[0,0,0]
    ds_write_b64 v244, v[234:235] offset:17920
    v_pk_fma_f32 v[232:233], v[236:237], v[234:235], v[212:213] op_sel:[0,0,0] op_sel_hi:[0,1,1]
    v_pk_fma_f32 v[232:233], v[236:237], v[234:235], v[232:233] op_sel:[1,1,0] op_sel_hi:[1,0,1] neg_lo:[1,0,0] neg_hi:[0,0,0]
    ds_write_b64 v244, v[232:233] offset:18176
    v_pk_fma_f32 v[234:235], v[236:237], v[232:233], v[214:215] op_sel:[0,0,0] op_sel_hi:[0,1,1]
    v_pk_fma_f32 v[234:235], v[236:237], v[232:233], v[234:235] op_sel:[1,1,0] op_sel_hi:[1,0,1] neg_lo:[1,0,0] neg_hi:[0,0,0]
    ds_write_b64 v244, v[234:235] offset:18432
    v_pk_fma_f32 v[232:233], v[236:237], v[234:235], v[216:217] op_sel:[0,0,0] op_sel_hi:[0,1,1]
    v_pk_fma_f32 v[232:233], v[236:237], v[234:235], v[232:233] op_sel:[1,1,0] op_sel_hi:[1,0,1] neg_lo:[1,0,0] neg_hi:[0,0,0]
    ds_write_b64 v244, v[232:233] offset:18688
    v_pk_fma_f32 v[234:235], v[236:237], v[232:233], v[218:219] op_sel:[0,0,0] op_sel_hi:[0,1,1]
    v_pk_fma_f32 v[234:235], v[236:237], v[232:233], v[234:235] op_sel:[1,1,0] op_sel_hi:[1,0,1] neg_lo:[1,0,0] neg_hi:[0,0,0]
    ds_write_b64 v244, v[234:235] offset:18944
    v_pk_fma_f32 v[232:233], v[236:237], v[234:235], v[220:221] op_sel:[0,0,0] op_sel_hi:[0,1,1]
    v_pk_fma_f32 v[232:233], v[236:237], v[234:235], v[232:233] op_sel:[1,1,0] op_sel_hi:[1,0,1] neg_lo:[1,0,0] neg_hi:[0,0,0]
    ds_write_b64 v244, v[232:233] offset:19200
    v_pk_fma_f32 v[234:235], v[236:237], v[232:233], v[222:223] op_sel:[0,0,0] op_sel_hi:[0,1,1]
    v_pk_fma_f32 v[234:235], v[236:237], v[232:233], v[234:235] op_sel:[1,1,0] op_sel_hi:[1,0,1] neg_lo:[1,0,0] neg_hi:[0,0,0]
    ds_write_b64 v244, v[234:235] offset:19456
    v_pk_fma_f32 v[232:233], v[236:237], v[234:235], v[224:225] op_sel:[0,0,0] op_sel_hi:[0,1,1]
    v_pk_fma_f32 v[232:233], v[236:237], v[234:235], v[232:233] op_sel:[1,1,0] op_sel_hi:[1,0,1] neg_lo:[1,0,0] neg_hi:[0,0,0]
    ds_write_b64 v244, v[232:233] offset:19712
    v_pk_fma_f32 v[234:235], v[236:237], v[232:233], v[226:227] op_sel:[0,0,0] op_sel_hi:[0,1,1]
    v_pk_fma_f32 v[234:235], v[236:237], v[232:233], v[234:235] op_sel:[1,1,0] op_sel_hi:[1,0,1] neg_lo:[1,0,0] neg_hi:[0,0,0]
    ds_write_b64 v244, v[234:235] offset:19968
    v_pk_fma_f32 v[232:233], v[236:237], v[234:235], v[228:229] op_sel:[0,0,0] op_sel_hi:[0,1,1]
    v_pk_fma_f32 v[232:233], v[236:237], v[234:235], v[232:233] op_sel:[1,1,0] op_sel_hi:[1,0,1] neg_lo:[1,0,0] neg_hi:[0,0,0]
    ds_write_b64 v244, v[232:233] offset:20224
    v_pk_fma_f32 v[234:235], v[236:237], v[232:233], v[230:231] op_sel:[0,0,0] op_sel_hi:[0,1,1]
    v_pk_fma_f32 v[234:235], v[236:237], v[232:233], v[234:235] op_sel:[1,1,0] op_sel_hi:[1,0,1] neg_lo:[1,0,0] neg_hi:[0,0,0]
    v_mov_b32 v240, v234
    v_mov_b32 v242, v235
    buffer_store_dwordx4 v[240:243], v245, s[20:23], s3 offen sc0 sc1
    s_mov_b64 exec, -1
    v_pk_mul_f32 v[248:249], v[108:109], v[16:17] op_sel:[1,0] op_sel_hi:[1,1]
    v_pk_mul_f32 v[250:251], v[108:109], v[60:61] op_sel:[1,0] op_sel_hi:[1,1]
    v_pk_mul_f32 v[252:253], v[120:121], v[24:25] op_sel:[1,0] op_sel_hi:[1,1]
    v_pk_mul_f32 v[10:11], v[120:121], v[68:69] op_sel:[1,0] op_sel_hi:[1,1]
    v_pk_mul_f32 v[16:17], v[108:109], v[16:17] op_sel:[0,0] op_sel_hi:[0,1]
    v_pk_mul_f32 v[60:61], v[108:109], v[60:61] op_sel:[0,0] op_sel_hi:[0,1]
    v_pk_mul_f32 v[24:25], v[120:121], v[24:25] op_sel:[0,0] op_sel_hi:[0,1]
    v_pk_mul_f32 v[68:69], v[120:121], v[68:69] op_sel:[0,0] op_sel_hi:[0,1]
    v_pk_fma_f32 v[16:17], v[108:109], v[12:13], v[16:17] op_sel:[1,0,0] op_sel_hi:[1,1,1]
    v_pk_fma_f32 v[60:61], v[108:109], v[56:57], v[60:61] op_sel:[1,0,0] op_sel_hi:[1,1,1]
    v_pk_fma_f32 v[24:25], v[120:121], v[20:21], v[24:25] op_sel:[1,0,0] op_sel_hi:[1,1,1]
    v_pk_fma_f32 v[68:69], v[120:121], v[64:65], v[68:69] op_sel:[1,0,0] op_sel_hi:[1,1,1]
    v_pk_fma_f32 v[12:13], v[108:109], v[12:13], v[248:249] op_sel:[0,0,0] op_sel_hi:[0,1,1] neg_lo:[0,0,1] neg_hi:[0,0,1]
    v_pk_fma_f32 v[56:57], v[108:109], v[56:57], v[250:251] op_sel:[0,0,0] op_sel_hi:[0,1,1] neg_lo:[0,0,1] neg_hi:[0,0,1]
    v_pk_fma_f32 v[20:21], v[120:121], v[20:21], v[252:253] op_sel:[0,0,0] op_sel_hi:[0,1,1] neg_lo:[0,0,1] neg_hi:[0,0,1]
    v_pk_fma_f32 v[64:65], v[120:121], v[64:65], v[10:11] op_sel:[0,0,0] op_sel_hi:[0,1,1] neg_lo:[0,0,1] neg_hi:[0,0,1]
    v_pk_mul_f32 v[248:249], v[108:109], v[18:19] op_sel:[1,0] op_sel_hi:[1,1]
    v_pk_mul_f32 v[250:251], v[108:109], v[62:63] op_sel:[1,0] op_sel_hi:[1,1]
    v_pk_mul_f32 v[252:253], v[120:121], v[26:27] op_sel:[1,0] op_sel_hi:[1,1]
    v_pk_mul_f32 v[10:11], v[120:121], v[70:71] op_sel:[1,0] op_sel_hi:[1,1]
    v_pk_mul_f32 v[18:19], v[108:109], v[18:19] op_sel:[0,0] op_sel_hi:[0,1]
    v_pk_mul_f32 v[62:63], v[108:109], v[62:63] op_sel:[0,0] op_sel_hi:[0,1]
    v_pk_mul_f32 v[26:27], v[120:121], v[26:27] op_sel:[0,0] op_sel_hi:[0,1]
    v_pk_mul_f32 v[70:71], v[120:121], v[70:71] op_sel:[0,0] op_sel_hi:[0,1]
    v_pk_fma_f32 v[18:19], v[108:109], v[14:15], v[18:19] op_sel:[1,0,0] op_sel_hi:[1,1,1]
    v_pk_fma_f32 v[62:63], v[108:109], v[58:59], v[62:63] op_sel:[1,0,0] op_sel_hi:[1,1,1]
    v_pk_fma_f32 v[26:27], v[120:121], v[22:23], v[26:27] op_sel:[1,0,0] op_sel_hi:[1,1,1]
    v_pk_fma_f32 v[70:71], v[120:121], v[66:67], v[70:71] op_sel:[1,0,0] op_sel_hi:[1,1,1]
    v_pk_fma_f32 v[14:15], v[108:109], v[14:15], v[248:249] op_sel:[0,0,0] op_sel_hi:[0,1,1] neg_lo:[0,0,1] neg_hi:[0,0,1]
    v_pk_fma_f32 v[58:59], v[108:109], v[58:59], v[250:251] op_sel:[0,0,0] op_sel_hi:[0,1,1] neg_lo:[0,0,1] neg_hi:[0,0,1]
    v_pk_fma_f32 v[22:23], v[120:121], v[22:23], v[252:253] op_sel:[0,0,0] op_sel_hi:[0,1,1] neg_lo:[0,0,1] neg_hi:[0,0,1]
    v_pk_fma_f32 v[66:67], v[120:121], v[66:67], v[10:11] op_sel:[0,0,0] op_sel_hi:[0,1,1] neg_lo:[0,0,1] neg_hi:[0,0,1]
    v_lshlrev_b32 v7, 4, v5
    v_and_b32 v10, 1, v6
    v_lshl_add_u32 v7, v10, 3, v7
    v_lshrrev_b32 v10, 1, v6
    v_lshl_add_u32 v7, v10, 8, v7
    s_mul_i32 s36, s45, 49152
    s_lshl_b32 s4, s46, 9
    s_add_u32 s36, s36, s4
    s_add_u32 s37, s36, 49152
    s_mov_b32 s4, 0xbfb8aa3b
    s_mov_b32 s5, s4
    v_cvt_pk_bf16_f32 v144, v28, v29
    v_cvt_pk_bf16_f32 v145, v30, v31
    v_cvt_pk_bf16_f32 v156, v32, v33
    v_cvt_pk_bf16_f32 v157, v34, v35
    v_lshlrev_b32 v28, 16, v144
    v_and_b32 v29, 0xffff0000, v144
    v_lshlrev_b32 v30, 16, v145
    v_and_b32 v31, 0xffff0000, v145
    v_lshlrev_b32 v32, 16, v156
    v_and_b32 v33, 0xffff0000, v156
    v_lshlrev_b32 v34, 16, v157
    v_and_b32 v35, 0xffff0000, v157
    v_pk_mul_f32 v[146:147], v[28:29], s[4:5]
    v_pk_mul_f32 v[148:149], v[30:31], s[4:5]
    v_pk_mul_f32 v[158:159], v[32:33], s[4:5]
    v_pk_mul_f32 v[160:161], v[34:35], s[4:5]
    v_exp_f32 v146, v146
    v_exp_f32 v147, v147
    v_exp_f32 v148, v148
    v_exp_f32 v149, v149
    v_exp_f32 v158, v158
    v_exp_f32 v159, v159
    v_exp_f32 v160, v160
    v_exp_f32 v161, v161
    v_pk_add_f32 v[146:147], v[146:147], 1.0 op_sel_hi:[1,0]
    v_pk_add_f32 v[148:149], v[148:149], 1.0 op_sel_hi:[1,0]
    v_pk_add_f32 v[158:159], v[158:159], 1.0 op_sel_hi:[1,0]
    v_pk_add_f32 v[160:161], v[160:161], 1.0 op_sel_hi:[1,0]
    v_rcp_f32 v146, v146
    v_rcp_f32 v147, v147
    v_rcp_f32 v148, v148
    v_rcp_f32 v149, v149
    v_rcp_f32 v158, v158
    v_rcp_f32 v159, v159
    v_rcp_f32 v160, v160
    v_rcp_f32 v161, v161
    v_pk_mul_f32 v[146:147], v[146:147], v[28:29] op_sel:[0,0] op_sel_hi:[1,1]
    v_pk_mul_f32 v[148:149], v[148:149], v[30:31] op_sel:[0,0] op_sel_hi:[1,1]
    v_pk_mul_f32 v[158:159], v[158:159], v[32:33] op_sel:[0,0] op_sel_hi:[1,1]
    v_pk_mul_f32 v[160:161], v[160:161], v[34:35] op_sel:[0,0] op_sel_hi:[1,1]
    v_cvt_pk_bf16_f32 v150, v146, v147
    v_cvt_pk_bf16_f32 v151, v148, v149
    v_cvt_pk_bf16_f32 v162, v158, v159
    v_cvt_pk_bf16_f32 v163, v160, v161
    buffer_store_dwordx2 v[150:151], v7, s[56:59], s36 offen offset:0 sc1
    buffer_store_dwordx2 v[162:163], v7, s[56:59], s36 offen offset:512 sc1
    v_cvt_pk_bf16_f32 v144, v36, v37
    v_cvt_pk_bf16_f32 v145, v38, v39
    v_cvt_pk_bf16_f32 v156, v40, v41
    v_cvt_pk_bf16_f32 v157, v42, v43
    v_lshlrev_b32 v36, 16, v144
    v_and_b32 v37, 0xffff0000, v144
    v_lshlrev_b32 v38, 16, v145
    v_and_b32 v39, 0xffff0000, v145
    v_lshlrev_b32 v40, 16, v156
    v_and_b32 v41, 0xffff0000, v156
    v_lshlrev_b32 v42, 16, v157
    v_and_b32 v43, 0xffff0000, v157
    v_pk_mul_f32 v[146:147], v[36:37], s[4:5]
    v_pk_mul_f32 v[148:149], v[38:39], s[4:5]
    v_pk_mul_f32 v[158:159], v[40:41], s[4:5]
    v_pk_mul_f32 v[160:161], v[42:43], s[4:5]
    v_exp_f32 v146, v146
    v_exp_f32 v147, v147
    v_exp_f32 v148, v148
    v_exp_f32 v149, v149
    v_exp_f32 v158, v158
    v_exp_f32 v159, v159
    v_exp_f32 v160, v160
    v_exp_f32 v161, v161
    v_pk_add_f32 v[146:147], v[146:147], 1.0 op_sel_hi:[1,0]
    v_pk_add_f32 v[148:149], v[148:149], 1.0 op_sel_hi:[1,0]
    v_pk_add_f32 v[158:159], v[158:159], 1.0 op_sel_hi:[1,0]
    v_pk_add_f32 v[160:161], v[160:161], 1.0 op_sel_hi:[1,0]
    v_rcp_f32 v146, v146
    v_rcp_f32 v147, v147
    v_rcp_f32 v148, v148
    v_rcp_f32 v149, v149
    v_rcp_f32 v158, v158
    v_rcp_f32 v159, v159
    v_rcp_f32 v160, v160
    v_rcp_f32 v161, v161
    v_pk_mul_f32 v[146:147], v[146:147], v[36:37] op_sel:[0,0] op_sel_hi:[1,1]
    v_pk_mul_f32 v[148:149], v[148:149], v[38:39] op_sel:[0,0] op_sel_hi:[1,1]
    v_pk_mul_f32 v[158:159], v[158:159], v[40:41] op_sel:[0,0] op_sel_hi:[1,1]
    v_pk_mul_f32 v[160:161], v[160:161], v[42:43] op_sel:[0,0] op_sel_hi:[1,1]
    v_cvt_pk_bf16_f32 v150, v146, v147
    v_cvt_pk_bf16_f32 v151, v148, v149
    v_cvt_pk_bf16_f32 v162, v158, v159
    v_cvt_pk_bf16_f32 v163, v160, v161
    buffer_store_dwordx2 v[150:151], v7, s[56:59], s36 offen offset:1024 sc1
    buffer_store_dwordx2 v[162:163], v7, s[56:59], s36 offen offset:1536 sc1
    v_cvt_pk_bf16_f32 v144, v44, v45
    v_cvt_pk_bf16_f32 v145, v46, v47
    v_cvt_pk_bf16_f32 v156, v48, v49
    v_cvt_pk_bf16_f32 v157, v50, v51
    v_lshlrev_b32 v44, 16, v144
    v_and_b32 v45, 0xffff0000, v144
    v_lshlrev_b32 v46, 16, v145
    v_and_b32 v47, 0xffff0000, v145
    v_lshlrev_b32 v48, 16, v156
    v_and_b32 v49, 0xffff0000, v156
    v_lshlrev_b32 v50, 16, v157
    v_and_b32 v51, 0xffff0000, v157
    v_pk_mul_f32 v[146:147], v[44:45], s[4:5]
    v_pk_mul_f32 v[148:149], v[46:47], s[4:5]
    v_pk_mul_f32 v[158:159], v[48:49], s[4:5]
    v_pk_mul_f32 v[160:161], v[50:51], s[4:5]
    v_exp_f32 v146, v146
    v_exp_f32 v147, v147
    v_exp_f32 v148, v148
    v_exp_f32 v149, v149
    v_exp_f32 v158, v158
    v_exp_f32 v159, v159
    v_exp_f32 v160, v160
    v_exp_f32 v161, v161
    v_pk_add_f32 v[146:147], v[146:147], 1.0 op_sel_hi:[1,0]
    v_pk_add_f32 v[148:149], v[148:149], 1.0 op_sel_hi:[1,0]
    v_pk_add_f32 v[158:159], v[158:159], 1.0 op_sel_hi:[1,0]
    v_pk_add_f32 v[160:161], v[160:161], 1.0 op_sel_hi:[1,0]
    v_rcp_f32 v146, v146
    v_rcp_f32 v147, v147
    v_rcp_f32 v148, v148
    v_rcp_f32 v149, v149
    v_rcp_f32 v158, v158
    v_rcp_f32 v159, v159
    v_rcp_f32 v160, v160
    v_rcp_f32 v161, v161
    v_pk_mul_f32 v[146:147], v[146:147], v[44:45] op_sel:[0,0] op_sel_hi:[1,1]
    v_pk_mul_f32 v[148:149], v[148:149], v[46:47] op_sel:[0,0] op_sel_hi:[1,1]
    v_pk_mul_f32 v[158:159], v[158:159], v[48:49] op_sel:[0,0] op_sel_hi:[1,1]
    v_pk_mul_f32 v[160:161], v[160:161], v[50:51] op_sel:[0,0] op_sel_hi:[1,1]
    v_cvt_pk_bf16_f32 v150, v146, v147
    v_cvt_pk_bf16_f32 v151, v148, v149
    v_cvt_pk_bf16_f32 v162, v158, v159
    v_cvt_pk_bf16_f32 v163, v160, v161
    buffer_store_dwordx2 v[150:151], v7, s[56:59], s36 offen offset:2048 sc1
    buffer_store_dwordx2 v[162:163], v7, s[56:59], s36 offen offset:2560 sc1
    s_mov_b64 exec, 0xff
    s_cmp_le_u32 s29, 0
    s_cbranch_scc1 K1_LD0B
    buffer_load_dwordx4 v[168:171], v245, s[20:23], s42 offen offset:0 sc0 sc1
    s_cmp_le_u32 s29, 1
    s_cbranch_scc1 K1_LD0B
    buffer_load_dwordx4 v[172:175], v245, s[20:23], s42 offen offset:256 sc0 sc1
    s_cmp_le_u32 s29, 2
    s_cbranch_scc1 K1_LD0B
    buffer_load_dwordx4 v[176:179], v245, s[20:23], s42 offen offset:512 sc0 sc1
    s_cmp_le_u32 s29, 3
    s_cbranch_scc1 K1_LD0B
    buffer_load_dwordx4 v[180:183], v245, s[20:23], s42 offen offset:768 sc0 sc1
    s_cmp_le_u32 s29, 4
    s_cbranch_scc1 K1_LD0B
    buffer_load_dwordx4 v[184:187], v245, s[20:23], s42 offen offset:1024 sc0 sc1
    s_cmp_le_u32 s29, 5
    s_cbranch_scc1 K1_LD0B
    buffer_load_dwordx4 v[188:191], v245, s[20:23], s42 offen offset:1280 sc0 sc1
    s_cmp_le_u32 s29, 6
    s_cbranch_scc1 K1_LD0B
    buffer_load_dwordx4 v[192:195], v245, s[20:23], s42 offen offset:1536 sc0 sc1
    s_cmp_le_u32 s29, 7
    s_cbranch_scc1 K1_LD0B
    buffer_load_dwordx4 v[196:199], v245, s[20:23], s42 offen offset:1792 sc0 sc1
    s_cmp_le_u32 s29, 8
    s_cbranch_scc1 K1_LD0B
    buffer_load_dwordx4 v[200:203], v245, s[20:23], s42 offen offset:2048 sc0 sc1
    s_cmp_le_u32 s29, 9
    s_cbranch_scc1 K1_LD0B
    buffer_load_dwordx4 v[204:207], v245, s[20:23], s42 offen offset:2304 sc0 sc1
    s_cmp_le_u32 s29, 10
    s_cbranch_scc1 K1_LD0B
    buffer_load_dwordx4 v[208:211], v245, s[20:23], s42 offen offset:2560 sc0 sc1
    s_cmp_le_u32 s29, 11
    s_cbranch_scc1 K1_LD0B
    buffer_load_dwordx4 v[212:215], v245, s[20:23], s42 offen offset:2816 sc0 sc1
    s_cmp_le_u32 s29, 12
    s_cbranch_scc1 K1_LD0B
    buffer_load_dwordx4 v[216:219], v245, s[20:23], s42 offen offset:3072 sc0 sc1
    s_cmp_le_u32 s29, 13
    s_cbranch_scc1 K1_LD0B
    buffer_load_dwordx4 v[220:223], v245, s[20:23], s42 offen offset:3328 sc0 sc1
    s_cmp_le_u32 s29, 14
    s_cbranch_scc1 K1_LD0B
    buffer_load_dwordx4 v[224:227], v245, s[20:23], s42 offen offset:3584 sc0 sc1
K1_LD0B:
    s_mov_b64 exec, -1
    v_cvt_pk_bf16_f32 v144, v52, v53
    v_cvt_pk_bf16_f32 v145, v54, v55
    v_cvt_pk_bf16_f32 v156, v72, v73
    v_cvt_pk_bf16_f32 v157, v74, v75
    v_lshlrev_b32 v52, 16, v144
    v_and_b32 v53, 0xffff0000, v144
    v_lshlrev_b32 v54, 16, v145
    v_and_b32 v55, 0xffff0000, v145
    v_lshlrev_b32 v72, 16, v156
    v_and_b32 v73, 0xffff0000, v156
    v_lshlrev_b32 v74, 16, v157
    v_and_b32 v75, 0xffff0000, v157
    v_pk_mul_f32 v[146:147], v[52:53], s[4:5]
    v_pk_mul_f32 v[148:149], v[54:55], s[4:5]
    v_pk_mul_f32 v[158:159], v[72:73], s[4:5]
    v_pk_mul_f32 v[160:161], v[74:75], s[4:5]
    v_exp_f32 v146, v146
    v_exp_f32 v147, v147
    v_exp_f32 v148, v148
    v_exp_f32 v149, v149
    v_exp_f32 v158, v158
    v_exp_f32 v159, v159
    v_exp_f32 v160, v160
    v_exp_f32 v161, v161
    v_pk_add_f32 v[146:147], v[146:147], 1.0 op_sel_hi:[1,0]
    v_pk_add_f32 v[148:149], v[148:149], 1.0 op_sel_hi:[1,0]
    v_pk_add_f32 v[158:159], v[158:159], 1.0 op_sel_hi:[1,0]
    v_pk_add_f32 v[160:161], v[160:161], 1.0 op_sel_hi:[1,0]
    v_rcp_f32 v146, v146
    v_rcp_f32 v147, v147
    v_rcp_f32 v148, v148
    v_rcp_f32 v149, v149
    v_rcp_f32 v158, v158
    v_rcp_f32 v159, v159
    v_rcp_f32 v160, v160
    v_rcp_f32 v161, v161
    v_pk_mul_f32 v[146:147], v[146:147], v[52:53] op_sel:[0,0] op_sel_hi:[1,1]
    v_pk_mul_f32 v[148:149], v[148:149], v[54:55] op_sel:[0,0] op_sel_hi:[1,1]
    v_pk_mul_f32 v[158:159], v[158:159], v[72:73] op_sel:[0,0] op_sel_hi:[1,1]
    v_pk_mul_f32 v[160:161], v[160:161], v[74:75] op_sel:[0,0] op_sel_hi:[1,1]
    v_cvt_pk_bf16_f32 v150, v146, v147
    v_cvt_pk_bf16_f32 v151, v148, v149
    v_cvt_pk_bf16_f32 v162, v158, v159
    v_cvt_pk_bf16_f32 v163, v160, v161
    buffer_store_dwordx2 v[150:151], v7, s[56:59], s36 offen offset:3072 sc1
    buffer_store_dwordx2 v[162:163], v7, s[56:59], s37 offen offset:0 sc1
    v_cvt_pk_bf16_f32 v144, v76, v77
    v_cvt_pk_bf16_f32 v145, v78, v79
    v_cvt_pk_bf16_f32 v156, v80, v81
    v_cvt_pk_bf16_f32 v157, v82, v83
    v_lshlrev_b32 v76, 16, v144
    v_and_b32 v77, 0xffff0000, v144
    v_lshlrev_b32 v78, 16, v145
    v_and_b32 v79, 0xffff0000, v145
    v_lshlrev_b32 v80, 16, v156
    v_and_b32 v81, 0xffff0000, v156
    v_lshlrev_b32 v82, 16, v157
    v_and_b32 v83, 0xffff0000, v157
    v_pk_mul_f32 v[146:147], v[76:77], s[4:5]
    v_pk_mul_f32 v[148:149], v[78:79], s[4:5]
    v_pk_mul_f32 v[158:159], v[80:81], s[4:5]
    v_pk_mul_f32 v[160:161], v[82:83], s[4:5]
    v_exp_f32 v146, v146
    v_exp_f32 v147, v147
    v_exp_f32 v148, v148
    v_exp_f32 v149, v149
    v_exp_f32 v158, v158
    v_exp_f32 v159, v159
    v_exp_f32 v160, v160
    v_exp_f32 v161, v161
    v_pk_add_f32 v[146:147], v[146:147], 1.0 op_sel_hi:[1,0]
    v_pk_add_f32 v[148:149], v[148:149], 1.0 op_sel_hi:[1,0]
    v_pk_add_f32 v[158:159], v[158:159], 1.0 op_sel_hi:[1,0]
    v_pk_add_f32 v[160:161], v[160:161], 1.0 op_sel_hi:[1,0]
    v_rcp_f32 v146, v146
    v_rcp_f32 v147, v147
    v_rcp_f32 v148, v148
    v_rcp_f32 v149, v149
    v_rcp_f32 v158, v158
    v_rcp_f32 v159, v159
    v_rcp_f32 v160, v160
    v_rcp_f32 v161, v161
    v_pk_mul_f32 v[146:147], v[146:147], v[76:77] op_sel:[0,0] op_sel_hi:[1,1]
    v_pk_mul_f32 v[148:149], v[148:149], v[78:79] op_sel:[0,0] op_sel_hi:[1,1]
    v_pk_mul_f32 v[158:159], v[158:159], v[80:81] op_sel:[0,0] op_sel_hi:[1,1]
    v_pk_mul_f32 v[160:161], v[160:161], v[82:83] op_sel:[0,0] op_sel_hi:[1,1]
    v_cvt_pk_bf16_f32 v150, v146, v147
    v_cvt_pk_bf16_f32 v151, v148, v149
    v_cvt_pk_bf16_f32 v162, v158, v159
    v_cvt_pk_bf16_f32 v163, v160, v161
    buffer_store_dwordx2 v[150:151], v7, s[56:59], s37 offen offset:512 sc1
    buffer_store_dwordx2 v[162:163], v7, s[56:59], s37 offen offset:1024 sc1
    v_cvt_pk_bf16_f32 v144, v84, v85
    v_cvt_pk_bf16_f32 v145, v86, v87
    v_cvt_pk_bf16_f32 v156, v88, v89
    v_cvt_pk_bf16_f32 v157, v90, v91
    v_lshlrev_b32 v84, 16, v144
    v_and_b32 v85, 0xffff0000, v144
    v_lshlrev_b32 v86, 16, v145
    v_and_b32 v87, 0xffff0000, v145
    v_lshlrev_b32 v88, 16, v156
    v_and_b32 v89, 0xffff0000, v156
    v_lshlrev_b32 v90, 16, v157
    v_and_b32 v91, 0xffff0000, v157
    v_pk_mul_f32 v[146:147], v[84:85], s[4:5]
    v_pk_mul_f32 v[148:149], v[86:87], s[4:5]
    v_pk_mul_f32 v[158:159], v[88:89], s[4:5]
    v_pk_mul_f32 v[160:161], v[90:91], s[4:5]
    v_exp_f32 v146, v146
    v_exp_f32 v147, v147
    v_exp_f32 v148, v148
    v_exp_f32 v149, v149
    v_exp_f32 v158, v158
    v_exp_f32 v159, v159
    v_exp_f32 v160, v160
    v_exp_f32 v161, v161
    v_pk_add_f32 v[146:147], v[146:147], 1.0 op_sel_hi:[1,0]
    v_pk_add_f32 v[148:149], v[148:149], 1.0 op_sel_hi:[1,0]
    v_pk_add_f32 v[158:159], v[158:159], 1.0 op_sel_hi:[1,0]
    v_pk_add_f32 v[160:161], v[160:161], 1.0 op_sel_hi:[1,0]
    v_rcp_f32 v146, v146
    v_rcp_f32 v147, v147
    v_rcp_f32 v148, v148
    v_rcp_f32 v149, v149
    v_rcp_f32 v158, v158
    v_rcp_f32 v159, v159
    v_rcp_f32 v160, v160
    v_rcp_f32 v161, v161
    v_pk_mul_f32 v[146:147], v[146:147], v[84:85] op_sel:[0,0] op_sel_hi:[1,1]
    v_pk_mul_f32 v[148:149], v[148:149], v[86:87] op_sel:[0,0] op_sel_hi:[1,1]
    v_pk_mul_f32 v[158:159], v[158:159], v[88:89] op_sel:[0,0] op_sel_hi:[1,1]
    v_pk_mul_f32 v[160:161], v[160:161], v[90:91] op_sel:[0,0] op_sel_hi:[1,1]
    v_cvt_pk_bf16_f32 v150, v146, v147
    v_cvt_pk_bf16_f32 v151, v148, v149
    v_cvt_pk_bf16_f32 v162, v158, v159
    v_cvt_pk_bf16_f32 v163, v160, v161
    buffer_store_dwordx2 v[150:151], v7, s[56:59], s37 offen offset:1536 sc1
    buffer_store_dwordx2 v[162:163], v7, s[56:59], s37 offen offset:2048 sc1
    v_cvt_pk_bf16_f32 v144, v92, v93
    v_cvt_pk_bf16_f32 v145, v94, v95
    v_cvt_pk_bf16_f32 v156, v96, v97
    v_cvt_pk_bf16_f32 v157, v98, v99
    v_lshlrev_b32 v92, 16, v144
    v_and_b32 v93, 0xffff0000, v144
    v_lshlrev_b32 v94, 16, v145
    v_and_b32 v95, 0xffff0000, v145
    v_lshlrev_b32 v96, 16, v156
    v_and_b32 v97, 0xffff0000, v156
    v_lshlrev_b32 v98, 16, v157
    v_and_b32 v99, 0xffff0000, v157
    v_pk_mul_f32 v[146:147], v[92:93], s[4:5]
    v_pk_mul_f32 v[148:149], v[94:95], s[4:5]
    v_pk_mul_f32 v[158:159], v[96:97], s[4:5]
    v_pk_mul_f32 v[160:161], v[98:99], s[4:5]
    v_exp_f32 v146, v146
    v_exp_f32 v147, v147
    v_exp_f32 v148, v148
    v_exp_f32 v149, v149
    v_exp_f32 v158, v158
    v_exp_f32 v159, v159
    v_exp_f32 v160, v160
    v_exp_f32 v161, v161
    v_pk_add_f32 v[146:147], v[146:147], 1.0 op_sel_hi:[1,0]
    v_pk_add_f32 v[148:149], v[148:149], 1.0 op_sel_hi:[1,0]
    v_pk_add_f32 v[158:159], v[158:159], 1.0 op_sel_hi:[1,0]
    v_pk_add_f32 v[160:161], v[160:161], 1.0 op_sel_hi:[1,0]
    v_rcp_f32 v146, v146
    v_rcp_f32 v147, v147
    v_rcp_f32 v148, v148
    v_rcp_f32 v149, v149
    v_rcp_f32 v158, v158
    v_rcp_f32 v159, v159
    v_rcp_f32 v160, v160
    v_rcp_f32 v161, v161
    v_pk_mul_f32 v[146:147], v[146:147], v[92:93] op_sel:[0,0] op_sel_hi:[1,1]
    v_pk_mul_f32 v[148:149], v[148:149], v[94:95] op_sel:[0,0] op_sel_hi:[1,1]
    v_pk_mul_f32 v[158:159], v[158:159], v[96:97] op_sel:[0,0] op_sel_hi:[1,1]
    v_pk_mul_f32 v[160:161], v[160:161], v[98:99] op_sel:[0,0] op_sel_hi:[1,1]
    v_cvt_pk_bf16_f32 v150, v146, v147
    v_cvt_pk_bf16_f32 v151, v148, v149
    v_cvt_pk_bf16_f32 v162, v158, v159
    v_cvt_pk_bf16_f32 v163, v160, v161
    buffer_store_dwordx2 v[150:151], v7, s[56:59], s37 offen offset:2560 sc1
    buffer_store_dwordx2 v[162:163], v7, s[56:59], s37 offen offset:3072 sc1
    s_waitcnt vmcnt(15)
    v_lshlrev_b32 v2, 4, v0
    v_add_u32 v2, 146432, v2
    ds_read_b128 v[144:147], v2
    ds_read_b128 v[148:151], v2 offset:4096
    s_mul_i32 s5, s2, 200
    v_add_u32 v3, s5, v0
    v_mul_u32_u24 v10, 0xcccd, v3
    v_lshrrev_b32 v10, 22, v10
    v_mul_u32_u24 v11, 80, v10
    v_sub_u32 v11, v3, v11
    v_lshrrev_b32 v2, 4, v10
    v_mul_u32_u24 v2, 40960, v2
    v_and_b32 v10, 15, v10
    v_lshl_add_u32 v2, v10, 4, v2
    v_lshl_add_u32 v2, v11, 9, v2
    s_mov_b32 s70, 0x05040100
    s_mov_b32 s71, 0x07060302
    s_mov_b32 s72, 0x80008000
    s_add_u32 s76, s6, 0x1310000
    s_addc_u32 s77, s7, 0
    s_and_b32 s77, s77, 0xffff
    s_mov_b32 s78, 0x190000
    s_mov_b32 s79, 0x00020000
    s_waitcnt lgkmcnt(0)
    v_xor_b32 v148, s72, v148
    v_xor_b32 v149, s72, v149
    v_xor_b32 v150, s72, v150
    v_xor_b32 v151, s72, v151
    v_perm_b32 v152, v148, v144, s70
    v_perm_b32 v153, v148, v144, s71
    v_perm_b32 v154, v149, v145, s70
    v_perm_b32 v155, v149, v145, s71
    v_perm_b32 v156, v150, v146, s70
    v_perm_b32 v157, v150, v146, s71
    v_perm_b32 v158, v151, v147, s70
    v_perm_b32 v159, v151, v147, s71
    v_cmp_gt_u32 vcc, 200, v0
    s_and_saveexec_b64 s[74:75], vcc
    s_cbranch_execz K1_NOC2B
    buffer_store_dwordx4 v[152:155], v2, s[76:79], 0 offen
    buffer_store_dwordx4 v[156:159], v2, s[76:79], 0 offen offset:256
K1_NOC2B:
    s_mov_b64 exec, -1
    s_mov_b64 exec, 0xff
    s_mov_b32 s43, 0
    s_waitcnt vmcnt(8)
    s_branch K1_LOADED2B
K1_POLLB:
    s_cmp_le_u32 s29, 0
    s_cbranch_scc1 K1_LOADEDB
    buffer_load_dwordx4 v[168:171], v245, s[20:23], s42 offen offset:0 sc0 sc1
    s_cmp_le_u32 s29, 1
    s_cbranch_scc1 K1_LOADEDB
    buffer_load_dwordx4 v[172:175], v245, s[20:23], s42 offen offset:256 sc0 sc1
    s_cmp_le_u32 s29, 2
    s_cbranch_scc1 K1_LOADEDB
    buffer_load_dwordx4 v[176:179], v245, s[20:23], s42 offen offset:512 sc0 sc1
    s_cmp_le_u32 s29, 3
    s_cbranch_scc1 K1_LOADEDB
    buffer_load_dwordx4 v[180:183], v245, s[20:23], s42 offen offset:768 sc0 sc1
    s_cmp_le_u32 s29, 4
    s_cbranch_scc1 K1_LOADEDB
    buffer_load_dwordx4 v[184:187], v245, s[20:23], s42 offen offset:1024 sc0 sc1
    s_cmp_le_u32 s29, 5
    s_cbranch_scc1 K1_LOADEDB
    buffer_load_dwordx4 v[188:191], v245, s[20:23], s42 offen offset:1280 sc0 sc1
    s_cmp_le_u32 s29, 6
    s_cbranch_scc1 K1_LOADEDB
    buffer_load_dwordx4 v[192:195], v245, s[20:23], s42 offen offset:1536 sc0 sc1
    s_cmp_le_u32 s29, 7
    s_cbranch_scc1 K1_LOADEDB
    buffer_load_dwordx4 v[196:199], v245, s[20:23], s42 offen offset:1792 sc0 sc1
    s_cmp_le_u32 s29, 8
    s_cbranch_scc1 K1_LOADEDB
    buffer_load_dwordx4 v[200:203], v245, s[20:23], s42 offen offset:2048 sc0 sc1
    s_cmp_le_u32 s29, 9
    s_cbranch_scc1 K1_LOADEDB
    buffer_load_dwordx4 v[204:207], v245, s[20:23], s42 offen offset:2304 sc0 sc1
    s_cmp_le_u32 s29, 10
    s_cbranch_scc1 K1_LOADEDB
    buffer_load_dwordx4 v[208:211], v245, s[20:23], s42 offen offset:2560 sc0 sc1
    s_cmp_le_u32 s29, 11
    s_cbranch_scc1 K1_LOADEDB
    buffer_load_dwordx4 v[212:215], v245, s[20:23], s42 offen offset:2816 sc0 sc1
    s_cmp_le_u32 s29, 12
    s_cbranch_scc1 K1_LOADEDB
    buffer_load_dwordx4 v[216:219], v245, s[20:23], s42 offen offset:3072 sc0 sc1
    s_cmp_le_u32 s29, 13
    s_cbranch_scc1 K1_LOADEDB
    buffer_load_dwordx4 v[220:223], v245, s[20:23], s42 offen offset:3328 sc0 sc1
    s_cmp_le_u32 s29, 14
    s_cbranch_scc1 K1_LOADEDB
    buffer_load_dwordx4 v[224:227], v245, s[20:23], s42 offen offset:3584 sc0 sc1
K1_LOADEDB:
    s_waitcnt vmcnt(0)
K1_LOADED2B:
    v_mov_b32 v246, 0
    s_cmp_le_u32 s29, 0
    s_cbranch_scc1 K1_CHKB
    v_and_b32 v247, v169, v171
    v_xor_b32 v247, 1, v247
    v_or_b32 v246, v246, v247
    s_cmp_le_u32 s29, 1
    s_cbranch_scc1 K1_CHKB
    v_and_b32 v247, v173, v175
    v_xor_b32 v247, 1, v247
    v_or_b32 v246, v246, v247
    s_cmp_le_u32 s29, 2
    s_cbranch_scc1 K1_CHKB
    v_and_b32 v247, v177, v179
    v_xor_b32 v247, 1, v247
    v_or_b32 v246, v246, v247
    s_cmp_le_u32 s29, 3
    s_cbranch_scc1 K1_CHKB
    v_and_b32 v247, v181, v183
    v_xor_b32 v247, 1, v247
    v_or_b32 v246, v246, v247
    s_cmp_le_u32 s29, 4
    s_cbranch_scc1 K1_CHKB
    v_and_b32 v247, v185, v187
    v_xor_b32 v247, 1, v247
    v_or_b32 v246, v246, v247
    s_cmp_le_u32 s29, 5
    s_cbranch_scc1 K1_CHKB
    v_and_b32 v247, v189, v191
    v_xor_b32 v247, 1, v247
    v_or_b32 v246, v246, v247
    s_cmp_le_u32 s29, 6
    s_cbranch_scc1 K1_CHKB
    v_and_b32 v247, v193, v195
    v_xor_b32 v247, 1, v247
    v_or_b32 v246, v246, v247
    s_cmp_le_u32 s29, 7
    s_cbranch_scc1 K1_CHKB
    v_and_b32 v247, v197, v199
    v_xor_b32 v247, 1, v247
    v_or_b32 v246, v246, v247
    s_cmp_le_u32 s29, 8
    s_cbranch_scc1 K1_CHKB
    v_and_b32 v247, v201, v203
    v_xor_b32 v247, 1, v247
    v_or_b32 v246, v246, v247
    s_cmp_le_u32 s29, 9
    s_cbranch_scc1 K1_CHKB
    v_and_b32 v247, v205, v207
    v_xor_b32 v247, 1, v247
    v_or_b32 v246, v246, v247
    s_cmp_le_u32 s29, 10
    s_cbranch_scc1 K1_CHKB
    v_and_b32 v247, v209, v211
    v_xor_b32 v247, 1, v247
    v_or_b32 v246, v246, v247
    s_cmp_le_u32 s29, 11
    s_cbranch_scc1 K1_CHKB
    v_and_b32 v247, v213, v215
    v_xor_b32 v247, 1, v247
    v_or_b32 v246, v246, v247
    s_cmp_le_u32 s29, 12
    s_cbranch_scc1 K1_CHKB
    v_and_b32 v247, v217, v219
    v_xor_b32 v247, 1, v247
    v_or_b32 v246, v246, v247
    s_cmp_le_u32 s29, 13
    s_cbranch_scc1 K1_CHKB
    v_and_b32 v247, v221, v223
    v_xor_b32 v247, 1, v247
    v_or_b32 v246, v246, v247
    s_cmp_le_u32 s29, 14
    s_cbranch_scc1 K1_CHKB
    v_and_b32 v247, v225, v227
    v_xor_b32 v247, 1, v247
    v_or_b32 v246, v246, v247
K1_CHKB:
    v_cmp_ne_u32 vcc, 0, v246
    s_add_u32 s43, s43, 1
    s_cmp_ge_u32 s43, 0x40000
    s_cbranch_scc1 K1_GOTB
    s_nop 4
    s_cbranch_vccnz K1_POLLB
K1_GOTB:
    v_mov_b32 v232, 0
    v_mov_b32 v233, 0
    s_cmp_le_u32 s29, 0
    s_cbranch_scc1 K1_CARRYB
    v_mov_b32 v169, v170
    v_pk_fma_f32 v[234:235], v[238:239], v[232:233], v[168:169] op_sel:[0,0,0] op_sel_hi:[0,1,1]
    v_pk_fma_f32 v[234:235], v[238:239], v[232:233], v[234:235] op_sel:[1,1,0] op_sel_hi:[1,0,1] neg_lo:[1,0,0] neg_hi:[0,0,0]
    v_mov_b32 v232, v234
    v_mov_b32 v233, v235
    s_cmp_le_u32 s29, 1
    s_cbranch_scc1 K1_CARRYB
    v_mov_b32 v173, v174
    v_pk_fma_f32 v[234:235], v[238:239], v[232:233], v[172:173] op_sel:[0,0,0] op_sel_hi:[0,1,1]
    v_pk_fma_f32 v[234:235], v[238:239], v[232:233], v[234:235] op_sel:[1,1,0] op_sel_hi:[1,0,1] neg_lo:[1,0,0] neg_hi:[0,0,0]
    v_mov_b32 v232, v234
    v_mov_b32 v233, v235
    s_cmp_le_u32 s29, 2
    s_cbranch_scc1 K1_CARRYB
    v_mov_b32 v177, v178
    v_pk_fma_f32 v[234:235], v[238:239], v[232:233], v[176:177] op_sel:[0,0,0] op_sel_hi:[0,1,1]
    v_pk_fma_f32 v[234:235], v[238:239], v[232:233], v[234:235] op_sel:[1,1,0] op_sel_hi:[1,0,1] neg_lo:[1,0,0] neg_hi:[0,0,0]
    v_mov_b32 v232, v234
    v_mov_b32 v233, v235
    s_cmp_le_u32 s29, 3
    s_cbranch_scc1 K1_CARRYB
    v_mov_b32 v181, v182
    v_pk_fma_f32 v[234:235], v[238:239], v[232:233], v[180:181] op_sel:[0,0,0] op_sel_hi:[0,1,1]
    v_pk_fma_f32 v[234:235], v[238:239], v[232:233], v[234:235] op_sel:[1,1,0] op_sel_hi:[1,0,1] neg_lo:[1,0,0] neg_hi:[0,0,0]
    v_mov_b32 v232, v234
    v_mov_b32 v233, v235
    s_cmp_le_u32 s29, 4
    s_cbranch_scc1 K1_CARRYB
    v_mov_b32 v185, v186
    v_pk_fma_f32 v[234:235], v[238:239], v[232:233], v[184:185] op_sel:[0,0,0] op_sel_hi:[0,1,1]
    v_pk_fma_f32 v[234:235], v[238:239], v[232:233], v[234:235] op_sel:[1,1,0] op_sel_hi:[1,0,1] neg_lo:[1,0,0] neg_hi:[0,0,0]
    v_mov_b32 v232, v234
    v_mov_b32 v233, v235
    s_cmp_le_u32 s29, 5
    s_cbranch_scc1 K1_CARRYB
    v_mov_b32 v189, v190
    v_pk_fma_f32 v[234:235], v[238:239], v[232:233], v[188:189] op_sel:[0,0,0] op_sel_hi:[0,1,1]
    v_pk_fma_f32 v[234:235], v[238:239], v[232:233], v[234:235] op_sel:[1,1,0] op_sel_hi:[1,0,1] neg_lo:[1,0,0] neg_hi:[0,0,0]
    v_mov_b32 v232, v234
    v_mov_b32 v233, v235
    s_cmp_le_u32 s29, 6
    s_cbranch_scc1 K1_CARRYB
    v_mov_b32 v193, v194
    v_pk_fma_f32 v[234:235], v[238:239], v[232:233], v[192:193] op_sel:[0,0,0] op_sel_hi:[0,1,1]
    v_pk_fma_f32 v[234:235], v[238:239], v[232:233], v[234:235] op_sel:[1,1,0] op_sel_hi:[1,0,1] neg_lo:[1,0,0] neg_hi:[0,0,0]
    v_mov_b32 v232, v234
    v_mov_b32 v233, v235
    s_cmp_le_u32 s29, 7
    s_cbranch_scc1 K1_CARRYB
    v_mov_b32 v197, v198
    v_pk_fma_f32 v[234:235], v[238:239], v[232:233], v[196:197] op_sel:[0,0,0] op_sel_hi:[0,1,1]
    v_pk_fma_f32 v[234:235], v[238:239], v[232:233], v[234:235] op_sel:[1,1,0] op_sel_hi:[1,0,1] neg_lo:[1,0,0] neg_hi:[0,0,0]
    v_mov_b32 v232, v234
    v_mov_b32 v233, v235
    s_cmp_le_u32 s29, 8
    s_cbranch_scc1 K1_CARRYB
    v_mov_b32 v201, v202
    v_pk_fma_f32 v[234:235], v[238:239], v[232:233], v[200:201] op_sel:[0,0,0] op_sel_hi:[0,1,1]
    v_pk_fma_f32 v[234:235], v[238:239], v[232:233], v[234:235] op_sel:[1,1,0] op_sel_hi:[1,0,1] neg_lo:[1,0,0] neg_hi:[0,0,0]
    v_mov_b32 v232, v234
    v_mov_b32 v233, v235
    s_cmp_le_u32 s29, 9
    s_cbranch_scc1 K1_CARRYB
    v_mov_b32 v205, v206
    v_pk_fma_f32 v[234:235], v[238:239], v[232:233], v[204:205] op_sel:[0,0,0] op_sel_hi:[0,1,1]
    v_pk_fma_f32 v[234:235], v[238:239], v[232:233], v[234:235] op_sel:[1,1,0] op_sel_hi:[1,0,1] neg_lo:[1,0,0] neg_hi:[0,0,0]
    v_mov_b32 v232, v234
    v_mov_b32 v233, v235
    s_cmp_le_u32 s29, 10
    s_cbranch_scc1 K1_CARRYB
    v_mov_b32 v209, v210
    v_pk_fma_f32 v[234:235], v[238:239], v[232:233], v[208:209] op_sel:[0,0,0] op_sel_hi:[0,1,1]
    v_pk_fma_f32 v[234:235], v[238:239], v[232:233], v[234:235] op_sel:[1,1,0] op_sel_hi:[1,0,1] neg_lo:[1,0,0] neg_hi:[0,0,0]
    v_mov_b32 v232, v234
    v_mov_b32 v233, v235
    s_cmp_le_u32 s29, 11
    s_cbranch_scc1 K1_CARRYB
    v_mov_b32 v213, v214
    v_pk_fma_f32 v[234:235], v[238:239], v[232:233], v[212:213] op_sel:[0,0,0] op_sel_hi:[0,1,1]
    v_pk_fma_f32 v[234:235], v[238:239], v[232:233], v[234:235] op_sel:[1,1,0] op_sel_hi:[1,0,1] neg_lo:[1,0,0] neg_hi:[0,0,0]
    v_mov_b32 v232, v234
    v_mov_b32 v233, v235
    s_cmp_le_u32 s29, 12
    s_cbranch_scc1 K1_CARRYB
    v_mov_b32 v217, v218
    v_pk_fma_f32 v[234:235], v[238:239], v[232:233], v[216:217] op_sel:[0,0,0] op_sel_hi:[0,1,1]
    v_pk_fma_f32 v[234:235], v[238:239], v[232:233], v[234:235] op_sel:[1,1,0] op_sel_hi:[1,0,1] neg_lo:[1,0,0] neg_hi:[0,0,0]
    v_mov_b32 v232, v234
    v_mov_b32 v233, v235
    s_cmp_le_u32 s29, 13
    s_cbranch_scc1 K1_CARRYB
    v_mov_b32 v221, v222
    v_pk_fma_f32 v[234:235], v[238:239], v[232:233], v[220:221] op_sel:[0,0,0] op_sel_hi:[0,1,1]
    v_pk_fma_f32 v[234:235], v[238:239], v[232:233], v[234:235] op_sel:[1,1,0] op_sel_hi:[1,0,1] neg_lo:[1,0,0] neg_hi:[0,0,0]
    v_mov_b32 v232, v234
    v_mov_b32 v233, v235
    s_cmp_le_u32 s29, 14
    s_cbranch_scc1 K1_CARRYB
    v_mov_b32 v225, v226
    v_pk_fma_f32 v[234:235], v[238:239], v[232:233], v[224:225] op_sel:[0,0,0] op_sel_hi:[0,1,1]
    v_pk_fma_f32 v[234:235], v[238:239], v[232:233], v[234:235] op_sel:[1,1,0] op_sel_hi:[1,0,1] neg_lo:[1,0,0] neg_hi:[0,0,0]
    v_mov_b32 v232, v234
    v_mov_b32 v233, v235
K1_CARRYB:
    ds_write_b64 v244, v[232:233] offset:24576
    s_mov_b64 exec, -1
    s_lshl_b32 s3, s28, 6
    s_add_u32 s3, s3, 125952
    v_lshlrev_b32 v9, 8, v5
    v_lshl_add_u32 v9, v6, 3, v9
    v_add_u32 v9, s3, v9
    ds_read_b64 v[188:189], v9 offset:0
    ds_read_b64 v[190:191], v9 offset:32
    ds_read_b64 v[192:193], v9 offset:4096
    ds_read_b64 v[194:195], v9 offset:4128
    v_lshlrev_b32 v10, 3, v5
    v_lshlrev_b32 v7, 6, v6
    v_lshrrev_b32 v9, 2, v5
    v_lshl_add_u32 v7, v9, 8, v7
    v_and_b32 v9, 3, v5
    v_lshl_add_u32 v7, v9, 2, v7
    s_mul_i32 s44, s28, 4096
    s_add_u32 s44, s44, 25600
    v_add_u32 v7, s44, v7
    v_add_u32 v11, s44, v1
    s_mul_i32 s36, s45, 40960
    s_lshl_b32 s4, s30, 10
    s_add_u32 s36, s36, s4
    s_add_u32 s37, s36, 40960
    s_waitcnt lgkmcnt(0)
    s_barrier
    ds_read_b64 v[168:169], v8 offset:12288
    ds_read_b64 v[170:171], v8 offset:13312
    ds_read_b64 v[172:173], v8 offset:12416
    ds_read_b64 v[174:175], v8 offset:13440
    ds_read_b64 v[212:213], v10 offset:24576
    ds_read_b64 v[214:215], v10 offset:24704
    s_waitcnt lgkmcnt(0)
    v_pk_fma_f32 v[168:169], v[188:189], v[212:213], v[168:169] op_sel:[0,0,0] op_sel_hi:[0,1,1]
    v_pk_fma_f32 v[170:171], v[190:191], v[212:213], v[170:171] op_sel:[0,0,0] op_sel_hi:[0,1,1]
    v_pk_fma_f32 v[172:173], v[192:193], v[214:215], v[172:173] op_sel:[0,0,0] op_sel_hi:[0,1,1]
    v_pk_fma_f32 v[174:175], v[194:195], v[214:215], v[174:175] op_sel:[0,0,0] op_sel_hi:[0,1,1]
    v_pk_fma_f32 v[168:169], v[188:189], v[212:213], v[168:169] op_sel:[1,1,0] op_sel_hi:[1,0,1] neg_lo:[1,0,0] neg_hi:[0,0,0]
    v_pk_fma_f32 v[170:171], v[190:191], v[212:213], v[170:171] op_sel:[1,1,0] op_sel_hi:[1,0,1] neg_lo:[1,0,0] neg_hi:[0,0,0]
    v_pk_fma_f32 v[172:173], v[192:193], v[214:215], v[172:173] op_sel:[1,1,0] op_sel_hi:[1,0,1] neg_lo:[1,0,0] neg_hi:[0,0,0]
    v_pk_fma_f32 v[174:175], v[194:195], v[214:215], v[174:175] op_sel:[1,1,0] op_sel_hi:[1,0,1] neg_lo:[1,0,0] neg_hi:[0,0,0]
    v_pk_mul_f32 v[188:189], v[108:109], v[168:169] op_sel:[0,0] op_sel_hi:[0,1]
    v_pk_mul_f32 v[190:191], v[108:109], v[170:171] op_sel:[0,0] op_sel_hi:[0,1]
    v_pk_mul_f32 v[192:193], v[120:121], v[172:173] op_sel:[0,0] op_sel_hi:[0,1]
    v_pk_mul_f32 v[194:195], v[120:121], v[174:175] op_sel:[0,0] op_sel_hi:[0,1]
    v_pk_fma_f32 v[188:189], v[108:109], v[168:169], v[188:189] op_sel:[1,1,0] op_sel_hi:[1,0,1] neg_lo:[1,0,0] neg_hi:[0,0,0]
    v_pk_fma_f32 v[190:191], v[108:109], v[170:171], v[190:191] op_sel:[1,1,0] op_sel_hi:[1,0,1] neg_lo:[1,0,0] neg_hi:[0,0,0]
    v_pk_fma_f32 v[192:193], v[120:121], v[172:173], v[192:193] op_sel:[1,1,0] op_sel_hi:[1,0,1] neg_lo:[1,0,0] neg_hi:[0,0,0]
    v_pk_fma_f32 v[194:195], v[120:121], v[174:175], v[194:195] op_sel:[1,1,0] op_sel_hi:[1,0,1] neg_lo:[1,0,0] neg_hi:[0,0,0]
    v_pk_fma_f32 v[12:13], v[110:111], v[188:189], v[12:13] op_sel:[0,0,0] op_sel_hi:[1,0,1]
    v_pk_fma_f32 v[56:57], v[110:111], v[190:191], v[56:57] op_sel:[0,0,0] op_sel_hi:[1,0,1]
    v_pk_fma_f32 v[20:21], v[122:123], v[192:193], v[20:21] op_sel:[0,0,0] op_sel_hi:[1,0,1]
    v_pk_fma_f32 v[64:65], v[122:123], v[194:195], v[64:65] op_sel:[0,0,0] op_sel_hi:[1,0,1]
    v_pk_fma_f32 v[16:17], v[110:111], v[188:189], v[16:17] op_sel:[0,1,0] op_sel_hi:[1,1,1]
    v_pk_fma_f32 v[60:61], v[110:111], v[190:191], v[60:61] op_sel:[0,1,0] op_sel_hi:[1,1,1]
    v_pk_fma_f32 v[24:25], v[122:123], v[192:193], v[24:25] op_sel:[0,1,0] op_sel_hi:[1,1,1]
    v_pk_fma_f32 v[68:69], v[122:123], v[194:195], v[68:69] op_sel:[0,1,0] op_sel_hi:[1,1,1]
    v_pk_fma_f32 v[12:13], v[114:115], v[188:189], v[12:13] op_sel:[0,1,0] op_sel_hi:[1,1,1] neg_lo:[1,0,0] neg_hi:[1,0,0]
    v_pk_fma_f32 v[56:57], v[114:115], v[190:191], v[56:57] op_sel:[0,1,0] op_sel_hi:[1,1,1] neg_lo:[1,0,0] neg_hi:[1,0,0]
    v_pk_fma_f32 v[20:21], v[126:127], v[192:193], v[20:21] op_sel:[0,1,0] op_sel_hi:[1,1,1] neg_lo:[1,0,0] neg_hi:[1,0,0]
    v_pk_fma_f32 v[64:65], v[126:127], v[194:195], v[64:65] op_sel:[0,1,0] op_sel_hi:[1,1,1] neg_lo:[1,0,0] neg_hi:[1,0,0]
    v_pk_fma_f32 v[16:17], v[114:115], v[188:189], v[16:17] op_sel:[0,0,0] op_sel_hi:[1,0,1]
    v_pk_fma_f32 v[60:61], v[114:115], v[190:191], v[60:61] op_sel:[0,0,0] op_sel_hi:[1,0,1]
    v_pk_fma_f32 v[24:25], v[126:127], v[192:193], v[24:25] op_sel:[0,0,0] op_sel_hi:[1,0,1]
    v_pk_fma_f32 v[68:69], v[126:127], v[194:195], v[68:69] op_sel:[0,0,0] op_sel_hi:[1,0,1]
    v_pk_fma_f32 v[14:15], v[112:113], v[188:189], v[14:15] op_sel:[0,0,0] op_sel_hi:[1,0,1]
    v_pk_fma_f32 v[58:59], v[112:113], v[190:191], v[58:59] op_sel:[0,0,0] op_sel_hi:[1,0,1]
    v_pk_fma_f32 v[22:23], v[124:125], v[192:193], v[22:23] op_sel:[0,0,0] op_sel_hi:[1,0,1]
    v_pk_fma_f32 v[66:67], v[124:125], v[194:195], v[66:67] op_sel:[0,0,0] op_sel_hi:[1,0,1]
    v_pk_fma_f32 v[18:19], v[112:113], v[188:189], v[18:19] op_sel:[0,1,0] op_sel_hi:[1,1,1]
    v_pk_fma_f32 v[62:63], v[112:113], v[190:191], v[62:63] op_sel:[0,1,0] op_sel_hi:[1,1,1]
    v_pk_fma_f32 v[26:27], v[124:125], v[192:193], v[26:27] op_sel:[0,1,0] op_sel_hi:[1,1,1]
    v_pk_fma_f32 v[70:71], v[124:125], v[194:195], v[70:71] op_sel:[0,1,0] op_sel_hi:[1,1,1]
    v_pk_fma_f32 v[14:15], v[116:117], v[188:189], v[14:15] op_sel:[0,1,0] op_sel_hi:[1,1,1] neg_lo:[1,0,0] neg_hi:[1,0,0]
    v_pk_fma_f32 v[58:59], v[116:117], v[190:191], v[58:59] op_sel:[0,1,0] op_sel_hi:[1,1,1] neg_lo:[1,0,0] neg_hi:[1,0,0]
    v_pk_fma_f32 v[22:23], v[128:129], v[192:193], v[22:23] op_sel:[0,1,0] op_sel_hi:[1,1,1] neg_lo:[1,0,0] neg_hi:[1,0,0]
    v_pk_fma_f32 v[66:67], v[128:129], v[194:195], v[66:67] op_sel:[0,1,0] op_sel_hi:[1,1,1] neg_lo:[1,0,0] neg_hi:[1,0,0]
    v_pk_fma_f32 v[18:19], v[116:117], v[188:189], v[18:19] op_sel:[0,0,0] op_sel_hi:[1,0,1]
    v_pk_fma_f32 v[62:63], v[116:117], v[190:191], v[62:63] op_sel:[0,0,0] op_sel_hi:[1,0,1]
    v_pk_fma_f32 v[26:27], v[128:129], v[192:193], v[26:27] op_sel:[0,0,0] op_sel_hi:[1,0,1]
    v_pk_fma_f32 v[70:71], v[128:129], v[194:195], v[70:71] op_sel:[0,0,0] op_sel_hi:[1,0,1]
    v_cvt_pk_bf16_f32 v12, v12, v16
    v_cvt_pk_bf16_f32 v56, v56, v60
    v_cvt_pk_bf16_f32 v20, v20, v24
    v_cvt_pk_bf16_f32 v64, v64, v68
    ds_write_b32 v7, v12 offset:0
    ds_write_b32 v7, v56 offset:2048
    ds_write_b32 v7, v20 offset:1024
    ds_write_b32 v7, v64 offset:3072
    v_cvt_pk_bf16_f32 v13, v13, v17
    v_cvt_pk_bf16_f32 v57, v57, v61
    v_cvt_pk_bf16_f32 v21, v21, v25
    v_cvt_pk_bf16_f32 v65, v65, v69
    ds_write_b32 v7, v13 offset:16
    ds_write_b32 v7, v57 offset:2064
    ds_write_b32 v7, v21 offset:1040
    ds_write_b32 v7, v65 offset:3088
    v_cvt_pk_bf16_f32 v14, v14, v18
    v_cvt_pk_bf16_f32 v58, v58, v62
    v_cvt_pk_bf16_f32 v22, v22, v26
    v_cvt_pk_bf16_f32 v66, v66, v70
    ds_write_b32 v7, v14 offset:32
    ds_write_b32 v7, v58 offset:2080
    ds_write_b32 v7, v22 offset:1056
    ds_write_b32 v7, v66 offset:3104
    v_cvt_pk_bf16_f32 v15, v15, v19
    v_cvt_pk_bf16_f32 v59, v59, v63
    v_cvt_pk_bf16_f32 v23, v23, v27
    v_cvt_pk_bf16_f32 v67, v67, v71
    ds_write_b32 v7, v15 offset:48
    ds_write_b32 v7, v59 offset:2096
    ds_write_b32 v7, v23 offset:1072
    ds_write_b32 v7, v67 offset:3120
    s_waitcnt lgkmcnt(0)
    ds_read_b128 v[168:171], v11 offset:0
    ds_read_b128 v[172:175], v11 offset:1024
    ds_read_b128 v[176:179], v11 offset:2048
    ds_read_b128 v[180:183], v11 offset:3072
    s_waitcnt lgkmcnt(3)
    buffer_store_dwordx4 v[168:171], v1, s[24:27], s36 offen offset:0 sc1
    s_waitcnt lgkmcnt(2)
    buffer_store_dwordx4 v[172:175], v1, s[24:27], s36 offen offset:1024 sc1
    s_waitcnt lgkmcnt(1)
    buffer_store_dwordx4 v[176:179], v1, s[24:27], s37 offen offset:0 sc1
    s_waitcnt lgkmcnt(0)
    buffer_store_dwordx4 v[180:183], v1, s[24:27], s37 offen offset:1024 sc1
    s_cmp_ge_u32 s2, 240
    s_cbranch_scc1 K1_NOW2B
    v_and_b32 v2, 15, v0
    v_lshrrev_b32 v3, 4, v0
    v_and_b32 v3, 7, v3
    v_lshrrev_b32 v10, 7, v0
    v_lshlrev_b32 v11, 10, v3
    v_lshl_add_u32 v11, v2, 1, v11
    v_lshl_add_u32 v11, v10, 5, v11
    v_add_u32 v11, 138240, v11
    ds_read_u16 v144, v11 offset:0
    ds_read_u16 v145, v11 offset:128
    ds_read_u16 v146, v11 offset:256
    ds_read_u16 v147, v11 offset:384
    ds_read_u16 v148, v11 offset:512
    ds_read_u16 v149, v11 offset:640
    ds_read_u16 v150, v11 offset:768
    ds_read_u16 v151, v11 offset:896
    ds_read_u16 v152, v11 offset:64
    ds_read_u16 v153, v11 offset:192
    ds_read_u16 v154, v11 offset:320
    ds_read_u16 v155, v11 offset:448
    ds_read_u16 v156, v11 offset:576
    ds_read_u16 v157, v11 offset:704
    ds_read_u16 v158, v11 offset:832
    ds_read_u16 v159, v11 offset:960
    v_mul_u32_u24 v10, 49152, v10
    v_lshl_add_u32 v10, v3, 8, v10
    v_lshl_add_u32 v10, v2, 4, v10
    s_add_u32 s76, s6, 0x460000
    s_addc_u32 s77, s7, 0
    s_and_b32 s77, s77, 0xffff
    s_mov_b32 s78, 0x1e0000
    s_mov_b32 s79, 0x00020000
    s_lshl_b32 s3, s68, 11
    s_mul_i32 s4, s69, 196608
    s_add_u32 s3, s3, s4
    s_add_u32 s4, s3, 98304
    s_waitcnt lgkmcnt(0)
    v_lshl_or_b32 v160, v145, 16, v144
    v_lshl_or_b32 v161, v147, 16, v146
    v_lshl_or_b32 v162, v149, 16, v148
    v_lshl_or_b32 v163, v151, 16, v150
    v_lshl_or_b32 v164, v153, 16, v152
    v_lshl_or_b32 v165, v155, 16, v154
    v_lshl_or_b32 v166, v157, 16, v156
    v_lshl_or_b32 v167, v159, 16, v158
    buffer_store_dwordx4 v[160:163], v10, s[76:79], s3 offen
    buffer_store_dwordx4 v[164:167], v10, s[76:79], s4 offen
K1_NOW2B:
    s_endpgm
K1_END:
    s_endpgm
.globl k3_kernel
.p2align 8
.type k3_kernel,@function
k3_kernel:
    s_cmp_ge_u32 s2, 256
    s_cbranch_scc1 K3_END
    s_load_dwordx2 s[6:7], s[0:1], 112
    s_load_dwordx2 s[52:53], s[0:1], 0
    s_load_dwordx2 s[54:55], s[0:1], 64
    s_load_dwordx2 s[56:57], s[0:1], 96
    v_lshrrev_b32 v1, 6, v0
    v_and_b32 v4, 63, v0
    s_nop 0
    v_readfirstlane_b32 s28, v1
    s_and_b32 s3, s2, 7
    s_lshr_b32 s4, s2, 3
    s_lshl_b32 s29, s3, 2
    s_lshr_b32 s5, s4, 3
    s_add_u32 s29, s29, s5
    s_and_b32 s30, s4, 7
    v_and_b32 v5, 15, v4
    v_lshrrev_b32 v6, 4, v4
    v_lshlrev_b32 v1, 4, v4
    s_waitcnt lgkmcnt(0)
    s_cmp_ge_u32 s28, 2
    s_cbranch_scc1 K3_FFNW
    s_add_u32 s8, s6, 0x680000
    s_addc_u32 s9, s7, 0
    s_and_b32 s9, s9, 0xffff
    s_mov_b32 s10, 0x500000
    s_mov_b32 s11, 0x00020000
    s_add_u32 s12, s6, 0x1310000
    s_addc_u32 s13, s7, 0
    s_and_b32 s13, s13, 0xffff
    s_mov_b32 s14, 0x190000
    s_mov_b32 s15, 0x00020000
    s_mul_i32 s36, s29, 163840
    s_mul_i32 s3, s28, 20480
    s_add_u32 s36, s36, s3
    s_add_u32 s37, s36, 40960
    s_add_u32 s38, s36, 81920
    s_add_u32 s39, s36, 122880
    s_mul_i32 s40, s30, 204800
    s_add_u32 s40, s40, s3
    s_add_u32 s41, s40, 40960
    s_add_u32 s42, s40, 81920
    s_add_u32 s43, s40, 122880
    s_add_u32 s44, s40, 163840
    s_mov_b32 s47, 4
    s_branch K3_MAIN
K3_FFNW:
    s_add_u32 s8, s6, 0xb80000
    s_addc_u32 s9, s7, 0
    s_and_b32 s9, s9, 0xffff
    s_mov_b32 s10, 0x600000
    s_mov_b32 s11, 0x00020000
    s_add_u32 s12, s6, 0x460000
    s_addc_u32 s13, s7, 0
    s_and_b32 s13, s13, 0xffff
    s_mov_b32 s14, 0x1e0000
    s_mov_b32 s15, 0x00020000
    s_mul_i32 s36, s29, 196608
    s_sub_u32 s3, s28, 2
    s_mul_i32 s3, s3, 24576
    s_add_u32 s36, s36, s3
    s_add_u32 s37, s36, 49152
    s_add_u32 s38, s36, 98304
    s_add_u32 s39, s36, 147456
    s_mul_i32 s40, s30, 245760
    s_add_u32 s40, s40, s3
    s_add_u32 s41, s40, 49152
    s_add_u32 s42, s40, 98304
    s_add_u32 s43, s40, 147456
    s_add_u32 s44, s40, 196608
    s_mov_b32 s47, 5
K3_MAIN:
    buffer_load_dwordx4 v[92:95], v1, s[8:11], s36 offen offset:0
    buffer_load_dwordx4 v[96:99], v1, s[8:11], s37 offen offset:0
    buffer_load_dwordx4 v[100:103], v1, s[8:11], s38 offen offset:0
    buffer_load_dwordx4 v[104:107], v1, s[8:11], s39 offen offset:0
    buffer_load_dwordx4 v[108:111], v1, s[12:15], s40 offen offset:0
    buffer_load_dwordx4 v[112:115], v1, s[12:15], s41 offen offset:0
    buffer_load_dwordx4 v[116:119], v1, s[12:15], s42 offen offset:0
    buffer_load_dwordx4 v[120:123], v1, s[12:15], s43 offen offset:0
    buffer_load_dwordx4 v[124:127], v1, s[12:15], s44 offen offset:0
    buffer_load_dwordx4 v[128:131], v1, s[8:11], s36 offen offset:1024
    buffer_load_dwordx4 v[132:135], v1, s[8:11], s37 offen offset:1024
    buffer_load_dwordx4 v[136:139], v1, s[8:11], s38 offen offset:1024
    buffer_load_dwordx4 v[140:143], v1, s[8:11], s39 offen offset:1024
    buffer_load_dwordx4 v[144:147], v1, s[12:15], s40 offen offset:1024
    buffer_load_dwordx4 v[148:151], v1, s[12:15], s41 offen offset:1024
    buffer_load_dwordx4 v[152:155], v1, s[12:15], s42 offen offset:1024
    buffer_load_dwordx4 v[156:159], v1, s[12:15], s43 offen offset:1024
    buffer_load_dwordx4 v[160:163], v1, s[12:15], s44 offen offset:1024
    buffer_load_dwordx4 v[164:167], v1, s[8:11], s36 offen offset:2048
    buffer_load_dwordx4 v[168:171], v1, s[8:11], s37 offen offset:2048
    buffer_load_dwordx4 v[172:175], v1, s[8:11], s38 offen offset:2048
    buffer_load_dwordx4 v[176:179], v1, s[8:11], s39 offen offset:2048
    buffer_load_dwordx4 v[180:183], v1, s[12:15], s40 offen offset:2048
    buffer_load_dwordx4 v[184:187], v1, s[12:15], s41 offen offset:2048
    buffer_load_dwordx4 v[188:191], v1, s[12:15], s42 offen offset:2048
    buffer_load_dwordx4 v[192:195], v1, s[12:15], s43 offen offset:2048
    buffer_load_dwordx4 v[196:199], v1, s[12:15], s44 offen offset:2048
    buffer_load_dwordx4 v[200:203], v1, s[8:11], s36 offen offset:3072
    buffer_load_dwordx4 v[204:207], v1, s[8:11], s37 offen offset:3072
    buffer_load_dwordx4 v[208:211], v1, s[8:11], s38 offen offset:3072
    buffer_load_dwordx4 v[212:215], v1, s[8:11], s39 offen offset:3072
    buffer_load_dwordx4 v[216:219], v1, s[12:15], s40 offen offset:3072
    buffer_load_dwordx4 v[220:223], v1, s[12:15], s41 offen offset:3072
    buffer_load_dwordx4 v[224:227], v1, s[12:15], s42 offen offset:3072
    buffer_load_dwordx4 v[228:231], v1, s[12:15], s43 offen offset:3072
    buffer_load_dwordx4 v[232:235], v1, s[12:15], s44 offen offset:3072
    v_add_u32 v1, 4096, v1
    v_mov_b32 v12, 0
    v_mov_b32 v13, 0
    v_mov_b32 v14, 0
    v_mov_b32 v15, 0
    v_mov_b32 v16, 0
    v_mov_b32 v17, 0
    v_mov_b32 v18, 0
    v_mov_b32 v19, 0
    v_mov_b32 v20, 0
    v_mov_b32 v21, 0
    v_mov_b32 v22, 0
    v_mov_b32 v23, 0
    v_mov_b32 v24, 0
    v_mov_b32 v25, 0
    v_mov_b32 v26, 0
    v_mov_b32 v27, 0
    v_mov_b32 v28, 0
    v_mov_b32 v29, 0
    v_mov_b32 v30, 0
    v_mov_b32 v31, 0
    v_mov_b32 v32, 0
    v_mov_b32 v33, 0
    v_mov_b32 v34, 0
    v_mov_b32 v35, 0
    v_mov_b32 v36, 0
    v_mov_b32 v37, 0
    v_mov_b32 v38, 0
    v_mov_b32 v39, 0
    v_mov_b32 v40, 0
    v_mov_b32 v41, 0
    v_mov_b32 v42, 0
    v_mov_b32 v43, 0
    v_mov_b32 v44, 0
    v_mov_b32 v45, 0
    v_mov_b32 v46, 0
    v_mov_b32 v47, 0
    v_mov_b32 v48, 0
    v_mov_b32 v49, 0
    v_mov_b32 v50, 0
    v_mov_b32 v51, 0
    v_mov_b32 v52, 0
    v_mov_b32 v53, 0
    v_mov_b32 v54, 0
    v_mov_b32 v55, 0
    v_mov_b32 v56, 0
    v_mov_b32 v57, 0
    v_mov_b32 v58, 0
    v_mov_b32 v59, 0
    v_mov_b32 v60, 0
    v_mov_b32 v61, 0
    v_mov_b32 v62, 0
    v_mov_b32 v63, 0
    v_mov_b32 v64, 0
    v_mov_b32 v65, 0
    v_mov_b32 v66, 0
    v_mov_b32 v67, 0
    v_mov_b32 v68, 0
    v_mov_b32 v69, 0
    v_mov_b32 v70, 0
    v_mov_b32 v71, 0
    v_mov_b32 v72, 0
    v_mov_b32 v73, 0
    v_mov_b32 v74, 0
    v_mov_b32 v75, 0
    v_mov_b32 v76, 0
    v_mov_b32 v77, 0
    v_mov_b32 v78, 0
    v_mov_b32 v79, 0
    v_mov_b32 v80, 0
    v_mov_b32 v81, 0
    v_mov_b32 v82, 0
    v_mov_b32 v83, 0
    v_mov_b32 v84, 0
    v_mov_b32 v85, 0
    v_mov_b32 v86, 0
    v_mov_b32 v87, 0
    v_mov_b32 v88, 0
    v_mov_b32 v89, 0
    v_mov_b32 v90, 0
    v_mov_b32 v91, 0
K3_LOOP:
    s_waitcnt vmcnt(27)
    v_mfma_f32_16x16x32_bf16 v[12:15], v[108:111], v[92:95], v[12:15]
    v_mfma_f32_16x16x32_bf16 v[16:19], v[112:115], v[92:95], v[16:19]
    v_mfma_f32_16x16x32_bf16 v[20:23], v[116:119], v[92:95], v[20:23]
    v_mfma_f32_16x16x32_bf16 v[24:27], v[120:123], v[92:95], v[24:27]
    v_mfma_f32_16x16x32_bf16 v[28:31], v[124:127], v[92:95], v[28:31]
    v_mfma_f32_16x16x32_bf16 v[32:35], v[108:111], v[96:99], v[32:35]
    v_mfma_f32_16x16x32_bf16 v[36:39], v[112:115], v[96:99], v[36:39]
    v_mfma_f32_16x16x32_bf16 v[40:43], v[116:119], v[96:99], v[40:43]
    v_mfma_f32_16x16x32_bf16 v[44:47], v[120:123], v[96:99], v[44:47]
    v_mfma_f32_16x16x32_bf16 v[48:51], v[124:127], v[96:99], v[48:51]
    v_mfma_f32_16x16x32_bf16 v[52:55], v[108:111], v[100:103], v[52:55]
    v_mfma_f32_16x16x32_bf16 v[56:59], v[112:115], v[100:103], v[56:59]
    v_mfma_f32_16x16x32_bf16 v[60:63], v[116:119], v[100:103], v[60:63]
    v_mfma_f32_16x16x32_bf16 v[64:67], v[120:123], v[100:103], v[64:67]
    v_mfma_f32_16x16x32_bf16 v[68:71], v[124:127], v[100:103], v[68:71]
    v_mfma_f32_16x16x32_bf16 v[72:75], v[108:111], v[104:107], v[72:75]
    v_mfma_f32_16x16x32_bf16 v[76:79], v[112:115], v[104:107], v[76:79]
    v_mfma_f32_16x16x32_bf16 v[80:83], v[116:119], v[104:107], v[80:83]
    v_mfma_f32_16x16x32_bf16 v[84:87], v[120:123], v[104:107], v[84:87]
    v_mfma_f32_16x16x32_bf16 v[88:91], v[124:127], v[104:107], v[88:91]
    buffer_load_dwordx4 v[92:95], v1, s[8:11], s36 offen offset:0
    buffer_load_dwordx4 v[96:99], v1, s[8:11], s37 offen offset:0
    buffer_load_dwordx4 v[100:103], v1, s[8:11], s38 offen offset:0
    buffer_load_dwordx4 v[104:107], v1, s[8:11], s39 offen offset:0
    buffer_load_dwordx4 v[108:111], v1, s[12:15], s40 offen offset:0
    buffer_load_dwordx4 v[112:115], v1, s[12:15], s41 offen offset:0
    buffer_load_dwordx4 v[116:119], v1, s[12:15], s42 offen offset:0
    buffer_load_dwordx4 v[120:123], v1, s[12:15], s43 offen offset:0
    buffer_load_dwordx4 v[124:127], v1, s[12:15], s44 offen offset:0
    s_waitcnt vmcnt(27)
    v_mfma_f32_16x16x32_bf16 v[12:15], v[144:147], v[128:131], v[12:15]
    v_mfma_f32_16x16x32_bf16 v[16:19], v[148:151], v[128:131], v[16:19]
    v_mfma_f32_16x16x32_bf16 v[20:23], v[152:155], v[128:131], v[20:23]
    v_mfma_f32_16x16x32_bf16 v[24:27], v[156:159], v[128:131], v[24:27]
    v_mfma_f32_16x16x32_bf16 v[28:31], v[160:163], v[128:131], v[28:31]
    v_mfma_f32_16x16x32_bf16 v[32:35], v[144:147], v[132:135], v[32:35]
    v_mfma_f32_16x16x32_bf16 v[36:39], v[148:151], v[132:135], v[36:39]
    v_mfma_f32_16x16x32_bf16 v[40:43], v[152:155], v[132:135], v[40:43]
    v_mfma_f32_16x16x32_bf16 v[44:47], v[156:159], v[132:135], v[44:47]
    v_mfma_f32_16x16x32_bf16 v[48:51], v[160:163], v[132:135], v[48:51]
    v_mfma_f32_16x16x32_bf16 v[52:55], v[144:147], v[136:139], v[52:55]
    v_mfma_f32_16x16x32_bf16 v[56:59], v[148:151], v[136:139], v[56:59]
    v_mfma_f32_16x16x32_bf16 v[60:63], v[152:155], v[136:139], v[60:63]
    v_mfma_f32_16x16x32_bf16 v[64:67], v[156:159], v[136:139], v[64:67]
    v_mfma_f32_16x16x32_bf16 v[68:71], v[160:163], v[136:139], v[68:71]
    v_mfma_f32_16x16x32_bf16 v[72:75], v[144:147], v[140:143], v[72:75]
    v_mfma_f32_16x16x32_bf16 v[76:79], v[148:151], v[140:143], v[76:79]
    v_mfma_f32_16x16x32_bf16 v[80:83], v[152:155], v[140:143], v[80:83]
    v_mfma_f32_16x16x32_bf16 v[84:87], v[156:159], v[140:143], v[84:87]
    v_mfma_f32_16x16x32_bf16 v[88:91], v[160:163], v[140:143], v[88:91]
    buffer_load_dwordx4 v[128:131], v1, s[8:11], s36 offen offset:1024
    buffer_load_dwordx4 v[132:135], v1, s[8:11], s37 offen offset:1024
    buffer_load_dwordx4 v[136:139], v1, s[8:11], s38 offen offset:1024
    buffer_load_dwordx4 v[140:143], v1, s[8:11], s39 offen offset:1024
    buffer_load_dwordx4 v[144:147], v1, s[12:15], s40 offen offset:1024
    buffer_load_dwordx4 v[148:151], v1, s[12:15], s41 offen offset:1024
    buffer_load_dwordx4 v[152:155], v1, s[12:15], s42 offen offset:1024
    buffer_load_dwordx4 v[156:159], v1, s[12:15], s43 offen offset:1024
    buffer_load_dwordx4 v[160:163], v1, s[12:15], s44 offen offset:1024
    s_waitcnt vmcnt(27)
    v_mfma_f32_16x16x32_bf16 v[12:15], v[180:183], v[164:167], v[12:15]
    v_mfma_f32_16x16x32_bf16 v[16:19], v[184:187], v[164:167], v[16:19]
    v_mfma_f32_16x16x32_bf16 v[20:23], v[188:191], v[164:167], v[20:23]
    v_mfma_f32_16x16x32_bf16 v[24:27], v[192:195], v[164:167], v[24:27]
    v_mfma_f32_16x16x32_bf16 v[28:31], v[196:199], v[164:167], v[28:31]
    v_mfma_f32_16x16x32_bf16 v[32:35], v[180:183], v[168:171], v[32:35]
    v_mfma_f32_16x16x32_bf16 v[36:39], v[184:187], v[168:171], v[36:39]
    v_mfma_f32_16x16x32_bf16 v[40:43], v[188:191], v[168:171], v[40:43]
    v_mfma_f32_16x16x32_bf16 v[44:47], v[192:195], v[168:171], v[44:47]
    v_mfma_f32_16x16x32_bf16 v[48:51], v[196:199], v[168:171], v[48:51]
    v_mfma_f32_16x16x32_bf16 v[52:55], v[180:183], v[172:175], v[52:55]
    v_mfma_f32_16x16x32_bf16 v[56:59], v[184:187], v[172:175], v[56:59]
    v_mfma_f32_16x16x32_bf16 v[60:63], v[188:191], v[172:175], v[60:63]
    v_mfma_f32_16x16x32_bf16 v[64:67], v[192:195], v[172:175], v[64:67]
    v_mfma_f32_16x16x32_bf16 v[68:71], v[196:199], v[172:175], v[68:71]
    v_mfma_f32_16x16x32_bf16 v[72:75], v[180:183], v[176:179], v[72:75]
    v_mfma_f32_16x16x32_bf16 v[76:79], v[184:187], v[176:179], v[76:79]
    v_mfma_f32_16x16x32_bf16 v[80:83], v[188:191], v[176:179], v[80:83]
    v_mfma_f32_16x16x32_bf16 v[84:87], v[192:195], v[176:179], v[84:87]
    v_mfma_f32_16x16x32_bf16 v[88:91], v[196:199], v[176:179], v[88:91]
    buffer_load_dwordx4 v[164:167], v1, s[8:11], s36 offen offset:2048
    buffer_load_dwordx4 v[168:171], v1, s[8:11], s37 offen offset:2048
    buffer_load_dwordx4 v[172:175], v1, s[8:11], s38 offen offset:2048
    buffer_load_dwordx4 v[176:179], v1, s[8:11], s39 offen offset:2048
    buffer_load_dwordx4 v[180:183], v1, s[12:15], s40 offen offset:2048
    buffer_load_dwordx4 v[184:187], v1, s[12:15], s41 offen offset:2048
    buffer_load_dwordx4 v[188:191], v1, s[12:15], s42 offen offset:2048
    buffer_load_dwordx4 v[192:195], v1, s[12:15], s43 offen offset:2048
    buffer_load_dwordx4 v[196:199], v1, s[12:15], s44 offen offset:2048
    s_waitcnt vmcnt(27)
    v_mfma_f32_16x16x32_bf16 v[12:15], v[216:219], v[200:203], v[12:15]
    v_mfma_f32_16x16x32_bf16 v[16:19], v[220:223], v[200:203], v[16:19]
    v_mfma_f32_16x16x32_bf16 v[20:23], v[224:227], v[200:203], v[20:23]
    v_mfma_f32_16x16x32_bf16 v[24:27], v[228:231], v[200:203], v[24:27]
    v_mfma_f32_16x16x32_bf16 v[28:31], v[232:235], v[200:203], v[28:31]
    v_mfma_f32_16x16x32_bf16 v[32:35], v[216:219], v[204:207], v[32:35]
    v_mfma_f32_16x16x32_bf16 v[36:39], v[220:223], v[204:207], v[36:39]
    v_mfma_f32_16x16x32_bf16 v[40:43], v[224:227], v[204:207], v[40:43]
    v_mfma_f32_16x16x32_bf16 v[44:47], v[228:231], v[204:207], v[44:47]
    v_mfma_f32_16x16x32_bf16 v[48:51], v[232:235], v[204:207], v[48:51]
    v_mfma_f32_16x16x32_bf16 v[52:55], v[216:219], v[208:211], v[52:55]
    v_mfma_f32_16x16x32_bf16 v[56:59], v[220:223], v[208:211], v[56:59]
    v_mfma_f32_16x16x32_bf16 v[60:63], v[224:227], v[208:211], v[60:63]
    v_mfma_f32_16x16x32_bf16 v[64:67], v[228:231], v[208:211], v[64:67]
    v_mfma_f32_16x16x32_bf16 v[68:71], v[232:235], v[208:211], v[68:71]
    v_mfma_f32_16x16x32_bf16 v[72:75], v[216:219], v[212:215], v[72:75]
    v_mfma_f32_16x16x32_bf16 v[76:79], v[220:223], v[212:215], v[76:79]
    v_mfma_f32_16x16x32_bf16 v[80:83], v[224:227], v[212:215], v[80:83]
    v_mfma_f32_16x16x32_bf16 v[84:87], v[228:231], v[212:215], v[84:87]
    v_mfma_f32_16x16x32_bf16 v[88:91], v[232:235], v[212:215], v[88:91]
    buffer_load_dwordx4 v[200:203], v1, s[8:11], s36 offen offset:3072
    buffer_load_dwordx4 v[204:207], v1, s[8:11], s37 offen offset:3072
    buffer_load_dwordx4 v[208:211], v1, s[8:11], s38 offen offset:3072
    buffer_load_dwordx4 v[212:215], v1, s[8:11], s39 offen offset:3072
    buffer_load_dwordx4 v[216:219], v1, s[12:15], s40 offen offset:3072
    buffer_load_dwordx4 v[220:223], v1, s[12:15], s41 offen offset:3072
    buffer_load_dwordx4 v[224:227], v1, s[12:15], s42 offen offset:3072
    buffer_load_dwordx4 v[228:231], v1, s[12:15], s43 offen offset:3072
    buffer_load_dwordx4 v[232:235], v1, s[12:15], s44 offen offset:3072
    v_add_u32 v1, 4096, v1
    s_sub_u32 s47, s47, 1
    s_cmp_lg_u32 s47, 0
    s_cbranch_scc1 K3_LOOP
    s_waitcnt vmcnt(27)
    v_mfma_f32_16x16x32_bf16 v[12:15], v[108:111], v[92:95], v[12:15]
    v_mfma_f32_16x16x32_bf16 v[16:19], v[112:115], v[92:95], v[16:19]
    v_mfma_f32_16x16x32_bf16 v[20:23], v[116:119], v[92:95], v[20:23]
    v_mfma_f32_16x16x32_bf16 v[24:27], v[120:123], v[92:95], v[24:27]
    v_mfma_f32_16x16x32_bf16 v[28:31], v[124:127], v[92:95], v[28:31]
    v_mfma_f32_16x16x32_bf16 v[32:35], v[108:111], v[96:99], v[32:35]
    v_mfma_f32_16x16x32_bf16 v[36:39], v[112:115], v[96:99], v[36:39]
    v_mfma_f32_16x16x32_bf16 v[40:43], v[116:119], v[96:99], v[40:43]
    v_mfma_f32_16x16x32_bf16 v[44:47], v[120:123], v[96:99], v[44:47]
    v_mfma_f32_16x16x32_bf16 v[48:51], v[124:127], v[96:99], v[48:51]
    v_mfma_f32_16x16x32_bf16 v[52:55], v[108:111], v[100:103], v[52:55]
    v_mfma_f32_16x16x32_bf16 v[56:59], v[112:115], v[100:103], v[56:59]
    v_mfma_f32_16x16x32_bf16 v[60:63], v[116:119], v[100:103], v[60:63]
    v_mfma_f32_16x16x32_bf16 v[64:67], v[120:123], v[100:103], v[64:67]
    v_mfma_f32_16x16x32_bf16 v[68:71], v[124:127], v[100:103], v[68:71]
    v_mfma_f32_16x16x32_bf16 v[72:75], v[108:111], v[104:107], v[72:75]
    v_mfma_f32_16x16x32_bf16 v[76:79], v[112:115], v[104:107], v[76:79]
    v_mfma_f32_16x16x32_bf16 v[80:83], v[116:119], v[104:107], v[80:83]
    v_mfma_f32_16x16x32_bf16 v[84:87], v[120:123], v[104:107], v[84:87]
    v_mfma_f32_16x16x32_bf16 v[88:91], v[124:127], v[104:107], v[88:91]
    s_waitcnt vmcnt(18)
    v_mfma_f32_16x16x32_bf16 v[12:15], v[144:147], v[128:131], v[12:15]
    v_mfma_f32_16x16x32_bf16 v[16:19], v[148:151], v[128:131], v[16:19]
    v_mfma_f32_16x16x32_bf16 v[20:23], v[152:155], v[128:131], v[20:23]
    v_mfma_f32_16x16x32_bf16 v[24:27], v[156:159], v[128:131], v[24:27]
    v_mfma_f32_16x16x32_bf16 v[28:31], v[160:163], v[128:131], v[28:31]
    v_mfma_f32_16x16x32_bf16 v[32:35], v[144:147], v[132:135], v[32:35]
    v_mfma_f32_16x16x32_bf16 v[36:39], v[148:151], v[132:135], v[36:39]
    v_mfma_f32_16x16x32_bf16 v[40:43], v[152:155], v[132:135], v[40:43]
    v_mfma_f32_16x16x32_bf16 v[44:47], v[156:159], v[132:135], v[44:47]
    v_mfma_f32_16x16x32_bf16 v[48:51], v[160:163], v[132:135], v[48:51]
    v_mfma_f32_16x16x32_bf16 v[52:55], v[144:147], v[136:139], v[52:55]
    v_mfma_f32_16x16x32_bf16 v[56:59], v[148:151], v[136:139], v[56:59]
    v_mfma_f32_16x16x32_bf16 v[60:63], v[152:155], v[136:139], v[60:63]
    v_mfma_f32_16x16x32_bf16 v[64:67], v[156:159], v[136:139], v[64:67]
    v_mfma_f32_16x16x32_bf16 v[68:71], v[160:163], v[136:139], v[68:71]
    v_mfma_f32_16x16x32_bf16 v[72:75], v[144:147], v[140:143], v[72:75]
    v_mfma_f32_16x16x32_bf16 v[76:79], v[148:151], v[140:143], v[76:79]
    v_mfma_f32_16x16x32_bf16 v[80:83], v[152:155], v[140:143], v[80:83]
    v_mfma_f32_16x16x32_bf16 v[84:87], v[156:159], v[140:143], v[84:87]
    v_mfma_f32_16x16x32_bf16 v[88:91], v[160:163], v[140:143], v[88:91]
    s_waitcnt vmcnt(9)
    v_mfma_f32_16x16x32_bf16 v[12:15], v[180:183], v[164:167], v[12:15]
    v_mfma_f32_16x16x32_bf16 v[16:19], v[184:187], v[164:167], v[16:19]
    v_mfma_f32_16x16x32_bf16 v[20:23], v[188:191], v[164:167], v[20:23]
    v_mfma_f32_16x16x32_bf16 v[24:27], v[192:195], v[164:167], v[24:27]
    v_mfma_f32_16x16x32_bf16 v[28:31], v[196:199], v[164:167], v[28:31]
    v_mfma_f32_16x16x32_bf16 v[32:35], v[180:183], v[168:171], v[32:35]
    v_mfma_f32_16x16x32_bf16 v[36:39], v[184:187], v[168:171], v[36:39]
    v_mfma_f32_16x16x32_bf16 v[40:43], v[188:191], v[168:171], v[40:43]
    v_mfma_f32_16x16x32_bf16 v[44:47], v[192:195], v[168:171], v[44:47]
    v_mfma_f32_16x16x32_bf16 v[48:51], v[196:199], v[168:171], v[48:51]
    v_mfma_f32_16x16x32_bf16 v[52:55], v[180:183], v[172:175], v[52:55]
    v_mfma_f32_16x16x32_bf16 v[56:59], v[184:187], v[172:175], v[56:59]
    v_mfma_f32_16x16x32_bf16 v[60:63], v[188:191], v[172:175], v[60:63]
    v_mfma_f32_16x16x32_bf16 v[64:67], v[192:195], v[172:175], v[64:67]
    v_mfma_f32_16x16x32_bf16 v[68:71], v[196:199], v[172:175], v[68:71]
    v_mfma_f32_16x16x32_bf16 v[72:75], v[180:183], v[176:179], v[72:75]
    v_mfma_f32_16x16x32_bf16 v[76:79], v[184:187], v[176:179], v[76:79]
    v_mfma_f32_16x16x32_bf16 v[80:83], v[188:191], v[176:179], v[80:83]
    v_mfma_f32_16x16x32_bf16 v[84:87], v[192:195], v[176:179], v[84:87]
    v_mfma_f32_16x16x32_bf16 v[88:91], v[196:199], v[176:179], v[88:91]
    s_waitcnt vmcnt(0)
    v_mfma_f32_16x16x32_bf16 v[12:15], v[216:219], v[200:203], v[12:15]
    v_mfma_f32_16x16x32_bf16 v[16:19], v[220:223], v[200:203], v[16:19]
    v_mfma_f32_16x16x32_bf16 v[20:23], v[224:227], v[200:203], v[20:23]
    v_mfma_f32_16x16x32_bf16 v[24:27], v[228:231], v[200:203], v[24:27]
    v_mfma_f32_16x16x32_bf16 v[28:31], v[232:235], v[200:203], v[28:31]
    v_mfma_f32_16x16x32_bf16 v[32:35], v[216:219], v[204:207], v[32:35]
    v_mfma_f32_16x16x32_bf16 v[36:39], v[220:223], v[204:207], v[36:39]
    v_mfma_f32_16x16x32_bf16 v[40:43], v[224:227], v[204:207], v[40:43]
    v_mfma_f32_16x16x32_bf16 v[44:47], v[228:231], v[204:207], v[44:47]
    v_mfma_f32_16x16x32_bf16 v[48:51], v[232:235], v[204:207], v[48:51]
    v_mfma_f32_16x16x32_bf16 v[52:55], v[216:219], v[208:211], v[52:55]
    v_mfma_f32_16x16x32_bf16 v[56:59], v[220:223], v[208:211], v[56:59]
    v_mfma_f32_16x16x32_bf16 v[60:63], v[224:227], v[208:211], v[60:63]
    v_mfma_f32_16x16x32_bf16 v[64:67], v[228:231], v[208:211], v[64:67]
    v_mfma_f32_16x16x32_bf16 v[68:71], v[232:235], v[208:211], v[68:71]
    v_mfma_f32_16x16x32_bf16 v[72:75], v[216:219], v[212:215], v[72:75]
    v_mfma_f32_16x16x32_bf16 v[76:79], v[220:223], v[212:215], v[76:79]
    v_mfma_f32_16x16x32_bf16 v[80:83], v[224:227], v[212:215], v[80:83]
    v_mfma_f32_16x16x32_bf16 v[84:87], v[228:231], v[212:215], v[84:87]
    v_mfma_f32_16x16x32_bf16 v[88:91], v[232:235], v[212:215], v[88:91]
K3_EPI:
    s_mov_b32 s16, s52
    s_mov_b32 s17, s53
    s_and_b32 s17, s17, 0xffff
    s_mov_b32 s18, 0x280000
    s_mov_b32 s19, 0x00020000
    s_mov_b32 s20, s6
    s_mov_b32 s21, s7
    s_and_b32 s21, s21, 0xffff
    s_mov_b32 s22, 0x280000
    s_mov_b32 s23, 0x00020000
    s_mov_b32 s24, s54
    s_mov_b32 s25, s55
    s_and_b32 s25, s25, 0xffff
    s_mov_b32 s26, 0x500
    s_mov_b32 s27, 0x00020000
    s_mov_b32 s32, s56
    s_mov_b32 s33, s57
    s_and_b32 s33, s33, 0xffff
    s_mov_b32 s34, 0x500000
    s_mov_b32 s35, 0x00020000
    s_mul_i32 s3, s29, 81920
    s_mul_i32 s4, s30, 160
    s_add_u32 s3, s3, s4
    s_lshl_b32 s5, s3, 1
    s_mul_i32 s46, s29, 81920
    s_mul_i32 s48, s30, 2560
    s_add_u32 s46, s46, s48
    v_add_u32 v7, 0, v0
    v_mul_u32_u24 v8, 0xcccd, v7
    v_lshrrev_b32 v8, 20, v8
    v_mul_u32_u24 v9, 20, v8
    v_sub_u32 v9, v7, v9
    v_mul_u32_u24 v92, 1280, v8
    v_lshl_add_u32 v92, v9, 3, v92
    v_mul_u32_u24 v93, 336, v8
    v_lshl_add_u32 v93, v9, 4, v93
    v_lshlrev_b32 v9, 3, v9
    buffer_load_dwordx2 v[94:95], v92, s[16:19], s3 offen
    v_lshrrev_b32 v10, 4, v8
    v_mul_u32_u24 v10, 20480, v10
    v_and_b32 v11, 15, v8
    v_lshl_add_u32 v10, v11, 4, v10
    v_lshrrev_b32 v11, 4, v9
    v_lshl_add_u32 v10, v11, 8, v10
    v_and_b32 v11, 8, v9
    v_add_u32 v10, v10, v11
    buffer_load_dwordx2 v[96:97], v10, s[20:23], s46 offen
    buffer_load_dwordx2 v[98:99], v9, s[24:27], s4 offen
    v_add_u32 v7, 256, v0
    v_mul_u32_u24 v8, 0xcccd, v7
    v_lshrrev_b32 v8, 20, v8
    v_mul_u32_u24 v9, 20, v8
    v_sub_u32 v9, v7, v9
    v_mul_u32_u24 v100, 1280, v8
    v_lshl_add_u32 v100, v9, 3, v100
    v_mul_u32_u24 v101, 336, v8
    v_lshl_add_u32 v101, v9, 4, v101
    v_lshlrev_b32 v9, 3, v9
    buffer_load_dwordx2 v[102:103], v100, s[16:19], s3 offen
    v_lshrrev_b32 v10, 4, v8
    v_mul_u32_u24 v10, 20480, v10
    v_and_b32 v11, 15, v8
    v_lshl_add_u32 v10, v11, 4, v10
    v_lshrrev_b32 v11, 4, v9
    v_lshl_add_u32 v10, v11, 8, v10
    v_and_b32 v11, 8, v9
    v_add_u32 v10, v10, v11
    buffer_load_dwordx2 v[104:105], v10, s[20:23], s46 offen
    buffer_load_dwordx2 v[106:107], v9, s[24:27], s4 offen
    v_add_u32 v7, 512, v0
    v_mul_u32_u24 v8, 0xcccd, v7
    v_lshrrev_b32 v8, 20, v8
    v_mul_u32_u24 v9, 20, v8
    v_sub_u32 v9, v7, v9
    v_mul_u32_u24 v108, 1280, v8
    v_lshl_add_u32 v108, v9, 3, v108
    v_mul_u32_u24 v109, 336, v8
    v_lshl_add_u32 v109, v9, 4, v109
    v_lshlrev_b32 v9, 3, v9
    buffer_load_dwordx2 v[110:111], v108, s[16:19], s3 offen
    v_lshrrev_b32 v10, 4, v8
    v_mul_u32_u24 v10, 20480, v10
    v_and_b32 v11, 15, v8
    v_lshl_add_u32 v10, v11, 4, v10
    v_lshrrev_b32 v11, 4, v9
    v_lshl_add_u32 v10, v11, 8, v10
    v_and_b32 v11, 8, v9
    v_add_u32 v10, v10, v11
    buffer_load_dwordx2 v[112:113], v10, s[20:23], s46 offen
    buffer_load_dwordx2 v[114:115], v9, s[24:27], s4 offen
    v_add_u32 v7, 768, v0
    v_mul_u32_u24 v8, 0xcccd, v7
    v_lshrrev_b32 v8, 20, v8
    v_mul_u32_u24 v9, 20, v8
    v_sub_u32 v9, v7, v9
    v_mul_u32_u24 v116, 1280, v8
    v_lshl_add_u32 v116, v9, 3, v116
    v_mul_u32_u24 v117, 336, v8
    v_lshl_add_u32 v117, v9, 4, v117
    v_lshlrev_b32 v9, 3, v9
    buffer_load_dwordx2 v[118:119], v116, s[16:19], s3 offen
    v_lshrrev_b32 v10, 4, v8
    v_mul_u32_u24 v10, 20480, v10
    v_and_b32 v11, 15, v8
    v_lshl_add_u32 v10, v11, 4, v10
    v_lshrrev_b32 v11, 4, v9
    v_lshl_add_u32 v10, v11, 8, v10
    v_and_b32 v11, 8, v9
    v_add_u32 v10, v10, v11
    buffer_load_dwordx2 v[120:121], v10, s[20:23], s46 offen
    buffer_load_dwordx2 v[122:123], v9, s[24:27], s4 offen
    v_add_u32 v7, 1024, v0
    v_mul_u32_u24 v8, 0xcccd, v7
    v_lshrrev_b32 v8, 20, v8
    v_mul_u32_u24 v9, 20, v8
    v_sub_u32 v9, v7, v9
    v_mul_u32_u24 v124, 1280, v8
    v_lshl_add_u32 v124, v9, 3, v124
    v_mul_u32_u24 v125, 336, v8
    v_lshl_add_u32 v125, v9, 4, v125
    v_lshlrev_b32 v9, 3, v9
    buffer_load_dwordx2 v[126:127], v124, s[16:19], s3 offen
    v_lshrrev_b32 v10, 4, v8
    v_mul_u32_u24 v10, 20480, v10
    v_and_b32 v11, 15, v8
    v_lshl_add_u32 v10, v11, 4, v10
    v_lshrrev_b32 v11, 4, v9
    v_lshl_add_u32 v10, v11, 8, v10
    v_and_b32 v11, 8, v9
    v_add_u32 v10, v10, v11
    buffer_load_dwordx2 v[128:129], v10, s[20:23], s46 offen
    buffer_load_dwordx2 v[130:131], v9, s[24:27], s4 offen
    v_mul_u32_u24 v7, 336, v5
    v_lshl_add_u32 v7, v6, 4, v7
    s_mul_i32 s10, s28, 21504
    v_add_u32 v7, s10, v7
    s_nop 7
    ds_write_b128 v7, v[12:15] offset:0
    ds_write_b128 v7, v[16:19] offset:64
    ds_write_b128 v7, v[20:23] offset:128
    ds_write_b128 v7, v[24:27] offset:192
    ds_write_b128 v7, v[28:31] offset:256
    ds_write_b128 v7, v[32:35] offset:5376
    ds_write_b128 v7, v[36:39] offset:5440
    ds_write_b128 v7, v[40:43] offset:5504
    ds_write_b128 v7, v[44:47] offset:5568
    ds_write_b128 v7, v[48:51] offset:5632
    ds_write_b128 v7, v[52:55] offset:10752
    ds_write_b128 v7, v[56:59] offset:10816
    ds_write_b128 v7, v[60:63] offset:10880
    ds_write_b128 v7, v[64:67] offset:10944
    ds_write_b128 v7, v[68:71] offset:11008
    ds_write_b128 v7, v[72:75] offset:16128
    ds_write_b128 v7, v[76:79] offset:16192
    ds_write_b128 v7, v[80:83] offset:16256
    ds_write_b128 v7, v[84:87] offset:16320
    ds_write_b128 v7, v[88:91] offset:16384
    s_mov_b32 s10, 0xbfb8aa3b
    s_mov_b32 s11, 0xbfb8aa3b
    s_waitcnt lgkmcnt(0)
    s_barrier
    ds_read_b128 v[140:143], v93 offset:0
    ds_read_b128 v[144:147], v93 offset:21504
    ds_read_b128 v[148:151], v93 offset:43008
    ds_read_b128 v[152:155], v93 offset:64512
    ds_read_b128 v[156:159], v101 offset:0
    ds_read_b128 v[160:163], v101 offset:21504
    ds_read_b128 v[164:167], v101 offset:43008
    ds_read_b128 v[168:171], v101 offset:64512
    ds_read_b128 v[172:175], v109 offset:0
    ds_read_b128 v[176:179], v109 offset:21504
    ds_read_b128 v[180:183], v109 offset:43008
    ds_read_b128 v[184:187], v109 offset:64512
    ds_read_b128 v[188:191], v117 offset:0
    ds_read_b128 v[192:195], v117 offset:21504
    ds_read_b128 v[196:199], v117 offset:43008
    ds_read_b128 v[200:203], v117 offset:64512
    ds_read_b128 v[204:207], v125 offset:0
    ds_read_b128 v[208:211], v125 offset:21504
    ds_read_b128 v[212:215], v125 offset:43008
    ds_read_b128 v[216:219], v125 offset:64512
    s_waitcnt vmcnt(0)
    v_lshlrev_b32 v12, 16, v96
    v_and_b32 v13, 0xffff0000, v96
    v_lshlrev_b32 v14, 16, v97
    v_and_b32 v15, 0xffff0000, v97
    v_lshlrev_b32 v28, 16, v104
    v_and_b32 v29, 0xffff0000, v104
    v_lshlrev_b32 v30, 16, v105
    v_and_b32 v31, 0xffff0000, v105
    v_lshlrev_b32 v44, 16, v112
    v_and_b32 v45, 0xffff0000, v112
    v_lshlrev_b32 v46, 16, v113
    v_and_b32 v47, 0xffff0000, v113
    v_lshlrev_b32 v60, 16, v120
    v_and_b32 v61, 0xffff0000, v120
    v_lshlrev_b32 v62, 16, v121
    v_and_b32 v63, 0xffff0000, v121
    v_lshlrev_b32 v76, 16, v128
    v_and_b32 v77, 0xffff0000, v128
    v_lshlrev_b32 v78, 16, v129
    v_and_b32 v79, 0xffff0000, v129
    v_lshlrev_b32 v16, 16, v98
    v_and_b32 v17, 0xffff0000, v98
    v_lshlrev_b32 v18, 16, v99
    v_and_b32 v19, 0xffff0000, v99
    v_lshlrev_b32 v32, 16, v106
    v_and_b32 v33, 0xffff0000, v106
    v_lshlrev_b32 v34, 16, v107
    v_and_b32 v35, 0xffff0000, v107
    v_lshlrev_b32 v48, 16, v114
    v_and_b32 v49, 0xffff0000, v114
    v_lshlrev_b32 v50, 16, v115
    v_and_b32 v51, 0xffff0000, v115
    v_lshlrev_b32 v64, 16, v122
    v_and_b32 v65, 0xffff0000, v122
    v_lshlrev_b32 v66, 16, v123
    v_and_b32 v67, 0xffff0000, v123
    v_lshlrev_b32 v80, 16, v130
    v_and_b32 v81, 0xffff0000, v130
    v_lshlrev_b32 v82, 16, v131
    v_and_b32 v83, 0xffff0000, v131
    v_pk_mul_f32 v[12:13], v[12:13], v[16:17] op_sel:[0,0] op_sel_hi:[1,1]
    v_pk_mul_f32 v[14:15], v[14:15], v[18:19] op_sel:[0,0] op_sel_hi:[1,1]
    v_pk_mul_f32 v[28:29], v[28:29], v[32:33] op_sel:[0,0] op_sel_hi:[1,1]
    v_pk_mul_f32 v[30:31], v[30:31], v[34:35] op_sel:[0,0] op_sel_hi:[1,1]
    v_pk_mul_f32 v[44:45], v[44:45], v[48:49] op_sel:[0,0] op_sel_hi:[1,1]
    v_pk_mul_f32 v[46:47], v[46:47], v[50:51] op_sel:[0,0] op_sel_hi:[1,1]
    v_pk_mul_f32 v[60:61], v[60:61], v[64:65] op_sel:[0,0] op_sel_hi:[1,1]
    v_pk_mul_f32 v[62:63], v[62:63], v[66:67] op_sel:[0,0] op_sel_hi:[1,1]
    v_pk_mul_f32 v[76:77], v[76:77], v[80:81] op_sel:[0,0] op_sel_hi:[1,1]
    v_pk_mul_f32 v[78:79], v[78:79], v[82:83] op_sel:[0,0] op_sel_hi:[1,1]
    v_cvt_pk_bf16_f32 v16, v12, v13
    v_cvt_pk_bf16_f32 v17, v14, v15
    v_cvt_pk_bf16_f32 v32, v28, v29
    v_cvt_pk_bf16_f32 v33, v30, v31
    v_cvt_pk_bf16_f32 v48, v44, v45
    v_cvt_pk_bf16_f32 v49, v46, v47
    v_cvt_pk_bf16_f32 v64, v60, v61
    v_cvt_pk_bf16_f32 v65, v62, v63
    v_cvt_pk_bf16_f32 v80, v76, v77
    v_cvt_pk_bf16_f32 v81, v78, v79
    v_lshlrev_b32 v12, 16, v16
    v_and_b32 v13, 0xffff0000, v16
    v_lshlrev_b32 v14, 16, v17
    v_and_b32 v15, 0xffff0000, v17
    v_lshlrev_b32 v28, 16, v32
    v_and_b32 v29, 0xffff0000, v32
    v_lshlrev_b32 v30, 16, v33
    v_and_b32 v31, 0xffff0000, v33
    v_lshlrev_b32 v44, 16, v48
    v_and_b32 v45, 0xffff0000, v48
    v_lshlrev_b32 v46, 16, v49
    v_and_b32 v47, 0xffff0000, v49
    v_lshlrev_b32 v60, 16, v64
    v_and_b32 v61, 0xffff0000, v64
    v_lshlrev_b32 v62, 16, v65
    v_and_b32 v63, 0xffff0000, v65
    v_lshlrev_b32 v76, 16, v80
    v_and_b32 v77, 0xffff0000, v80
    v_lshlrev_b32 v78, 16, v81
    v_and_b32 v79, 0xffff0000, v81
    v_lshlrev_b32 v20, 16, v94
    v_and_b32 v21, 0xffff0000, v94
    v_lshlrev_b32 v22, 16, v95
    v_and_b32 v23, 0xffff0000, v95
    v_lshlrev_b32 v36, 16, v102
    v_and_b32 v37, 0xffff0000, v102
    v_lshlrev_b32 v38, 16, v103
    v_and_b32 v39, 0xffff0000, v103
    v_lshlrev_b32 v52, 16, v110
    v_and_b32 v53, 0xffff0000, v110
    v_lshlrev_b32 v54, 16, v111
    v_and_b32 v55, 0xffff0000, v111
    v_lshlrev_b32 v68, 16, v118
    v_and_b32 v69, 0xffff0000, v118
    v_lshlrev_b32 v70, 16, v119
    v_and_b32 v71, 0xffff0000, v119
    v_lshlrev_b32 v84, 16, v126
    v_and_b32 v85, 0xffff0000, v126
    v_lshlrev_b32 v86, 16, v127
    v_and_b32 v87, 0xffff0000, v127
    s_waitcnt lgkmcnt(0)
    v_pk_add_f32 v[140:141], v[140:141], v[144:145] op_sel:[0,0] op_sel_hi:[1,1]
    v_pk_add_f32 v[148:149], v[148:149], v[152:153] op_sel:[0,0] op_sel_hi:[1,1]
    v_pk_add_f32 v[142:143], v[142:143], v[146:147] op_sel:[0,0] op_sel_hi:[1,1]
    v_pk_add_f32 v[150:151], v[150:151], v[154:155] op_sel:[0,0] op_sel_hi:[1,1]
    v_pk_add_f32 v[156:157], v[156:157], v[160:161] op_sel:[0,0] op_sel_hi:[1,1]
    v_pk_add_f32 v[164:165], v[164:165], v[168:169] op_sel:[0,0] op_sel_hi:[1,1]
    v_pk_add_f32 v[158:159], v[158:159], v[162:163] op_sel:[0,0] op_sel_hi:[1,1]
    v_pk_add_f32 v[166:167], v[166:167], v[170:171] op_sel:[0,0] op_sel_hi:[1,1]
    v_pk_add_f32 v[172:173], v[172:173], v[176:177] op_sel:[0,0] op_sel_hi:[1,1]
    v_pk_add_f32 v[180:181], v[180:181], v[184:185] op_sel:[0,0] op_sel_hi:[1,1]
    v_pk_add_f32 v[174:175], v[174:175], v[178:179] op_sel:[0,0] op_sel_hi:[1,1]
    v_pk_add_f32 v[182:183], v[182:183], v[186:187] op_sel:[0,0] op_sel_hi:[1,1]
    v_pk_add_f32 v[188:189], v[188:189], v[192:193] op_sel:[0,0] op_sel_hi:[1,1]
    v_pk_add_f32 v[196:197], v[196:197], v[200:201] op_sel:[0,0] op_sel_hi:[1,1]
    v_pk_add_f32 v[190:191], v[190:191], v[194:195] op_sel:[0,0] op_sel_hi:[1,1]
    v_pk_add_f32 v[198:199], v[198:199], v[202:203] op_sel:[0,0] op_sel_hi:[1,1]
    v_pk_add_f32 v[204:205], v[204:205], v[208:209] op_sel:[0,0] op_sel_hi:[1,1]
    v_pk_add_f32 v[212:213], v[212:213], v[216:217] op_sel:[0,0] op_sel_hi:[1,1]
    v_pk_add_f32 v[206:207], v[206:207], v[210:211] op_sel:[0,0] op_sel_hi:[1,1]
    v_pk_add_f32 v[214:215], v[214:215], v[218:219] op_sel:[0,0] op_sel_hi:[1,1]
    v_pk_fma_f32 v[12:13], v[140:141], 2.0, v[12:13] op_sel_hi:[1,0,1]
    v_pk_fma_f32 v[14:15], v[142:143], 2.0, v[14:15] op_sel_hi:[1,0,1]
    v_cvt_pk_bf16_f32 v16, v148, v149
    v_cvt_pk_bf16_f32 v17, v150, v151
    v_pk_fma_f32 v[28:29], v[156:157], 2.0, v[28:29] op_sel_hi:[1,0,1]
    v_pk_fma_f32 v[30:31], v[158:159], 2.0, v[30:31] op_sel_hi:[1,0,1]
    v_cvt_pk_bf16_f32 v32, v164, v165
    v_cvt_pk_bf16_f32 v33, v166, v167
    v_pk_fma_f32 v[44:45], v[172:173], 2.0, v[44:45] op_sel_hi:[1,0,1]
    v_pk_fma_f32 v[46:47], v[174:175], 2.0, v[46:47] op_sel_hi:[1,0,1]
    v_cvt_pk_bf16_f32 v48, v180, v181
    v_cvt_pk_bf16_f32 v49, v182, v183
    v_pk_fma_f32 v[60:61], v[188:189], 2.0, v[60:61] op_sel_hi:[1,0,1]
    v_pk_fma_f32 v[62:63], v[190:191], 2.0, v[62:63] op_sel_hi:[1,0,1]
    v_cvt_pk_bf16_f32 v64, v196, v197
    v_cvt_pk_bf16_f32 v65, v198, v199
    v_pk_fma_f32 v[76:77], v[204:205], 2.0, v[76:77] op_sel_hi:[1,0,1]
    v_pk_fma_f32 v[78:79], v[206:207], 2.0, v[78:79] op_sel_hi:[1,0,1]
    v_cvt_pk_bf16_f32 v80, v212, v213
    v_cvt_pk_bf16_f32 v81, v214, v215
    v_lshlrev_b32 v148, 16, v16
    v_and_b32 v149, 0xffff0000, v16
    v_lshlrev_b32 v150, 16, v17
    v_and_b32 v151, 0xffff0000, v17
    v_lshlrev_b32 v164, 16, v32
    v_and_b32 v165, 0xffff0000, v32
    v_lshlrev_b32 v166, 16, v33
    v_and_b32 v167, 0xffff0000, v33
    v_lshlrev_b32 v180, 16, v48
    v_and_b32 v181, 0xffff0000, v48
    v_lshlrev_b32 v182, 16, v49
    v_and_b32 v183, 0xffff0000, v49
    v_lshlrev_b32 v196, 16, v64
    v_and_b32 v197, 0xffff0000, v64
    v_lshlrev_b32 v198, 16, v65
    v_and_b32 v199, 0xffff0000, v65
    v_lshlrev_b32 v212, 16, v80
    v_and_b32 v213, 0xffff0000, v80
    v_lshlrev_b32 v214, 16, v81
    v_and_b32 v215, 0xffff0000, v81
    v_pk_mul_f32 v[152:153], v[148:149], s[10:11]
    v_pk_mul_f32 v[154:155], v[150:151], s[10:11]
    v_pk_mul_f32 v[168:169], v[164:165], s[10:11]
    v_pk_mul_f32 v[170:171], v[166:167], s[10:11]
    v_pk_mul_f32 v[184:185], v[180:181], s[10:11]
    v_pk_mul_f32 v[186:187], v[182:183], s[10:11]
    v_pk_mul_f32 v[200:201], v[196:197], s[10:11]
    v_pk_mul_f32 v[202:203], v[198:199], s[10:11]
    v_pk_mul_f32 v[216:217], v[212:213], s[10:11]
    v_pk_mul_f32 v[218:219], v[214:215], s[10:11]
    v_exp_f32 v152, v152
    v_exp_f32 v153, v153
    v_exp_f32 v154, v154
    v_exp_f32 v155, v155
    v_exp_f32 v168, v168
    v_exp_f32 v169, v169
    v_exp_f32 v170, v170
    v_exp_f32 v171, v171
    v_exp_f32 v184, v184
    v_exp_f32 v185, v185
    v_exp_f32 v186, v186
    v_exp_f32 v187, v187
    v_exp_f32 v200, v200
    v_exp_f32 v201, v201
    v_exp_f32 v202, v202
    v_exp_f32 v203, v203
    v_exp_f32 v216, v216
    v_exp_f32 v217, v217
    v_exp_f32 v218, v218
    v_exp_f32 v219, v219
    v_pk_add_f32 v[152:153], v[152:153], 1.0 op_sel_hi:[1,0]
    v_pk_add_f32 v[154:155], v[154:155], 1.0 op_sel_hi:[1,0]
    v_pk_add_f32 v[168:169], v[168:169], 1.0 op_sel_hi:[1,0]
    v_pk_add_f32 v[170:171], v[170:171], 1.0 op_sel_hi:[1,0]
    v_pk_add_f32 v[184:185], v[184:185], 1.0 op_sel_hi:[1,0]
    v_pk_add_f32 v[186:187], v[186:187], 1.0 op_sel_hi:[1,0]
    v_pk_add_f32 v[200:201], v[200:201], 1.0 op_sel_hi:[1,0]
    v_pk_add_f32 v[202:203], v[202:203], 1.0 op_sel_hi:[1,0]
    v_pk_add_f32 v[216:217], v[216:217], 1.0 op_sel_hi:[1,0]
    v_pk_add_f32 v[218:219], v[218:219], 1.0 op_sel_hi:[1,0]
    v_rcp_f32 v152, v152
    v_rcp_f32 v153, v153
    v_rcp_f32 v154, v154
    v_rcp_f32 v155, v155
    v_rcp_f32 v168, v168
    v_rcp_f32 v169, v169
    v_rcp_f32 v170, v170
    v_rcp_f32 v171, v171
    v_rcp_f32 v184, v184
    v_rcp_f32 v185, v185
    v_rcp_f32 v186, v186
    v_rcp_f32 v187, v187
    v_rcp_f32 v200, v200
    v_rcp_f32 v201, v201
    v_rcp_f32 v202, v202
    v_rcp_f32 v203, v203
    v_rcp_f32 v216, v216
    v_rcp_f32 v217, v217
    v_rcp_f32 v218, v218
    v_rcp_f32 v219, v219
    v_pk_mul_f32 v[152:153], v[152:153], v[148:149] op_sel:[0,0] op_sel_hi:[1,1]
    v_pk_mul_f32 v[154:155], v[154:155], v[150:151] op_sel:[0,0] op_sel_hi:[1,1]
    v_pk_mul_f32 v[168:169], v[168:169], v[164:165] op_sel:[0,0] op_sel_hi:[1,1]
    v_pk_mul_f32 v[170:171], v[170:171], v[166:167] op_sel:[0,0] op_sel_hi:[1,1]
    v_pk_mul_f32 v[184:185], v[184:185], v[180:181] op_sel:[0,0] op_sel_hi:[1,1]
    v_pk_mul_f32 v[186:187], v[186:187], v[182:183] op_sel:[0,0] op_sel_hi:[1,1]
    v_pk_mul_f32 v[200:201], v[200:201], v[196:197] op_sel:[0,0] op_sel_hi:[1,1]
    v_pk_mul_f32 v[202:203], v[202:203], v[198:199] op_sel:[0,0] op_sel_hi:[1,1]
    v_pk_mul_f32 v[216:217], v[216:217], v[212:213] op_sel:[0,0] op_sel_hi:[1,1]
    v_pk_mul_f32 v[218:219], v[218:219], v[214:215] op_sel:[0,0] op_sel_hi:[1,1]
    v_cvt_pk_bf16_f32 v16, v152, v153
    v_cvt_pk_bf16_f32 v17, v154, v155
    v_cvt_pk_bf16_f32 v32, v168, v169
    v_cvt_pk_bf16_f32 v33, v170, v171
    v_cvt_pk_bf16_f32 v48, v184, v185
    v_cvt_pk_bf16_f32 v49, v186, v187
    v_cvt_pk_bf16_f32 v64, v200, v201
    v_cvt_pk_bf16_f32 v65, v202, v203
    v_cvt_pk_bf16_f32 v80, v216, v217
    v_cvt_pk_bf16_f32 v81, v218, v219
    v_lshlrev_b32 v152, 16, v16
    v_and_b32 v153, 0xffff0000, v16
    v_lshlrev_b32 v154, 16, v17
    v_and_b32 v155, 0xffff0000, v17
    v_lshlrev_b32 v168, 16, v32
    v_and_b32 v169, 0xffff0000, v32
    v_lshlrev_b32 v170, 16, v33
    v_and_b32 v171, 0xffff0000, v33
    v_lshlrev_b32 v184, 16, v48
    v_and_b32 v185, 0xffff0000, v48
    v_lshlrev_b32 v186, 16, v49
    v_and_b32 v187, 0xffff0000, v49
    v_lshlrev_b32 v200, 16, v64
    v_and_b32 v201, 0xffff0000, v64
    v_lshlrev_b32 v202, 16, v65
    v_and_b32 v203, 0xffff0000, v65
    v_lshlrev_b32 v216, 16, v80
    v_and_b32 v217, 0xffff0000, v80
    v_lshlrev_b32 v218, 16, v81
    v_and_b32 v219, 0xffff0000, v81
    v_pk_mul_f32 v[12:13], v[12:13], v[152:153] op_sel:[0,0] op_sel_hi:[1,1]
    v_pk_mul_f32 v[14:15], v[14:15], v[154:155] op_sel:[0,0] op_sel_hi:[1,1]
    v_pk_mul_f32 v[28:29], v[28:29], v[168:169] op_sel:[0,0] op_sel_hi:[1,1]
    v_pk_mul_f32 v[30:31], v[30:31], v[170:171] op_sel:[0,0] op_sel_hi:[1,1]
    v_pk_mul_f32 v[44:45], v[44:45], v[184:185] op_sel:[0,0] op_sel_hi:[1,1]
    v_pk_mul_f32 v[46:47], v[46:47], v[186:187] op_sel:[0,0] op_sel_hi:[1,1]
    v_pk_mul_f32 v[60:61], v[60:61], v[200:201] op_sel:[0,0] op_sel_hi:[1,1]
    v_pk_mul_f32 v[62:63], v[62:63], v[202:203] op_sel:[0,0] op_sel_hi:[1,1]
    v_pk_mul_f32 v[76:77], v[76:77], v[216:217] op_sel:[0,0] op_sel_hi:[1,1]
    v_pk_mul_f32 v[78:79], v[78:79], v[218:219] op_sel:[0,0] op_sel_hi:[1,1]
    v_pk_add_f32 v[12:13], v[12:13], v[20:21] op_sel:[0,0] op_sel_hi:[1,1]
    v_pk_add_f32 v[14:15], v[14:15], v[22:23] op_sel:[0,0] op_sel_hi:[1,1]
    v_lshlrev_b32 v16, 1, v92
    v_pk_add_f32 v[28:29], v[28:29], v[36:37] op_sel:[0,0] op_sel_hi:[1,1]
    v_pk_add_f32 v[30:31], v[30:31], v[38:39] op_sel:[0,0] op_sel_hi:[1,1]
    v_lshlrev_b32 v32, 1, v100
    v_pk_add_f32 v[44:45], v[44:45], v[52:53] op_sel:[0,0] op_sel_hi:[1,1]
    v_pk_add_f32 v[46:47], v[46:47], v[54:55] op_sel:[0,0] op_sel_hi:[1,1]
    v_lshlrev_b32 v48, 1, v108
    v_pk_add_f32 v[60:61], v[60:61], v[68:69] op_sel:[0,0] op_sel_hi:[1,1]
    v_pk_add_f32 v[62:63], v[62:63], v[70:71] op_sel:[0,0] op_sel_hi:[1,1]
    v_lshlrev_b32 v64, 1, v116
    v_pk_add_f32 v[76:77], v[76:77], v[84:85] op_sel:[0,0] op_sel_hi:[1,1]
    v_pk_add_f32 v[78:79], v[78:79], v[86:87] op_sel:[0,0] op_sel_hi:[1,1]
    v_lshlrev_b32 v80, 1, v124
    buffer_store_dwordx4 v[12:15], v16, s[32:35], s5 offen sc1
    buffer_store_dwordx4 v[28:31], v32, s[32:35], s5 offen sc1
    buffer_store_dwordx4 v[44:47], v48, s[32:35], s5 offen sc1
    buffer_store_dwordx4 v[60:63], v64, s[32:35], s5 offen sc1
    buffer_store_dwordx4 v[76:79], v80, s[32:35], s5 offen sc1
K3_END:
    s_endpgm
.section .rodata,"a"
.p2align 6
.amdhsa_kernel k0_kernel
  .amdhsa_next_free_vgpr 128
  .amdhsa_next_free_sgpr 102
  .amdhsa_accum_offset 128
  .amdhsa_group_segment_fixed_size 0
  .amdhsa_kernarg_size 120
  .amdhsa_user_sgpr_count 2
  .amdhsa_user_sgpr_kernarg_segment_ptr 1
  .amdhsa_system_sgpr_workgroup_id_x 1
  .amdhsa_float_denorm_mode_32 3
.end_amdhsa_kernel
.p2align 6
.amdhsa_kernel k1_kernel
  .amdhsa_next_free_vgpr 256
  .amdhsa_next_free_sgpr 102
  .amdhsa_accum_offset 256
  .amdhsa_group_segment_fixed_size 0
  .amdhsa_kernarg_size 120
  .amdhsa_user_sgpr_count 2
  .amdhsa_user_sgpr_kernarg_segment_ptr 1
  .amdhsa_system_sgpr_workgroup_id_x 1
  .amdhsa_float_denorm_mode_32 3
.end_amdhsa_kernel
.p2align 6
.amdhsa_kernel k3_kernel
  .amdhsa_next_free_vgpr 256
  .amdhsa_next_free_sgpr 102
  .amdhsa_accum_offset 256
  .amdhsa_group_segment_fixed_size 0
  .amdhsa_kernarg_size 120
  .amdhsa_user_sgpr_count 2
  .amdhsa_user_sgpr_kernarg_segment_ptr 1
  .amdhsa_system_sgpr_workgroup_id_x 1
  .amdhsa_float_denorm_mode_32 3
.end_amdhsa_kernel
```
